```python
import torch

def _softmax(x, axis=-1):
    return torch.softmax(x, dim=axis)
def _gelu(x):
    return torch.nn.functional.gelu(x, approximate="tanh")
def _silu(x):
    return torch.nn.functional.silu(x)
def _sigmoid(x):
    return torch.sigmoid(x)
def _layernorm(x, axis=-1, eps=1e-5):
    m = x.mean(dim=axis, keepdim=True)
    v = x.var(dim=axis, keepdim=True, unbiased=False)
    return (x - m) / torch.sqrt(v + eps)
def _scatter_add(tgt, idx, src, axis=0):
    return tgt.clone().index_add_(axis, idx, src)
def _segment_sum(src, seg, n):
    out = torch.zeros((n,) + src.shape[1:], dtype=src.dtype)
    return out.index_add_(0, seg, src)
def _pad(x, pw):
    flat = tuple(v for pair in reversed(pw) for v in pair)
    return torch.nn.functional.pad(x, flat)

kernel_name = 'gated_mix__ssm_conv_s5__linear_attn_block__prompt'

def setup_inputs():

    _w = (lambda a: (lambda t: t.to(torch.bfloat16) if t.is_floating_point() else t)(torch.as_tensor(a)))
    def _A_setup():
        B, S, D = 1, 2048, 640
        P = D
        Lambda_re = -0.5 * (lambda _x: torch.exp(torch.as_tensor(_x)))((lambda *s: torch.randn(*s, dtype=torch.bfloat16) * 0.2)(P))
        Lambda_im = (lambda *s: torch.randn(*s, dtype=torch.bfloat16) * 0.8)(P) * 1.0
        B_re = (lambda *s: torch.randn(*s, dtype=torch.bfloat16) * 0.4)(P, D) * (D ** -0.5)
        B_im = (lambda *s: torch.randn(*s, dtype=torch.bfloat16) * 0.4)(P, D) * (D ** -0.5)
        C_re = (lambda *s: torch.randn(*s, dtype=torch.bfloat16) * 0.4)(D, P) * (P ** -0.5)
        C_im = (lambda *s: torch.randn(*s, dtype=torch.bfloat16) * 0.4)(D, P) * (P ** -0.5)
        log_dt = (lambda *s: torch.randn(*s, dtype=torch.bfloat16) * 0.2)(P) * 0.3 - 2.0
        Dskip = (lambda *s: torch.randn(*s, dtype=torch.bfloat16) * 0.05)(D)
        return {
            "x": _w((lambda *s: torch.randn(*s, dtype=torch.bfloat16) * 0.05)(B, S, D)),
            "Lambda_re": _w(Lambda_re),
            "Lambda_im": _w(Lambda_im),
            "B_re": _w(B_re),
            "B_im": _w(B_im),
            "C_re": _w(C_re),
            "C_im": _w(C_im),
            "log_dt": _w(log_dt),
            "Dskip": _w(Dskip),
        }
    _A_in = _A_setup()

    def _B_setup():
        B, S, D = 1, 2048, 640
        return {
            "x": _w((lambda *s: torch.randn(*s, dtype=torch.bfloat16) * 0.05)(B, S, D)),
            "wqkv": _w((lambda *s: torch.randn(*s, dtype=torch.bfloat16) * 0.8)(D, 3 * D)),
            "wo": _w((lambda *s: torch.randn(*s, dtype=torch.bfloat16) * 0.05)(D, D)),
        }
    _B_in = _B_setup()

    return {
        "A_x": _A_in["x"],
        "A_Lambda_re": _A_in["Lambda_re"],
        "A_Lambda_im": _A_in["Lambda_im"],
        "A_B_re": _A_in["B_re"],
        "A_B_im": _A_in["B_im"],
        "A_C_re": _A_in["C_re"],
        "A_C_im": _A_in["C_im"],
        "A_log_dt": _A_in["log_dt"],
        "A_Dskip": _A_in["Dskip"],
        "B_x": _B_in["x"],
        "B_wqkv": _B_in["wqkv"],
        "B_wo": _B_in["wo"],
        "gate_w": _w((lambda *s: torch.randn(*s, dtype=torch.bfloat16) * 0.05)(640) * 16.0),
    }

def reference(A_x, A_Lambda_re, A_Lambda_im, A_B_re, A_B_im, A_C_re, A_C_im, A_log_dt, A_Dskip, B_x, B_wqkv, B_wo, gate_w):
    def _A_ref(x, Lambda_re, Lambda_im, B_re, B_im, C_re, C_im, log_dt, Dskip):
        Bsz, L, H = x.shape
        Lam = Lambda_re + 1j * Lambda_im
        Bmat = B_re + 1j * B_im
        Cmat = C_re + 1j * C_im
        dt = torch.exp(log_dt)
        Lam_bar = torch.exp(dt * Lam)
        B_bar = ((Lam_bar - 1.0) / Lam)[:, None] * Bmat
        Bu = torch.einsum("bld,pd->blp", x + 0j, B_bar)
        h = torch.zeros_like(Bu[:, 0, :])
        hs = []
        for t in range(L):
            h = Lam_bar[None, :] * h + Bu[:, t, :]
            hs.append(h)
        hseq = torch.stack(hs, 1)
        y = 2.0 * torch.einsum("blp,dp->bld", hseq, Cmat).real + x * Dskip[None, None, :]
        return y

    def _B_ref(x, wqkv, wo):
        B, S, D = x.shape
        H = 32; Dh = D // H
        qkv = (lambda x, *d: x.permute(*d))((x @ wqkv).reshape(B, S, 3, H, Dh), 2, 0, 3, 1, 4)
        q, k, v = qkv[0], qkv[1], qkv[2]
        phi = lambda t: torch.where(t > 0, t + 1, torch.exp(t)) + 1e-6
        pq, pk = phi(q), phi(k)
        kv = torch.einsum("bhsd,bhse->bhde", pk, v)
        z = torch.einsum("bhsd->bhd", pk)
        num = torch.einsum("bhqd,bhde->bhqe", pq, kv)
        den = torch.einsum("bhqd,bhd->bhq", pq, z)[..., None] + 1e-6
        o = num / den
        return (lambda x, *d: x.permute(*d))(o, 0, 2, 1, 3).reshape(B, S, D) @ wo

    x = A_x
    g = _sigmoid((x * gate_w).sum(-1, keepdims=True))
    a = _A_ref(x, A_Lambda_re, A_Lambda_im, A_B_re, A_B_im, A_C_re, A_C_im, A_log_dt, A_Dskip)
    b = _B_ref(x, B_wqkv, B_wo)
    return g * a + (1 - g) * b
```

```asm
; @launch grid=(256,1,1) block=(256,1,1) lds=163840
.amdgcn_target "amdgcn-amd-amdhsa--gfx950"
.text
.globl gated_mix__ssm_conv_s5__linear_attn_block__prompt_kernel
.p2align 8
.type gated_mix__ssm_conv_s5__linear_attn_block__prompt_kernel,@function
gated_mix__ssm_conv_s5__linear_attn_block__prompt_kernel:
    s_cmp_ge_u32 s2, 256
    s_cbranch_scc1 Lend
    s_load_dwordx16 s[32:47], s[0:1], 0
    s_load_dwordx16 s[48:63], s[0:1], 64
    v_and_b32 v1, 63, v0
    v_lshrrev_b32 v32, 6, v0
    s_and_b32 s7, s2, 7
    s_lshr_b32 s31, s2, 3
    v_readfirstlane_b32 s3, v32
    s_getpc_b64 s[92:93]
Lpc:
    s_lshl_b32 s94, s3, 5
    s_add_u32 s94, s94, s31
    s_lshl_b32 s94, s94, 10
    s_cmp_ge_u32 s94, Lcode_end-Lpc
    s_cbranch_scc1 Lnopf
    v_lshl_add_u32 v33, v1, 4, s94
    global_load_dwordx4 v[36:39], v33, s[92:93]
Lnopf:
    s_lshr_b32 s4, s7, 2
    s_lshl_b32 s4, s4, 3
    s_and_b32 s29, s31, 7
    s_add_u32 s4, s4, s29
    s_lshr_b32 s101, s31, 3
    s_and_b32 s5, s7, 3
    s_lshl_b32 s5, s5, 1
    s_and_b32 s93, s101, 1
    s_add_u32 s5, s5, s93
    s_lshl_b32 s28, s7, 2
    s_and_b32 s93, s29, 1
    s_lshl_b32 s93, s93, 1
    s_xor_b32 s93, s93, s101
    s_add_u32 s28, s28, s93
    s_lshl_b32 s92, s101, 2
    s_lshr_b32 s92, 0x3210, s92
    s_and_b32 s92, s92, 15
    s_add_u32 s92, s92, s29
    s_sub_u32 s93, s92, 10
    s_cmp_ge_u32 s92, 10
    s_cselect_b32 s92, s93, s92
    s_sub_u32 s93, s92, 5
    s_cmp_ge_u32 s92, 5
    s_cselect_b32 s92, s93, s92
    s_lshl_b32 s64, s92, 7
    s_add_u32 s65, s64, 128
    s_cmp_eq_u32 s65, 640
    s_cselect_b32 s65, 0, s65
    s_lshl_b32 s89, s3, 14
    s_mul_i32 s90, s3, 5120
    s_add_u32 s90, s90, 65536
    v_lshrrev_b32 v40, 3, v1
    v_and_b32 v41, 7, v1
    v_lshrrev_b32 v43, 1, v40
    v_xor_b32 v41, v41, v43
    v_lshlrev_b32 v41, 4, v41
    v_lshrrev_b32 v42, 2, v40
    v_lshlrev_b32 v42, 3, v42
    v_and_b32 v43, 1, v43
    v_add_u32 v42, v42, v43
    v_and_b32 v43, 1, v40
    v_lshl_add_u32 v42, v43, 2, v42
    s_lshl_b32 s92, s4, 7
    s_lshl_b32 s93, s3, 5
    s_add_u32 s92, s92, s93
    v_add_u32 v42, s92, v42
    v_mul_u32_u24 v42, 1280, v42
    v_add_u32 v2, v42, v41
    v_xor_b32 v44, 64, v41
    v_add_u32 v3, v42, v44
    v_add_u32 v3, 19456, v3
    v_add_u32 v4, 512, v2
    v_add_u32 v5, 512, v3
    v_mul_u32_u24 v43, 1280, v40
    v_add_u32 v45, v43, v41
    v_add_u32 v46, v43, v44
    s_mov_b32 s10, 2621440
    s_mov_b32 s11, 0x20000
    s_mov_b32 s14, 819200
    s_mov_b32 s15, 0x20000
    s_mov_b32 s18, 2457600
    s_mov_b32 s19, 0x20000
    s_cmp_lt_u32 s101, 2
    s_cbranch_scc0 LtypeA
    s_mov_b32 s100, 1
    s_and_b32 s92, s3, 1
    s_mul_i32 s93, s92, 40
    s_mul_i32 s94, s5, 80
    s_add_u32 s93, s93, s94
    s_mul_i32 s93, s93, 1280
    s_lshl_b32 s94, s92, 6
    v_xor_b32 v64, s94, v45
    v_xor_b32 v65, s94, v46
    v_add_u32 v6, s93, v64
    v_add_u32 v65, s93, v65
    v_add_u32 v7, 9216, v65
    v_add_u32 v8, 18432, v6
    v_add_u32 v9, 27648, v65
    v_add_u32 v10, 40960, v6
    s_mul_i32 s94, s5, 160
    v_and_b32 v66, 127, v0
    v_min_u32 v66, 79, v66
    v_lshl_add_u32 v66, v66, 1, s94
    v_mov_b32 v176, 0
    v_mov_b32 v177, 0
    v_mov_b32 v178, 0
    s_mul_i32 s74, s64, 1920
    s_mul_i32 s75, s65, 1920
    s_mul_i32 s95, s92, 122880
    s_add_u32 s95, s95, s94
    s_waitcnt lgkmcnt(0)
    s_mov_b32 s8, s32
    s_and_b32 s9, s33, 0xffff
    s_cmp_ge_u32 s3, 2
    s_cselect_b32 s12, s40, s38
    s_cselect_b32 s13, s41, s39
    s_and_b32 s13, s13, 0xffff
    global_load_short_d16_hi v176, v66, s[34:35]
    global_load_short_d16_hi v177, v66, s[36:37]
    global_load_short_d16_hi v178, v66, s[46:47]
    s_add_u32 m0, s89, 0
    s_nop 0
    buffer_load_dwordx4 v2, s[8:11], s64 offen offset:0 lds
    buffer_load_dwordx4 v3, s[8:11], s64 offen offset:1024 lds
    buffer_load_dwordx4 v4, s[8:11], s64 offen offset:2048 lds
    buffer_load_dwordx4 v5, s[8:11], s64 offen offset:3072 lds
    s_add_u32 m0, s90, 0
    s_nop 0
    buffer_load_dwordx4 v6, s[12:15], s64 offen offset:0 lds
    buffer_load_dwordx4 v7, s[12:15], s64 offen offset:1024 lds
    buffer_load_dwordx4 v8, s[12:15], s64 offen offset:2048 lds
    buffer_load_dwordx4 v9, s[12:15], s64 offen offset:3072 lds
    s_add_u32 m0, s90, 4096
    s_nop 0
    buffer_load_dwordx4 v10, s[12:15], s64 offen lds
    s_branch LB_rest
LtypeA:
    s_mov_b32 s100, 0
    s_lshr_b32 s92, s3, 1
    s_add_u32 s92, s92, 1
    s_mul_i32 s92, s92, 1280
    s_mul_i32 s93, s5, 160
    s_add_u32 s92, s92, s93
    s_and_b32 s93, s3, 1
    s_mul_i32 s93, s93, 122880
    s_add_u32 s92, s92, s93
    s_mul_i32 s74, s64, 1920
    s_mul_i32 s75, s65, 1920
    v_add_u32 v52, 0, v1
    v_mul_u32_u24 v53, 6554, v52
    v_lshrrev_b32 v53, 16, v53
    v_mul_u32_u24 v54, 10, v53
    v_sub_u32 v54, v52, v54
    v_lshrrev_b32 v55, 1, v53
    v_and_b32 v55, 4, v55
    v_xor_b32 v53, v53, v55
    v_mul_u32_u24 v53, 3840, v53
    v_lshl_add_u32 v54, v54, 4, s92
    v_add_u32 v6, v53, v54
    v_add_u32 v52, 64, v1
    v_mul_u32_u24 v53, 6554, v52
    v_lshrrev_b32 v53, 16, v53
    v_mul_u32_u24 v54, 10, v53
    v_sub_u32 v54, v52, v54
    v_lshrrev_b32 v55, 1, v53
    v_and_b32 v55, 4, v55
    v_xor_b32 v53, v53, v55
    v_mul_u32_u24 v53, 3840, v53
    v_lshl_add_u32 v54, v54, 4, s92
    v_subrev_u32 v53, 1024, v53
    v_add_u32 v7, v53, v54
    v_add_u32 v52, 128, v1
    v_mul_u32_u24 v53, 6554, v52
    v_lshrrev_b32 v53, 16, v53
    v_mul_u32_u24 v54, 10, v53
    v_sub_u32 v54, v52, v54
    v_lshrrev_b32 v55, 1, v53
    v_and_b32 v55, 4, v55
    v_xor_b32 v53, v53, v55
    v_mul_u32_u24 v53, 3840, v53
    v_lshl_add_u32 v54, v54, 4, s92
    v_subrev_u32 v53, 2048, v53
    v_add_u32 v8, v53, v54
    v_add_u32 v52, 192, v1
    v_mul_u32_u24 v53, 6554, v52
    v_lshrrev_b32 v53, 16, v53
    v_mul_u32_u24 v54, 10, v53
    v_sub_u32 v54, v52, v54
    v_lshrrev_b32 v55, 1, v53
    v_and_b32 v55, 4, v55
    v_xor_b32 v53, v53, v55
    v_mul_u32_u24 v53, 3840, v53
    v_lshl_add_u32 v54, v54, 4, s92
    v_subrev_u32 v53, 3072, v53
    v_add_u32 v9, v53, v54
    v_add_u32 v52, 256, v1
    v_mul_u32_u24 v53, 6554, v52
    v_lshrrev_b32 v53, 16, v53
    v_mul_u32_u24 v54, 10, v53
    v_sub_u32 v54, v52, v54
    v_lshrrev_b32 v55, 1, v53
    v_and_b32 v55, 4, v55
    v_xor_b32 v53, v53, v55
    v_mul_u32_u24 v53, 3840, v53
    v_lshl_add_u32 v54, v54, 4, s92
    v_add_u32 v10, v53, v54
    s_waitcnt lgkmcnt(0)
    s_mov_b32 s8, s32
    s_and_b32 s9, s33, 0xffff
    s_mov_b32 s16, s52
    s_and_b32 s17, s53, 0xffff
    s_add_u32 m0, s89, 0
    s_nop 0
    buffer_load_dwordx4 v2, s[8:11], s64 offen offset:0 lds
    buffer_load_dwordx4 v3, s[8:11], s64 offen offset:1024 lds
    buffer_load_dwordx4 v4, s[8:11], s64 offen offset:2048 lds
    buffer_load_dwordx4 v5, s[8:11], s64 offen offset:3072 lds
    s_add_u32 m0, s90, 0
    s_nop 0
    buffer_load_dwordx4 v6, s[16:19], s74 offen offset:0 lds
    buffer_load_dwordx4 v7, s[16:19], s74 offen offset:1024 lds
    buffer_load_dwordx4 v8, s[16:19], s74 offen offset:2048 lds
    buffer_load_dwordx4 v9, s[16:19], s74 offen offset:3072 lds
    s_add_u32 m0, s90, 4096
    s_nop 0
    buffer_load_dwordx4 v10, s[16:19], s74 offen lds
    s_mov_b32 s12, s56
    s_and_b32 s13, s57, 0xffff
    s_mov_b32 s14, 1280
    s_mov_b32 s15, 0x20000
    s_and_b32 s92, s3, 1
    s_lshl_b32 s92, s92, 10
    v_lshlrev_b32 v64, 4, v1
    s_add_u32 m0, s92, 147456
    s_nop 0
    buffer_load_dwordx4 v64, s[12:15], s92 offen lds
    s_mov_b32 s20, s62
    s_and_b32 s21, s63, 0xffff
    s_mov_b32 s22, 13238272
    s_mov_b32 s23, 0x20000
    s_add_u32 s92, s62, 11272192
    s_addc_u32 s93, s63, 0
    s_load_dword s6, s[92:93], 0
    s_add_u32 s66, s65, 128
    s_cmp_eq_u32 s66, 640
    s_cselect_b32 s66, 0, s66
    s_add_u32 s67, s66, 128
    s_cmp_eq_u32 s67, 640
    s_cselect_b32 s67, 0, s67
    s_add_u32 s68, s67, 128
    s_cmp_eq_u32 s68, 640
    s_cselect_b32 s68, 0, s68
    s_add_u32 s69, s64, 640
    s_add_u32 s70, s65, 640
    s_add_u32 s71, s66, 640
    s_add_u32 s72, s67, 640
    s_add_u32 s73, s68, 640
    v_and_b32 v52, 15, v1
    v_lshrrev_b32 v53, 4, v1
    v_lshrrev_b32 v54, 1, v52
    v_xor_b32 v54, v54, v53
    v_lshlrev_b32 v54, 4, v54
    v_lshl_add_u32 v56, v52, 7, v54
    v_xor_b32 v57, 64, v56
    v_add_u32 v16, s89, v56
    v_add_u32 v17, s89, v57
    v_bfe_u32 v54, v1, 2, 2
    v_lshl_add_u32 v54, v53, 3, v54
    v_and_b32 v55, 1, v53
    v_lshlrev_b32 v55, 2, v55
    v_add_u32 v58, v54, v55
    v_xor_b32 v55, 4, v55
    v_add_u32 v59, v54, v55
    v_mul_u32_u24 v58, 160, v58
    v_mul_u32_u24 v59, 160, v59
    v_and_b32 v60, 3, v1
    v_mul_u32_u24 v61, 40, v60
    v_add_u32 v62, v58, v61
    v_add_u32 v63, v59, v61
    v_add_u32 v22, 65536, v62
    v_add_u32 v23, 65536, v63
    v_add_u32 v24, 106496, v62
    v_add_u32 v25, 106496, v63
    s_mul_i32 s92, s29, 204800
    v_lshl_add_u32 v26, v1, 4, s92
    v_add_u32 v27, 4096, v26
    v_add_u32 v28, 8192, v26
    s_lshr_b32 s92, s92, 1
    v_lshl_add_u32 v29, v1, 4, s92
    s_mul_i32 s76, s66, 1920
    s_mul_i32 s77, s67, 1920
    s_mul_i32 s78, s68, 1920
    s_mul_i32 s79, s69, 1920
    s_mul_i32 s80, s70, 1920
    s_mul_i32 s81, s71, 1920
    s_mul_i32 s82, s72, 1920
    s_mul_i32 s83, s73, 1920
    v_lshlrev_b32 v61, 3, v60
    v_add_u32 v62, v58, v61
    v_add_u32 v63, v59, v61
    v_add_u32 v18, 65536, v62
    v_add_u32 v19, 65536, v63
    v_add_u32 v20, 106496, v62
    v_add_u32 v21, 106496, v63
    v_lshrrev_b32 v11, 4, v1
    v_lshlrev_b32 v11, 4, v11
    v_add_u32 v11, 147456, v11
    s_and_b32 s92, s5, 1
    s_lshl_b32 s92, s92, 11
    s_xor_b32 s93, s92, 2048
    v_add_u32 v12, s92, v16
    v_add_u32 v13, s92, v17
    v_add_u32 v14, s93, v16
    v_add_u32 v15, s93, v17
    s_mov_b32 s12, s54
    s_and_b32 s13, s55, 0xffff
    s_mov_b32 s14, 819200
    s_mov_b32 s15, 0x20000
    s_and_b32 s31, s4, 1
    s_mul_i32 s92, s31, 40
    s_mul_i32 s93, s5, 80
    s_add_u32 s92, s92, s93
    s_mul_i32 s92, s92, 1280
    s_lshr_b32 s93, s4, 1
    s_mul_i32 s93, s93, 160
    s_add_u32 s92, s92, s93
    s_mov_b32 s50, s92
    s_lshl_b32 s51, s3, 10
    v_mov_b32 v211, 1073741824
    v_add_u32 v65, 0, v0
    v_mul_u32_u24 v66, 6554, v65
    v_lshrrev_b32 v66, 16, v66
    v_mul_u32_u24 v67, 10, v66
    v_sub_u32 v67, v65, v67
    v_mul_u32_u24 v66, 1280, v66
    v_lshl_add_u32 v66, v67, 4, v66
    v_cmp_gt_u32 vcc, 400, v65
    s_nop 1
    v_cndmask_b32 v72, v211, v66, vcc
    v_add_u32 v65, 256, v0
    v_mul_u32_u24 v66, 6554, v65
    v_lshrrev_b32 v66, 16, v66
    v_mul_u32_u24 v67, 10, v66
    v_sub_u32 v67, v65, v67
    v_mul_u32_u24 v66, 1280, v66
    v_lshl_add_u32 v66, v67, 4, v66
    v_cmp_gt_u32 vcc, 400, v65
    s_nop 1
    v_cndmask_b32 v73, v211, v66, vcc
    s_add_u32 m0, s51, 149504
    s_nop 0
    buffer_load_dwordx4 v72, s[12:15], s50 offen lds
    s_add_u32 m0, s51, 153600
    s_cmp_eq_u32 s3, 3
    s_cbranch_scc1 LskipWo
    buffer_load_dwordx4 v73, s[12:15], s50 offen lds
LskipWo:
    s_lshl_b32 s92, s5, 1
    s_add_u32 s92, s92, s31
    s_lshl_b32 s92, s92, 2
    s_add_u32 s92, s92, s3
    s_lshl_b32 s92, s92, 1
    s_cmp_ge_u32 s92, 50
    s_cselect_b32 s24, s44, s42
    s_cselect_b32 s25, s45, s43
    s_cselect_b32 s95, 1280, 0
    s_and_b32 s25, s25, 0xffff
    s_mov_b32 s26, 819200
    s_mov_b32 s27, 0x20000
    s_lshr_b32 s93, s4, 1
    s_mul_i32 s54, s93, 100
    s_add_u32 s54, s54, s92
    s_lshl_b32 s54, s54, 11
    s_add_u32 s54, s54, 11534336
    s_mul_i32 s93, s93, 102400
    s_sub_u32 s95, s93, s95
    s_cmp_ge_u32 s92, 100
    s_cmov_b32 s54, 1073741824
    s_cmov_b32 s95, 1073741824
    v_add_u32 v74, 9216, v46
    s_mul_i32 s93, s92, 13108
    s_lshr_b32 s93, s93, 16
    s_mul_i32 s94, s93, 5
    s_sub_u32 s94, s92, s94
    s_mul_i32 s94, s94, 20480
    s_lshl_b32 s93, s93, 7
    s_add_u32 s93, s93, s94
    s_add_u32 s52, s93, s95
    s_add_u32 s92, s92, 1
    s_mul_i32 s93, s92, 13108
    s_lshr_b32 s93, s93, 16
    s_mul_i32 s94, s93, 5
    s_sub_u32 s94, s92, s94
    s_mul_i32 s94, s94, 20480
    s_lshl_b32 s93, s93, 7
    s_add_u32 s93, s93, s94
    s_add_u32 s53, s93, s95
    s_add_u32 s92, s92, 1
    s_add_u32 m0, s89, 12288
    s_nop 0
    buffer_load_dwordx4 v45, s[24:27], s52 offen lds
    buffer_load_dwordx4 v74, s[24:27], s52 offen offset:1024 lds
    s_add_u32 m0, s89, 14336
    s_nop 0
    buffer_load_dwordx4 v45, s[24:27], s53 offen lds
    buffer_load_dwordx4 v74, s[24:27], s53 offen offset:1024 lds
    v_and_b32 v208, 15, v1
    v_lshrrev_b32 v209, 4, v1
    v_lshrrev_b32 v210, 2, v208
    v_lshlrev_b32 v212, 4, v209
    v_lshl_add_u32 v212, v208, 6, v212
    v_cmp_gt_u32 vcc, 2, v208
    s_nop 1
    v_cndmask_b32 v212, v211, v212, vcc
    s_lshl_b32 s41, s4, 3
    s_add_u32 s41, s41, s5
    s_lshl_b32 s41, s41, 7
    s_add_u32 s41, s41, 11010048
    v_cmp_eq_u32 s[60:61], s3, v210
    v_cmp_eq_u32 s[94:95], s3, v209
    s_add_u32 s92, s3, 1
    s_and_b32 s92, s92, 3
    s_lshl_b32 s92, s92, 2
    v_and_b32 v240, 3, v208
    v_add_u32 v241, 16, v240
    v_lshlrev_b32 v241, 4, v241
    v_cndmask_b32 v241, v211, v241, s[60:61]
    v_mov_b32 v243, 320
    v_cmp_eq_u32 vcc, s92, v208
    s_nop 1
    v_cndmask_b32 v241, v241, v243, vcc
    v_mul_u32_u24 v242, 336, v209
    v_lshl_add_u32 v215, v208, 4, v242
    v_lshlrev_b32 v216, 4, v208
    v_cndmask_b32 v216, v211, v216, s[94:95]
    v_add_u32 v217, v241, v242
    v_cndmask_b32 v218, v211, v241, s[94:95]
    s_lshl_b32 s92, s5, 4
    s_add_u32 s92, s92, s4
    s_lshl_b32 s34, s92, 9
    s_add_u32 s34, s34, 10485760
    s_mul_i32 s35, s92, 6720
    s_mul_i32 s93, s3, 1680
    s_add_u32 s35, s35, s93
    s_add_u32 s35, s35, 9437184
    v_lshlrev_b32 v220, 4, v1
    v_add_u32 v219, s89, v220
    s_lshl_b32 s92, s3, 10
    v_add_u32 v221, s92, v220
    s_mul_i32 s92, s4, 27
    v_and_b32 v242, 31, v1
    v_min_u32 v242, 26, v242
    v_add_u32 v242, s92, v242
    v_min_u32 v242, 419, v242
    v_lshrrev_b32 v243, 5, v1
    v_mul_u32_u24 v243, 53760, v243
    v_lshl_add_u32 v222, v242, 4, v243
    s_mul_i32 s36, s5, 107520
    s_add_u32 s36, s36, 9437184
    s_and_b32 s31, s4, 1
    v_and_b32 v242, 1, v209
    v_mul_u32_u24 v242, 20, v242
    v_add_u32 v242, v242, v210
    v_mul_u32_u24 v243, 160, v242
    v_lshl_add_u32 v243, v240, 3, v243
    v_add_u32 v233, 152064, v243
    v_lshrrev_b32 v242, 1, v209
    v_mul_u32_u24 v242, 1280, v242
    v_add_u32 v243, v243, v242
    v_add_u32 v232, 149504, v243
    s_lshl_b32 s92, s3, 5
    v_add_u32 v230, s92, v232
    v_add_u32 v231, s92, v233
    v_and_b32 v242, 1, v209
    v_lshrrev_b32 v243, 1, v209
    v_lshl_add_u32 v242, v243, 2, v242
    v_lshlrev_b32 v242, 8, v242
    v_lshl_add_u32 v234, v208, 4, v242
    v_mul_u32_u24 v243, 81920, v209
    v_lshl_add_u32 v243, v208, 4, v243
    s_cmp_eq_u32 s3, 0
    s_cselect_b32 s7, 2, 1
    v_cmp_gt_u32 vcc, s7, v209
    s_nop 1
    v_cndmask_b32 v235, v211, v243, vcc
    s_lshr_b32 s7, s4, 1
    s_mul_i32 s7, s7, 102400
    s_mul_i32 s92, s5, 2560
    s_add_u32 s7, s7, s92
    s_add_u32 s7, s7, 8388608
    s_lshl_b32 s92, s31, 9
    s_add_u32 s92, s92, s7
    s_lshl_b32 s93, s31, 8
    s_add_u32 s93, s93, s7
    s_mul_i32 s7, s3, 20480
    s_add_u32 s37, s92, s7
    s_add_u32 s38, s93, s7
    s_add_u32 s92, s92, 81920
    s_add_u32 s93, s93, 81920
    s_cmp_eq_u32 s3, 0
    s_cselect_b32 s39, s92, 1073741824
    s_cselect_b32 s40, s93, 1073741824
    v_mov_b32 v236, 0x3f803f80
    s_lshr_b32 s92, s28, 1
    v_lshl_add_u32 v240, v1, 4, s92
    v_mul_u32_u24 v240, 128, v240
    v_add_u32 v223, 11108352, v240
    s_and_b32 s93, s28, 1
    s_mul_i32 s93, s93, 8192
    s_add_u32 s93, s93, 11059200
    v_add_u32 v240, s93, v240
    s_lshl_b32 s92, s29, 1
    v_lshrrev_b32 v224, 1, v1
    v_lshl_add_u32 v224, v224, 4, s92
    v_and_b32 v241, 1, v1
    v_add_u32 v224, v224, v241
    v_mul_u32_u24 v224, 128, v224
    v_add_u32 v224, 11091968, v224
    v_cmp_gt_u32 vcc, 16, v1
    s_nop 1
    v_cndmask_b32 v224, v240, v224, vcc
    v_subrev_u32 v240, 40960, v223
    v_cmp_gt_u32 vcc, 20, v1
    s_nop 1
    v_cndmask_b32 v224, v240, v224, vcc
    v_subrev_u32 v223, 32768, v223
    s_lshl_b32 s92, s101, 2
    s_lshr_b32 s30, 0x3210, s92
    s_and_b32 s30, s30, 15
    s_add_u32 s30, s30, s29
    s_sub_u32 s93, s30, 10
    s_cmp_ge_u32 s30, 10
    s_cselect_b32 s30, s93, s30
    s_sub_u32 s93, s30, 5
    s_cmp_ge_u32 s30, 5
    s_cselect_b32 s30, s93, s30
    s_mul_i32 s92, s3, 5
    s_add_u32 s92, s92, s30
    s_add_u32 s84, s92, 0
    s_sub_u32 s93, s84, 20
    s_cmp_ge_u32 s84, 20
    s_cselect_b32 s84, s93, s84
    s_add_u32 s85, s92, 1
    s_sub_u32 s93, s85, 20
    s_cmp_ge_u32 s85, 20
    s_cselect_b32 s85, s93, s85
    s_add_u32 s86, s92, 2
    s_sub_u32 s93, s86, 20
    s_cmp_ge_u32 s86, 20
    s_cselect_b32 s86, s93, s86
    s_add_u32 s87, s92, 3
    s_sub_u32 s93, s87, 20
    s_cmp_ge_u32 s87, 20
    s_cselect_b32 s87, s93, s87
    s_add_u32 s88, s92, 4
    s_sub_u32 s93, s88, 20
    s_cmp_ge_u32 s88, 20
    s_cselect_b32 s88, s93, s88
    s_add_u32 m0, s89, 4096
    s_nop 0
    buffer_load_dwordx4 v2, s[8:11], s65 offen offset:0 lds
    buffer_load_dwordx4 v3, s[8:11], s65 offen offset:1024 lds
    buffer_load_dwordx4 v4, s[8:11], s65 offen offset:2048 lds
    buffer_load_dwordx4 v5, s[8:11], s65 offen offset:3072 lds
    s_add_u32 m0, s90, 20480
    s_nop 0
    buffer_load_dwordx4 v6, s[16:19], s75 offen offset:0 lds
    buffer_load_dwordx4 v7, s[16:19], s75 offen offset:1024 lds
    buffer_load_dwordx4 v8, s[16:19], s75 offen offset:2048 lds
    buffer_load_dwordx4 v9, s[16:19], s75 offen offset:3072 lds
    s_add_u32 m0, s90, 24576
    s_nop 0
    buffer_load_dwordx4 v10, s[16:19], s75 offen lds
    s_mov_b32 s24, s48
    s_and_b32 s25, s49, 0xffff
    s_mov_b32 s26, 1280
    s_mov_b32 s27, 0x20000
    s_add_u32 s7, s3, s29
    s_and_b32 s7, s7, 3
    s_lshl_b32 s56, s28, 2
    s_add_u32 s7, s7, s56
    s_lshr_b32 s56, s7, 1
    s_lshl_b32 s56, s56, 5
    s_and_b32 s57, s7, 1
    s_lshl_b32 s57, s57, 1
    s_add_u32 s56, s56, s57
    s_mul_i32 s56, s56, 1280
    s_mul_i32 s57, s29, 160
    s_add_u32 s56, s56, s57
    v_bfe_u32 v238, v1, 5, 1
    v_bfe_u32 v239, v1, 4, 1
    v_lshl_add_u32 v238, v239, 2, v238
    v_mul_u32_u24 v238, 1280, v238
    v_lshrrev_b32 v239, 4, v1
    v_mul_u32_u24 v239, 17, v239
    v_sub_u32 v239, v1, v239
    v_med3_i32 v239, v239, 0, 9
    v_lshl_add_u32 v238, v239, 4, v238
    s_waitcnt lgkmcnt(0)
    s_add_u32 s6, s6, 0x9e3779b1
    s_and_b32 s92, s6, 0xff
    v_mov_b32 v237, s92
    s_lshr_b32 s92, s5, 1
    s_sub_u32 s46, s92, s3
    s_waitcnt vmcnt(9)
    s_barrier
    ds_read_b128 a[0:3], v12 offset:0
    ds_read_b128 a[4:7], v14 offset:0
    ds_read_b64_tr_b16 v[116:117], v18 offset:0
    ds_read_b64_tr_b16 v[118:119], v19 offset:0
    ds_read_b64_tr_b16 v[120:121], v18 offset:40
    ds_read_b64_tr_b16 v[122:123], v19 offset:40
    ds_read_b64_tr_b16 v[124:125], v18 offset:80
    ds_read_b64_tr_b16 v[126:127], v19 offset:80
    ds_read_b64_tr_b16 v[128:129], v18 offset:120
    ds_read_b64_tr_b16 v[130:131], v19 offset:120
    ds_read_b64_tr_b16 v[132:133], v22 offset:32
    ds_read_b64_tr_b16 v[134:135], v23 offset:32
    ds_read_b64_tr_b16 v[136:137], v18 offset:10240
    ds_read_b64_tr_b16 v[138:139], v19 offset:10240
    ds_read_b64_tr_b16 v[140:141], v18 offset:10280
    ds_read_b64_tr_b16 v[142:143], v19 offset:10280
    ds_read_b64_tr_b16 v[196:197], v230 offset:0
    ds_read_b64_tr_b16 v[198:199], v230 offset:640
    ds_read_b64_tr_b16 v[204:205], v231 offset:0
    ds_read_b64_tr_b16 v[200:201], v232 offset:128
    ds_read_b64_tr_b16 v[202:203], v232 offset:768
    ds_read_b64_tr_b16 v[206:207], v233 offset:128
    ds_read_b128 v[152:155], v16 offset:12288
    ds_read_b128 v[156:159], v17 offset:12288
    ds_read_b128 v[160:163], v16 offset:14336
    ds_read_b128 v[164:167], v17 offset:14336
    s_waitcnt lgkmcnt(15)
    v_mfma_f32_16x16x32_bf16 v[32:35], a[0:3], v[116:119], 0
    ds_read_b64_tr_b16 v[144:145], v18 offset:10320
    s_add_u32 m0, s89, 8192
    v_mfma_f32_16x16x32_bf16 v[36:39], a[4:7], v[116:119], 0
    buffer_load_dwordx4 v2, s[8:11], s66 offen offset:0 lds
    s_waitcnt lgkmcnt(15)
    v_mfma_f32_16x16x32_bf16 v[40:43], a[0:3], v[120:123], 0
    ds_read_b64_tr_b16 v[146:147], v19 offset:10320
    v_mfma_f32_16x16x32_bf16 v[44:47], a[4:7], v[120:123], 0
    ds_read_b64_tr_b16 v[116:117], v18 offset:10360
    s_waitcnt lgkmcnt(3)
    v_mfma_f32_16x16x32_bf16 v[48:51], a[0:3], v[124:127], 0
    ds_read_b64_tr_b16 v[118:119], v19 offset:10360
    v_mfma_f32_16x16x32_bf16 v[52:55], a[4:7], v[124:127], 0
    buffer_load_dwordx4 v3, s[8:11], s66 offen offset:1024 lds
    v_permlane16_swap_b32 v204, v206
    v_permlane16_swap_b32 v205, v207
    buffer_store_dwordx4 v[152:155], v220, s[20:23], s54 offen offset:0 sc1
    buffer_store_dwordx4 v[156:159], v220, s[20:23], s54 offen offset:1024 sc1
    buffer_store_dwordx4 v[160:163], v220, s[20:23], s54 offen offset:2048 sc1
    buffer_store_dwordx4 v[164:167], v220, s[20:23], s54 offen offset:3072 sc1
    buffer_store_dwordx4 v[196:199], v234, s[20:23], s37 offen sc1
    buffer_store_dwordx4 v[200:203], v234, s[20:23], s39 offen sc1
    buffer_store_dwordx4 v[204:207], v235, s[20:23], s38 offen offset:2048 sc1
    v_mfma_f32_16x16x32_bf16 v[56:59], a[0:3], v[128:131], 0
    ds_read_b64_tr_b16 v[120:121], v22 offset:10272
    v_mfma_f32_16x16x32_bf16 v[60:63], a[4:7], v[128:131], 0
    ds_read_b64_tr_b16 v[122:123], v23 offset:10272
    v_mfma_f32_16x16x32_bf16 v[64:67], a[0:3], v[132:135], 0
    v_add_u32 v148, s64, v11
    ds_read_b128 v[124:127], v148 offset:0
    v_mfma_f32_16x16x32_bf16 v[68:71], a[4:7], v[132:135], 0
    buffer_load_dwordx4 v4, s[8:11], s66 offen offset:2048 lds
    v_mfma_f32_16x16x32_bf16 v[72:75], a[0:3], v[136:139], 0
    ds_read_b128 a[8:11], v13 offset:0
    ds_read_b128 a[12:15], v15 offset:0
    v_mfma_f32_16x16x32_bf16 v[76:79], a[4:7], v[136:139], 0
    ds_read_b64_tr_b16 v[128:129], v18 offset:5120
    ds_read_b64_tr_b16 v[130:131], v19 offset:5120
    v_mfma_f32_16x16x32_bf16 v[80:83], a[0:3], v[140:143], 0
    ds_read_b64_tr_b16 v[132:133], v18 offset:5160
    ds_read_b64_tr_b16 v[134:135], v19 offset:5160
    v_mfma_f32_16x16x32_bf16 v[84:87], a[4:7], v[140:143], 0
    buffer_load_dwordx4 v5, s[8:11], s66 offen offset:3072 lds
    s_waitcnt lgkmcnt(11)
    v_mfma_f32_16x16x32_bf16 v[88:91], a[0:3], v[144:147], 0
    ds_read_b64_tr_b16 v[136:137], v18 offset:5200
    v_mfma_f32_16x16x32_bf16 v[92:95], a[4:7], v[144:147], 0
    ds_read_b64_tr_b16 v[138:139], v19 offset:5200
    s_waitcnt lgkmcnt(11)
    v_mfma_f32_16x16x32_bf16 v[96:99], a[0:3], v[116:119], 0
    ds_read_b64_tr_b16 v[140:141], v18 offset:5240
    ds_read_b64_tr_b16 v[142:143], v19 offset:5240
    s_add_u32 m0, s90, 40960
    v_mfma_f32_16x16x32_bf16 v[100:103], a[4:7], v[116:119], 0
    buffer_load_dwordx4 v6, s[16:19], s76 offen offset:0 lds
    s_waitcnt lgkmcnt(11)
    v_mfma_f32_16x16x32_bf16 v[104:107], a[0:3], v[120:123], 0
    ds_read_b64_tr_b16 v[144:145], v22 offset:5152
    v_mfma_f32_16x16x32_bf16 v[108:111], a[4:7], v[120:123], 0
    ds_read_b64_tr_b16 v[146:147], v23 offset:5152
    s_waitcnt lgkmcnt(12)
    s_cmp_lg_u32 s46, 0
    s_cbranch_scc1 Lng_1
    v_mfma_f32_16x16x32_bf16 v[112:115], a[0:3], v[124:127], 0
Lng_1:
    ds_read_b64_tr_b16 v[116:117], v18 offset:15360
    ds_read_b64_tr_b16 v[118:119], v19 offset:15360
    s_waitcnt lgkmcnt(10)
    v_mfma_f32_16x16x32_bf16 v[32:35], a[8:11], v[128:131], v[32:35]
    buffer_load_dwordx4 v7, s[16:19], s76 offen offset:1024 lds
    v_mfma_f32_16x16x32_bf16 v[36:39], a[12:15], v[128:131], v[36:39]
    ds_read_b64_tr_b16 v[120:121], v18 offset:15400
    ds_read_b64_tr_b16 v[122:123], v19 offset:15400
    s_waitcnt lgkmcnt(10)
    v_mfma_f32_16x16x32_bf16 v[40:43], a[8:11], v[132:135], v[40:43]
    ds_read_b64_tr_b16 v[124:125], v18 offset:15440
    v_mfma_f32_16x16x32_bf16 v[44:47], a[12:15], v[132:135], v[44:47]
    ds_read_b64_tr_b16 v[126:127], v19 offset:15440
    s_waitcnt lgkmcnt(10)
    v_mfma_f32_16x16x32_bf16 v[48:51], a[8:11], v[136:139], v[48:51]
    buffer_load_dwordx4 v8, s[16:19], s76 offen offset:2048 lds
    v_mfma_f32_16x16x32_bf16 v[52:55], a[12:15], v[136:139], v[52:55]
    ds_read_b64_tr_b16 v[128:129], v18 offset:15480
    ds_read_b64_tr_b16 v[130:131], v19 offset:15480
    s_waitcnt lgkmcnt(10)
    v_mfma_f32_16x16x32_bf16 v[56:59], a[8:11], v[140:143], v[56:59]
    ds_read_b64_tr_b16 v[132:133], v22 offset:15392
    v_mfma_f32_16x16x32_bf16 v[60:63], a[12:15], v[140:143], v[60:63]
    ds_read_b64_tr_b16 v[134:135], v23 offset:15392
    s_waitcnt lgkmcnt(10)
    v_mfma_f32_16x16x32_bf16 v[64:67], a[8:11], v[144:147], v[64:67]
    buffer_load_dwordx4 v9, s[16:19], s76 offen offset:3072 lds
    v_mfma_f32_16x16x32_bf16 v[68:71], a[12:15], v[144:147], v[68:71]
    ds_read_b128 v[136:139], v148 offset:64
    s_waitcnt lgkmcnt(9)
    v_mfma_f32_16x16x32_bf16 v[72:75], a[8:11], v[116:119], v[72:75]
    s_waitcnt vmcnt(15)
    s_barrier
    ds_read_b128 a[16:19], v12 offset:4096
    ds_read_b128 a[20:23], v14 offset:4096
    v_mfma_f32_16x16x32_bf16 v[76:79], a[12:15], v[116:119], v[76:79]
    ds_read_b64_tr_b16 v[140:141], v18 offset:20480
    ds_read_b64_tr_b16 v[142:143], v19 offset:20480
    s_add_u32 m0, s90, 45056
    s_waitcnt lgkmcnt(11)
    v_mfma_f32_16x16x32_bf16 v[80:83], a[8:11], v[120:123], v[80:83]
    buffer_load_dwordx4 v10, s[16:19], s76 offen lds
    v_mfma_f32_16x16x32_bf16 v[84:87], a[12:15], v[120:123], v[84:87]
    ds_read_b64_tr_b16 v[144:145], v18 offset:20520
    ds_read_b64_tr_b16 v[146:147], v19 offset:20520
    s_waitcnt lgkmcnt(11)
    v_mfma_f32_16x16x32_bf16 v[88:91], a[8:11], v[124:127], v[88:91]
    ds_read_b64_tr_b16 v[116:117], v18 offset:20560
    v_mfma_f32_16x16x32_bf16 v[92:95], a[12:15], v[124:127], v[92:95]
    ds_read_b64_tr_b16 v[118:119], v19 offset:20560
    s_add_u32 m0, s90, 61440
    s_waitcnt lgkmcnt(11)
    v_mfma_f32_16x16x32_bf16 v[96:99], a[8:11], v[128:131], v[96:99]
    buffer_load_dwordx4 v6, s[16:19], s77 offen offset:0 lds
    v_mfma_f32_16x16x32_bf16 v[100:103], a[12:15], v[128:131], v[100:103]
    ds_read_b64_tr_b16 v[120:121], v18 offset:20600
    ds_read_b64_tr_b16 v[122:123], v19 offset:20600
    s_waitcnt lgkmcnt(11)
    v_mfma_f32_16x16x32_bf16 v[104:107], a[8:11], v[132:135], v[104:107]
    ds_read_b64_tr_b16 v[124:125], v22 offset:20512
    v_mfma_f32_16x16x32_bf16 v[108:111], a[12:15], v[132:135], v[108:111]
    ds_read_b64_tr_b16 v[126:127], v23 offset:20512
    s_waitcnt lgkmcnt(12)
    s_cmp_lg_u32 s46, 0
    s_cbranch_scc1 Lng_2
    v_mfma_f32_16x16x32_bf16 v[112:115], a[8:11], v[136:139], v[112:115]
Lng_2:
    buffer_load_dwordx4 v7, s[16:19], s77 offen offset:1024 lds
    ds_read_b64_tr_b16 v[128:129], v18 offset:30720
    ds_read_b64_tr_b16 v[130:131], v19 offset:30720
    s_waitcnt lgkmcnt(10)
    v_mfma_f32_16x16x32_bf16 v[32:35], a[16:19], v[140:143], v[32:35]
    ds_read_b64_tr_b16 v[132:133], v18 offset:30760
    v_mfma_f32_16x16x32_bf16 v[36:39], a[20:23], v[140:143], v[36:39]
    ds_read_b64_tr_b16 v[134:135], v19 offset:30760
    s_waitcnt lgkmcnt(10)
    v_mfma_f32_16x16x32_bf16 v[40:43], a[16:19], v[144:147], v[40:43]
    ds_read_b64_tr_b16 v[136:137], v18 offset:30800
    ds_read_b64_tr_b16 v[138:139], v19 offset:30800
    v_mfma_f32_16x16x32_bf16 v[44:47], a[20:23], v[144:147], v[44:47]
    buffer_load_dwordx4 v8, s[16:19], s77 offen offset:2048 lds
    s_waitcnt lgkmcnt(10)
    v_mfma_f32_16x16x32_bf16 v[48:51], a[16:19], v[116:119], v[48:51]
    ds_read_b64_tr_b16 v[140:141], v18 offset:30840
    v_mfma_f32_16x16x32_bf16 v[52:55], a[20:23], v[116:119], v[52:55]
    ds_read_b64_tr_b16 v[142:143], v19 offset:30840
    s_waitcnt lgkmcnt(10)
    v_mfma_f32_16x16x32_bf16 v[56:59], a[16:19], v[120:123], v[56:59]
    ds_read_b64_tr_b16 v[144:145], v22 offset:30752
    ds_read_b64_tr_b16 v[146:147], v23 offset:30752
    v_mfma_f32_16x16x32_bf16 v[60:63], a[20:23], v[120:123], v[60:63]
    buffer_load_dwordx4 v9, s[16:19], s77 offen offset:3072 lds
    s_waitcnt lgkmcnt(10)
    v_mfma_f32_16x16x32_bf16 v[64:67], a[16:19], v[124:127], v[64:67]
    v_add_u32 v148, s65, v11
    ds_read_b128 v[116:119], v148 offset:0
    v_mfma_f32_16x16x32_bf16 v[68:71], a[20:23], v[124:127], v[68:71]
    ds_read_b128 a[24:27], v13 offset:4096
    s_waitcnt lgkmcnt(10)
    v_mfma_f32_16x16x32_bf16 v[72:75], a[16:19], v[128:131], v[72:75]
    ds_read_b128 a[28:31], v15 offset:4096
    ds_read_b64_tr_b16 v[120:121], v18 offset:25600
    ds_read_b64_tr_b16 v[122:123], v19 offset:25600
    s_add_u32 m0, s90, 65536
    v_mfma_f32_16x16x32_bf16 v[76:79], a[20:23], v[128:131], v[76:79]
    buffer_load_dwordx4 v10, s[16:19], s77 offen lds
    s_waitcnt lgkmcnt(11)
    v_mfma_f32_16x16x32_bf16 v[80:83], a[16:19], v[132:135], v[80:83]
    ds_read_b64_tr_b16 v[124:125], v18 offset:25640
    v_mfma_f32_16x16x32_bf16 v[84:87], a[20:23], v[132:135], v[84:87]
    ds_read_b64_tr_b16 v[126:127], v19 offset:25640
    s_waitcnt lgkmcnt(11)
    v_mfma_f32_16x16x32_bf16 v[88:91], a[16:19], v[136:139], v[88:91]
    ds_read_b64_tr_b16 v[128:129], v18 offset:25680
    ds_read_b64_tr_b16 v[130:131], v19 offset:25680
    s_add_u32 m0, s89, 12288
    v_mfma_f32_16x16x32_bf16 v[92:95], a[20:23], v[136:139], v[92:95]
    buffer_load_dwordx4 v2, s[8:11], s67 offen offset:0 lds
    s_waitcnt lgkmcnt(11)
    v_mfma_f32_16x16x32_bf16 v[96:99], a[16:19], v[140:143], v[96:99]
    ds_read_b64_tr_b16 v[132:133], v18 offset:25720
    v_mfma_f32_16x16x32_bf16 v[100:103], a[20:23], v[140:143], v[100:103]
    ds_read_b64_tr_b16 v[134:135], v19 offset:25720
    s_waitcnt lgkmcnt(11)
    v_mfma_f32_16x16x32_bf16 v[104:107], a[16:19], v[144:147], v[104:107]
    ds_read_b64_tr_b16 v[136:137], v22 offset:25632
    ds_read_b64_tr_b16 v[138:139], v23 offset:25632
    v_mfma_f32_16x16x32_bf16 v[108:111], a[20:23], v[144:147], v[108:111]
    buffer_load_dwordx4 v3, s[8:11], s67 offen offset:1024 lds
    s_waitcnt lgkmcnt(12)
    s_cmp_lg_u32 s46, 0
    s_cbranch_scc1 Lng_3
    v_mfma_f32_16x16x32_bf16 v[112:115], a[16:19], v[116:119], v[112:115]
Lng_3:
    ds_read_b64_tr_b16 v[140:141], v18 offset:35840
    ds_read_b64_tr_b16 v[142:143], v19 offset:35840
    s_waitcnt lgkmcnt(10)
    v_mfma_f32_16x16x32_bf16 v[32:35], a[24:27], v[120:123], v[32:35]
    ds_read_b64_tr_b16 v[144:145], v18 offset:35880
    v_mfma_f32_16x16x32_bf16 v[36:39], a[28:31], v[120:123], v[36:39]
    ds_read_b64_tr_b16 v[146:147], v19 offset:35880
    s_waitcnt lgkmcnt(10)
    v_mfma_f32_16x16x32_bf16 v[40:43], a[24:27], v[124:127], v[40:43]
    buffer_load_dwordx4 v4, s[8:11], s67 offen offset:2048 lds
    v_mfma_f32_16x16x32_bf16 v[44:47], a[28:31], v[124:127], v[44:47]
    ds_read_b64_tr_b16 v[116:117], v18 offset:35920
    ds_read_b64_tr_b16 v[118:119], v19 offset:35920
    s_waitcnt lgkmcnt(10)
    v_mfma_f32_16x16x32_bf16 v[48:51], a[24:27], v[128:131], v[48:51]
    ds_read_b64_tr_b16 v[120:121], v18 offset:35960
    v_mfma_f32_16x16x32_bf16 v[52:55], a[28:31], v[128:131], v[52:55]
    ds_read_b64_tr_b16 v[122:123], v19 offset:35960
    s_waitcnt lgkmcnt(10)
    v_mfma_f32_16x16x32_bf16 v[56:59], a[24:27], v[132:135], v[56:59]
    buffer_load_dwordx4 v5, s[8:11], s67 offen offset:3072 lds
    v_mfma_f32_16x16x32_bf16 v[60:63], a[28:31], v[132:135], v[60:63]
    ds_read_b64_tr_b16 v[124:125], v22 offset:35872
    ds_read_b64_tr_b16 v[126:127], v23 offset:35872
    s_waitcnt lgkmcnt(10)
    v_mfma_f32_16x16x32_bf16 v[64:67], a[24:27], v[136:139], v[64:67]
    ds_read_b128 v[128:131], v148 offset:64
    v_mfma_f32_16x16x32_bf16 v[68:71], a[28:31], v[136:139], v[68:71]
    s_waitcnt vmcnt(9)
    s_barrier
    ds_read_b128 a[0:3], v12 offset:8192
    s_add_u32 m0, s89, 0
    s_waitcnt lgkmcnt(10)
    v_mfma_f32_16x16x32_bf16 v[72:75], a[24:27], v[140:143], v[72:75]
    buffer_load_dwordx4 v2, s[8:11], s68 offen offset:0 lds
    v_mfma_f32_16x16x32_bf16 v[76:79], a[28:31], v[140:143], v[76:79]
    ds_read_b128 a[4:7], v14 offset:8192
    ds_read_b64_tr_b16 v[132:133], v20 offset:0
    ds_read_b64_tr_b16 v[134:135], v21 offset:0
    s_waitcnt lgkmcnt(11)
    v_mfma_f32_16x16x32_bf16 v[80:83], a[24:27], v[144:147], v[80:83]
    ds_read_b64_tr_b16 v[136:137], v20 offset:40
    v_mfma_f32_16x16x32_bf16 v[84:87], a[28:31], v[144:147], v[84:87]
    ds_read_b64_tr_b16 v[138:139], v21 offset:40
    s_waitcnt lgkmcnt(11)
    v_mfma_f32_16x16x32_bf16 v[88:91], a[24:27], v[116:119], v[88:91]
    buffer_load_dwordx4 v3, s[8:11], s68 offen offset:1024 lds
    v_mfma_f32_16x16x32_bf16 v[92:95], a[28:31], v[116:119], v[92:95]
    ds_read_b64_tr_b16 v[140:141], v20 offset:80
    ds_read_b64_tr_b16 v[142:143], v21 offset:80
    s_waitcnt lgkmcnt(11)
    v_mfma_f32_16x16x32_bf16 v[96:99], a[24:27], v[120:123], v[96:99]
    ds_read_b64_tr_b16 v[144:145], v20 offset:120
    v_mfma_f32_16x16x32_bf16 v[100:103], a[28:31], v[120:123], v[100:103]
    ds_read_b64_tr_b16 v[146:147], v21 offset:120
    s_waitcnt lgkmcnt(11)
    v_mfma_f32_16x16x32_bf16 v[104:107], a[24:27], v[124:127], v[104:107]
    buffer_load_dwordx4 v4, s[8:11], s68 offen offset:2048 lds
    v_mfma_f32_16x16x32_bf16 v[108:111], a[28:31], v[124:127], v[108:111]
    ds_read_b64_tr_b16 v[116:117], v24 offset:32
    ds_read_b64_tr_b16 v[118:119], v25 offset:32
    s_waitcnt lgkmcnt(12)
    s_cmp_lg_u32 s46, 0
    s_cbranch_scc1 Lng_4
    v_mfma_f32_16x16x32_bf16 v[112:115], a[24:27], v[128:131], v[112:115]
Lng_4:
    ds_read_b64_tr_b16 v[120:121], v20 offset:10240
    ds_read_b64_tr_b16 v[122:123], v21 offset:10240
    s_cmp_lg_u32 s3, 3
    s_cbranch_scc1 LA_nf2
    s_lshl_b32 s7, s5, 4
    s_add_u32 s7, s7, s4
    s_mul_i32 s7, s7, 128
    s_add_u32 s7, s7, 11091968
    v_lshl_add_u32 v150, v1, 2, s7
    v_mov_b32 v151, s6
    s_mov_b32 exec_hi, 0
    buffer_store_dword v151, v150, s[20:23], 0 offen sc1
    s_mov_b64 exec, -1
LA_nf2:
    s_waitcnt lgkmcnt(10)
    v_mfma_f32_16x16x32_bf16 v[32:35], a[0:3], v[132:135], v[32:35]
    ds_read_b64_tr_b16 v[124:125], v20 offset:10280
    ds_read_b64_tr_b16 v[126:127], v21 offset:10280
    v_mfma_f32_16x16x32_bf16 v[36:39], a[4:7], v[132:135], v[36:39]
    buffer_load_dwordx4 v5, s[8:11], s68 offen offset:3072 lds
    s_waitcnt lgkmcnt(10)
    v_mfma_f32_16x16x32_bf16 v[40:43], a[0:3], v[136:139], v[40:43]
    ds_read_b64_tr_b16 v[128:129], v20 offset:10320
    v_mfma_f32_16x16x32_bf16 v[44:47], a[4:7], v[136:139], v[44:47]
    ds_read_b64_tr_b16 v[130:131], v21 offset:10320
    s_waitcnt lgkmcnt(10)
    v_mfma_f32_16x16x32_bf16 v[48:51], a[0:3], v[140:143], v[48:51]
    ds_read_b64_tr_b16 v[132:133], v20 offset:10360
    ds_read_b64_tr_b16 v[134:135], v21 offset:10360
    s_add_u32 m0, s90, 0
    v_mfma_f32_16x16x32_bf16 v[52:55], a[4:7], v[140:143], v[52:55]
    buffer_load_dwordx4 v6, s[16:19], s78 offen offset:0 lds
    s_waitcnt lgkmcnt(10)
    v_mfma_f32_16x16x32_bf16 v[56:59], a[0:3], v[144:147], v[56:59]
    ds_read_b64_tr_b16 v[136:137], v24 offset:10272
    v_mfma_f32_16x16x32_bf16 v[60:63], a[4:7], v[144:147], v[60:63]
    ds_read_b64_tr_b16 v[138:139], v25 offset:10272
    s_waitcnt lgkmcnt(10)
    v_mfma_f32_16x16x32_bf16 v[64:67], a[0:3], v[116:119], v[64:67]
    v_add_u32 v148, s66, v11
    ds_read_b128 v[140:143], v148 offset:0
    v_mfma_f32_16x16x32_bf16 v[68:71], a[4:7], v[116:119], v[68:71]
    buffer_load_dwordx4 v7, s[16:19], s78 offen offset:1024 lds
    s_waitcnt lgkmcnt(9)
    v_mfma_f32_16x16x32_bf16 v[72:75], a[0:3], v[120:123], v[72:75]
    ds_read_b128 a[8:11], v13 offset:8192
    ds_read_b128 a[12:15], v15 offset:8192
    v_mfma_f32_16x16x32_bf16 v[76:79], a[4:7], v[120:123], v[76:79]
    ds_read_b64_tr_b16 v[144:145], v20 offset:5120
    ds_read_b64_tr_b16 v[146:147], v21 offset:5120
    s_waitcnt lgkmcnt(11)
    v_mfma_f32_16x16x32_bf16 v[80:83], a[0:3], v[124:127], v[80:83]
    ds_read_b64_tr_b16 v[116:117], v20 offset:5160
    ds_read_b64_tr_b16 v[118:119], v21 offset:5160
    v_mfma_f32_16x16x32_bf16 v[84:87], a[4:7], v[124:127], v[84:87]
    buffer_load_dwordx4 v8, s[16:19], s78 offen offset:2048 lds
    s_waitcnt lgkmcnt(11)
    v_mfma_f32_16x16x32_bf16 v[88:91], a[0:3], v[128:131], v[88:91]
    ds_read_b64_tr_b16 v[120:121], v20 offset:5200
    v_mfma_f32_16x16x32_bf16 v[92:95], a[4:7], v[128:131], v[92:95]
    ds_read_b64_tr_b16 v[122:123], v21 offset:5200
    s_waitcnt lgkmcnt(11)
    v_mfma_f32_16x16x32_bf16 v[96:99], a[0:3], v[132:135], v[96:99]
    ds_read_b64_tr_b16 v[124:125], v20 offset:5240
    ds_read_b64_tr_b16 v[126:127], v21 offset:5240
    v_mfma_f32_16x16x32_bf16 v[100:103], a[4:7], v[132:135], v[100:103]
    buffer_load_dwordx4 v9, s[16:19], s78 offen offset:3072 lds
    s_waitcnt lgkmcnt(11)
    v_mfma_f32_16x16x32_bf16 v[104:107], a[0:3], v[136:139], v[104:107]
    ds_read_b64_tr_b16 v[128:129], v24 offset:5152
    v_mfma_f32_16x16x32_bf16 v[108:111], a[4:7], v[136:139], v[108:111]
    ds_read_b64_tr_b16 v[130:131], v25 offset:5152
    s_waitcnt lgkmcnt(12)
    s_cmp_lg_u32 s46, 0
    s_cbranch_scc1 Lng_5
    v_mfma_f32_16x16x32_bf16 v[112:115], a[0:3], v[140:143], v[112:115]
Lng_5:
    ds_read_b64_tr_b16 v[132:133], v20 offset:15360
    ds_read_b64_tr_b16 v[134:135], v21 offset:15360
    s_add_u32 m0, s90, 4096
    s_waitcnt lgkmcnt(10)
    v_mfma_f32_16x16x32_bf16 v[32:35], a[8:11], v[144:147], v[32:35]
    buffer_load_dwordx4 v10, s[16:19], s78 offen lds
    v_mfma_f32_16x16x32_bf16 v[36:39], a[12:15], v[144:147], v[36:39]
    ds_read_b64_tr_b16 v[136:137], v20 offset:15400
    ds_read_b64_tr_b16 v[138:139], v21 offset:15400
    s_waitcnt lgkmcnt(10)
    v_mfma_f32_16x16x32_bf16 v[40:43], a[8:11], v[116:119], v[40:43]
    ds_read_b64_tr_b16 v[140:141], v20 offset:15440
    v_mfma_f32_16x16x32_bf16 v[44:47], a[12:15], v[116:119], v[44:47]
    ds_read_b64_tr_b16 v[142:143], v21 offset:15440
    s_waitcnt lgkmcnt(10)
    v_mfma_f32_16x16x32_bf16 v[48:51], a[8:11], v[120:123], v[48:51]
    ds_read_b64_tr_b16 v[144:145], v20 offset:15480
    v_mfma_f32_16x16x32_bf16 v[52:55], a[12:15], v[120:123], v[52:55]
    ds_read_b64_tr_b16 v[146:147], v21 offset:15480
    s_waitcnt lgkmcnt(10)
    v_mfma_f32_16x16x32_bf16 v[56:59], a[8:11], v[124:127], v[56:59]
    ds_read_b64_tr_b16 v[116:117], v24 offset:15392
    v_mfma_f32_16x16x32_bf16 v[60:63], a[12:15], v[124:127], v[60:63]
    ds_read_b64_tr_b16 v[118:119], v25 offset:15392
    s_waitcnt lgkmcnt(10)
    v_mfma_f32_16x16x32_bf16 v[64:67], a[8:11], v[128:131], v[64:67]
    ds_read_b128 v[120:123], v148 offset:64
    v_mfma_f32_16x16x32_bf16 v[68:71], a[12:15], v[128:131], v[68:71]
    s_waitcnt vmcnt(9)
    s_barrier
    ds_read_b128 a[16:19], v12 offset:12288
    s_waitcnt lgkmcnt(10)
    v_mfma_f32_16x16x32_bf16 v[72:75], a[8:11], v[132:135], v[72:75]
    ds_read_b128 a[20:23], v14 offset:12288
    ds_read_b64_tr_b16 v[124:125], v20 offset:20480
    v_mfma_f32_16x16x32_bf16 v[76:79], a[12:15], v[132:135], v[76:79]
    ds_read_b64_tr_b16 v[126:127], v21 offset:20480
    s_add_u32 m0, s89, 4096
    s_waitcnt lgkmcnt(11)
    v_mfma_f32_16x16x32_bf16 v[80:83], a[8:11], v[136:139], v[80:83]
    buffer_load_dwordx4 v2, s[8:11], s69 offen offset:0 lds
    v_mfma_f32_16x16x32_bf16 v[84:87], a[12:15], v[136:139], v[84:87]
    ds_read_b64_tr_b16 v[128:129], v20 offset:20520
    ds_read_b64_tr_b16 v[130:131], v21 offset:20520
    s_waitcnt lgkmcnt(11)
    v_mfma_f32_16x16x32_bf16 v[88:91], a[8:11], v[140:143], v[88:91]
    ds_read_b64_tr_b16 v[132:133], v20 offset:20560
    v_mfma_f32_16x16x32_bf16 v[92:95], a[12:15], v[140:143], v[92:95]
    ds_read_b64_tr_b16 v[134:135], v21 offset:20560
    s_waitcnt lgkmcnt(11)
    v_mfma_f32_16x16x32_bf16 v[96:99], a[8:11], v[144:147], v[96:99]
    buffer_load_dwordx4 v3, s[8:11], s69 offen offset:1024 lds
    v_mfma_f32_16x16x32_bf16 v[100:103], a[12:15], v[144:147], v[100:103]
    ds_read_b64_tr_b16 v[136:137], v20 offset:20600
    ds_read_b64_tr_b16 v[138:139], v21 offset:20600
    s_waitcnt lgkmcnt(11)
    v_mfma_f32_16x16x32_bf16 v[104:107], a[8:11], v[116:119], v[104:107]
    ds_read_b64_tr_b16 v[140:141], v24 offset:20512
    v_mfma_f32_16x16x32_bf16 v[108:111], a[12:15], v[116:119], v[108:111]
    ds_read_b64_tr_b16 v[142:143], v25 offset:20512
    s_waitcnt lgkmcnt(12)
    s_cmp_lg_u32 s46, 0
    s_cbranch_scc1 Lng_6
    v_mfma_f32_16x16x32_bf16 v[112:115], a[8:11], v[120:123], v[112:115]
Lng_6:
    buffer_load_dwordx4 v4, s[8:11], s69 offen offset:2048 lds
    ds_read_b64_tr_b16 v[144:145], v20 offset:30720
    ds_read_b64_tr_b16 v[146:147], v21 offset:30720
    s_waitcnt lgkmcnt(10)
    v_mfma_f32_16x16x32_bf16 v[32:35], a[16:19], v[124:127], v[32:35]
    ds_read_b64_tr_b16 v[116:117], v20 offset:30760
    v_mfma_f32_16x16x32_bf16 v[36:39], a[20:23], v[124:127], v[36:39]
    ds_read_b64_tr_b16 v[118:119], v21 offset:30760
    s_waitcnt lgkmcnt(10)
    v_mfma_f32_16x16x32_bf16 v[40:43], a[16:19], v[128:131], v[40:43]
    ds_read_b64_tr_b16 v[120:121], v20 offset:30800
    ds_read_b64_tr_b16 v[122:123], v21 offset:30800
    v_mfma_f32_16x16x32_bf16 v[44:47], a[20:23], v[128:131], v[44:47]
    buffer_load_dwordx4 v5, s[8:11], s69 offen offset:3072 lds
    s_waitcnt lgkmcnt(10)
    v_mfma_f32_16x16x32_bf16 v[48:51], a[16:19], v[132:135], v[48:51]
    ds_read_b64_tr_b16 v[124:125], v20 offset:30840
    v_mfma_f32_16x16x32_bf16 v[52:55], a[20:23], v[132:135], v[52:55]
    ds_read_b64_tr_b16 v[126:127], v21 offset:30840
    s_waitcnt lgkmcnt(10)
    v_mfma_f32_16x16x32_bf16 v[56:59], a[16:19], v[136:139], v[56:59]
    ds_read_b64_tr_b16 v[128:129], v24 offset:30752
    ds_read_b64_tr_b16 v[130:131], v25 offset:30752
    s_add_u32 m0, s90, 20480
    v_mfma_f32_16x16x32_bf16 v[60:63], a[20:23], v[136:139], v[60:63]
    buffer_load_dwordx4 v6, s[16:19], s79 offen offset:0 lds
    s_waitcnt lgkmcnt(10)
    v_mfma_f32_16x16x32_bf16 v[64:67], a[16:19], v[140:143], v[64:67]
    v_add_u32 v148, s67, v11
    ds_read_b128 v[132:135], v148 offset:0
    v_mfma_f32_16x16x32_bf16 v[68:71], a[20:23], v[140:143], v[68:71]
    ds_read_b128 a[24:27], v13 offset:12288
    s_waitcnt lgkmcnt(10)
    v_mfma_f32_16x16x32_bf16 v[72:75], a[16:19], v[144:147], v[72:75]
    ds_read_b128 a[28:31], v15 offset:12288
    ds_read_b64_tr_b16 v[136:137], v20 offset:25600
    ds_read_b64_tr_b16 v[138:139], v21 offset:25600
    v_mfma_f32_16x16x32_bf16 v[76:79], a[20:23], v[144:147], v[76:79]
    buffer_load_dwordx4 v7, s[16:19], s79 offen offset:1024 lds
    s_waitcnt lgkmcnt(11)
    v_mfma_f32_16x16x32_bf16 v[80:83], a[16:19], v[116:119], v[80:83]
    ds_read_b64_tr_b16 v[140:141], v20 offset:25640
    v_mfma_f32_16x16x32_bf16 v[84:87], a[20:23], v[116:119], v[84:87]
    ds_read_b64_tr_b16 v[142:143], v21 offset:25640
    s_waitcnt lgkmcnt(11)
    v_mfma_f32_16x16x32_bf16 v[88:91], a[16:19], v[120:123], v[88:91]
    ds_read_b64_tr_b16 v[144:145], v20 offset:25680
    ds_read_b64_tr_b16 v[146:147], v21 offset:25680
    v_mfma_f32_16x16x32_bf16 v[92:95], a[20:23], v[120:123], v[92:95]
    buffer_load_dwordx4 v8, s[16:19], s79 offen offset:2048 lds
    s_waitcnt lgkmcnt(11)
    v_mfma_f32_16x16x32_bf16 v[96:99], a[16:19], v[124:127], v[96:99]
    ds_read_b64_tr_b16 v[116:117], v20 offset:25720
    v_mfma_f32_16x16x32_bf16 v[100:103], a[20:23], v[124:127], v[100:103]
    ds_read_b64_tr_b16 v[118:119], v21 offset:25720
    s_waitcnt lgkmcnt(11)
    v_mfma_f32_16x16x32_bf16 v[104:107], a[16:19], v[128:131], v[104:107]
    ds_read_b64_tr_b16 v[120:121], v24 offset:25632
    ds_read_b64_tr_b16 v[122:123], v25 offset:25632
    v_mfma_f32_16x16x32_bf16 v[108:111], a[20:23], v[128:131], v[108:111]
    buffer_load_dwordx4 v9, s[16:19], s79 offen offset:3072 lds
    s_waitcnt lgkmcnt(12)
    s_cmp_lg_u32 s46, 0
    s_cbranch_scc1 Lng_7
    v_mfma_f32_16x16x32_bf16 v[112:115], a[16:19], v[132:135], v[112:115]
Lng_7:
    ds_read_b64_tr_b16 v[124:125], v20 offset:35840
    ds_read_b64_tr_b16 v[126:127], v21 offset:35840
    s_waitcnt lgkmcnt(10)
    v_mfma_f32_16x16x32_bf16 v[32:35], a[24:27], v[136:139], v[32:35]
    ds_read_b64_tr_b16 v[128:129], v20 offset:35880
    v_mfma_f32_16x16x32_bf16 v[36:39], a[28:31], v[136:139], v[36:39]
    ds_read_b64_tr_b16 v[130:131], v21 offset:35880
    s_add_u32 m0, s90, 24576
    s_waitcnt lgkmcnt(10)
    v_mfma_f32_16x16x32_bf16 v[40:43], a[24:27], v[140:143], v[40:43]
    buffer_load_dwordx4 v10, s[16:19], s79 offen lds
    v_mfma_f32_16x16x32_bf16 v[44:47], a[28:31], v[140:143], v[44:47]
    ds_read_b64_tr_b16 v[132:133], v20 offset:35920
    ds_read_b64_tr_b16 v[134:135], v21 offset:35920
    s_waitcnt lgkmcnt(10)
    v_mfma_f32_16x16x32_bf16 v[48:51], a[24:27], v[144:147], v[48:51]
    ds_read_b64_tr_b16 v[136:137], v20 offset:35960
    v_mfma_f32_16x16x32_bf16 v[52:55], a[28:31], v[144:147], v[52:55]
    ds_read_b64_tr_b16 v[138:139], v21 offset:35960
    s_waitcnt lgkmcnt(10)
    v_mfma_f32_16x16x32_bf16 v[56:59], a[24:27], v[116:119], v[56:59]
    ds_read_b64_tr_b16 v[140:141], v24 offset:35872
    v_mfma_f32_16x16x32_bf16 v[60:63], a[28:31], v[116:119], v[60:63]
    ds_read_b64_tr_b16 v[142:143], v25 offset:35872
    s_waitcnt lgkmcnt(10)
    v_mfma_f32_16x16x32_bf16 v[64:67], a[24:27], v[120:123], v[64:67]
    ds_read_b128 v[144:147], v148 offset:64
    v_mfma_f32_16x16x32_bf16 v[68:71], a[28:31], v[120:123], v[68:71]
    s_waitcnt vmcnt(9)
    s_barrier
    ds_read_b128 a[0:3], v12 offset:0
    s_add_u32 m0, s89, 8192
    s_waitcnt lgkmcnt(10)
    v_mfma_f32_16x16x32_bf16 v[72:75], a[24:27], v[124:127], v[72:75]
    buffer_load_dwordx4 v2, s[8:11], s70 offen offset:0 lds
    v_mfma_f32_16x16x32_bf16 v[76:79], a[28:31], v[124:127], v[76:79]
    ds_read_b128 a[4:7], v14 offset:0
    ds_read_b64_tr_b16 v[116:117], v18 offset:0
    ds_read_b64_tr_b16 v[118:119], v19 offset:0
    s_waitcnt lgkmcnt(11)
    v_mfma_f32_16x16x32_bf16 v[80:83], a[24:27], v[128:131], v[80:83]
    ds_read_b64_tr_b16 v[120:121], v18 offset:40
    v_mfma_f32_16x16x32_bf16 v[84:87], a[28:31], v[128:131], v[84:87]
    ds_read_b64_tr_b16 v[122:123], v19 offset:40
    s_waitcnt lgkmcnt(11)
    v_mfma_f32_16x16x32_bf16 v[88:91], a[24:27], v[132:135], v[88:91]
    buffer_load_dwordx4 v3, s[8:11], s70 offen offset:1024 lds
    v_mfma_f32_16x16x32_bf16 v[92:95], a[28:31], v[132:135], v[92:95]
    ds_read_b64_tr_b16 v[124:125], v18 offset:80
    ds_read_b64_tr_b16 v[126:127], v19 offset:80
    s_waitcnt lgkmcnt(11)
    v_mfma_f32_16x16x32_bf16 v[96:99], a[24:27], v[136:139], v[96:99]
    ds_read_b64_tr_b16 v[128:129], v18 offset:120
    v_mfma_f32_16x16x32_bf16 v[100:103], a[28:31], v[136:139], v[100:103]
    ds_read_b64_tr_b16 v[130:131], v19 offset:120
    s_waitcnt lgkmcnt(11)
    v_mfma_f32_16x16x32_bf16 v[104:107], a[24:27], v[140:143], v[104:107]
    buffer_load_dwordx4 v4, s[8:11], s70 offen offset:2048 lds
    v_mfma_f32_16x16x32_bf16 v[108:111], a[28:31], v[140:143], v[108:111]
    ds_read_b64_tr_b16 v[132:133], v22 offset:32
    ds_read_b64_tr_b16 v[134:135], v23 offset:32
    s_waitcnt lgkmcnt(12)
    s_cmp_lg_u32 s46, 0
    s_cbranch_scc1 Lng_8
    v_mfma_f32_16x16x32_bf16 v[112:115], a[24:27], v[144:147], v[112:115]
Lng_8:
    ds_read_b64_tr_b16 v[136:137], v18 offset:10240
    ds_read_b64_tr_b16 v[138:139], v19 offset:10240
    s_waitcnt lgkmcnt(10)
    v_mfma_f32_16x16x32_bf16 v[32:35], a[0:3], v[116:119], v[32:35]
    ds_read_b64_tr_b16 v[140:141], v18 offset:10280
    ds_read_b64_tr_b16 v[142:143], v19 offset:10280
    v_mfma_f32_16x16x32_bf16 v[36:39], a[4:7], v[116:119], v[36:39]
    buffer_load_dwordx4 v5, s[8:11], s70 offen offset:3072 lds
    s_waitcnt lgkmcnt(10)
    v_mfma_f32_16x16x32_bf16 v[40:43], a[0:3], v[120:123], v[40:43]
    ds_read_b64_tr_b16 v[144:145], v18 offset:10320
    v_mfma_f32_16x16x32_bf16 v[44:47], a[4:7], v[120:123], v[44:47]
    ds_read_b64_tr_b16 v[146:147], v19 offset:10320
    s_waitcnt lgkmcnt(10)
    v_mfma_f32_16x16x32_bf16 v[48:51], a[0:3], v[124:127], v[48:51]
    ds_read_b64_tr_b16 v[116:117], v18 offset:10360
    ds_read_b64_tr_b16 v[118:119], v19 offset:10360
    s_add_u32 m0, s90, 40960
    v_mfma_f32_16x16x32_bf16 v[52:55], a[4:7], v[124:127], v[52:55]
    buffer_load_dwordx4 v6, s[16:19], s80 offen offset:0 lds
    s_waitcnt lgkmcnt(10)
    v_mfma_f32_16x16x32_bf16 v[56:59], a[0:3], v[128:131], v[56:59]
    ds_read_b64_tr_b16 v[120:121], v22 offset:10272
    v_mfma_f32_16x16x32_bf16 v[60:63], a[4:7], v[128:131], v[60:63]
    ds_read_b64_tr_b16 v[122:123], v23 offset:10272
    s_waitcnt lgkmcnt(10)
    v_mfma_f32_16x16x32_bf16 v[64:67], a[0:3], v[132:135], v[64:67]
    v_add_u32 v148, s68, v11
    ds_read_b128 v[124:127], v148 offset:0
    v_mfma_f32_16x16x32_bf16 v[68:71], a[4:7], v[132:135], v[68:71]
    buffer_load_dwordx4 v7, s[16:19], s80 offen offset:1024 lds
    s_waitcnt lgkmcnt(9)
    v_mfma_f32_16x16x32_bf16 v[72:75], a[0:3], v[136:139], v[72:75]
    ds_read_b128 a[8:11], v13 offset:0
    ds_read_b128 a[12:15], v15 offset:0
    v_mfma_f32_16x16x32_bf16 v[76:79], a[4:7], v[136:139], v[76:79]
    ds_read_b64_tr_b16 v[128:129], v18 offset:5120
    ds_read_b64_tr_b16 v[130:131], v19 offset:5120
    s_waitcnt lgkmcnt(11)
    v_mfma_f32_16x16x32_bf16 v[80:83], a[0:3], v[140:143], v[80:83]
    ds_read_b64_tr_b16 v[132:133], v18 offset:5160
    ds_read_b64_tr_b16 v[134:135], v19 offset:5160
    v_mfma_f32_16x16x32_bf16 v[84:87], a[4:7], v[140:143], v[84:87]
    buffer_load_dwordx4 v8, s[16:19], s80 offen offset:2048 lds
    s_waitcnt lgkmcnt(11)
    v_mfma_f32_16x16x32_bf16 v[88:91], a[0:3], v[144:147], v[88:91]
    ds_read_b64_tr_b16 v[136:137], v18 offset:5200
    v_mfma_f32_16x16x32_bf16 v[92:95], a[4:7], v[144:147], v[92:95]
    ds_read_b64_tr_b16 v[138:139], v19 offset:5200
    s_waitcnt lgkmcnt(11)
    v_mfma_f32_16x16x32_bf16 v[96:99], a[0:3], v[116:119], v[96:99]
    ds_read_b64_tr_b16 v[140:141], v18 offset:5240
    ds_read_b64_tr_b16 v[142:143], v19 offset:5240
    v_mfma_f32_16x16x32_bf16 v[100:103], a[4:7], v[116:119], v[100:103]
    buffer_load_dwordx4 v9, s[16:19], s80 offen offset:3072 lds
    s_waitcnt lgkmcnt(11)
    v_mfma_f32_16x16x32_bf16 v[104:107], a[0:3], v[120:123], v[104:107]
    ds_read_b64_tr_b16 v[144:145], v22 offset:5152
    v_mfma_f32_16x16x32_bf16 v[108:111], a[4:7], v[120:123], v[108:111]
    ds_read_b64_tr_b16 v[146:147], v23 offset:5152
    s_waitcnt lgkmcnt(12)
    s_cmp_lg_u32 s46, 0
    s_cbranch_scc1 Lng_9
    v_mfma_f32_16x16x32_bf16 v[112:115], a[0:3], v[124:127], v[112:115]
Lng_9:
    ds_read_b64_tr_b16 v[116:117], v18 offset:15360
    ds_read_b64_tr_b16 v[118:119], v19 offset:15360
    s_add_u32 m0, s90, 45056
    s_waitcnt lgkmcnt(10)
    v_mfma_f32_16x16x32_bf16 v[32:35], a[8:11], v[128:131], v[32:35]
    buffer_load_dwordx4 v10, s[16:19], s80 offen lds
    v_mfma_f32_16x16x32_bf16 v[36:39], a[12:15], v[128:131], v[36:39]
    ds_read_b64_tr_b16 v[120:121], v18 offset:15400
    ds_read_b64_tr_b16 v[122:123], v19 offset:15400
    s_waitcnt lgkmcnt(10)
    v_mfma_f32_16x16x32_bf16 v[40:43], a[8:11], v[132:135], v[40:43]
    ds_read_b64_tr_b16 v[124:125], v18 offset:15440
    v_mfma_f32_16x16x32_bf16 v[44:47], a[12:15], v[132:135], v[44:47]
    ds_read_b64_tr_b16 v[126:127], v19 offset:15440
    s_waitcnt lgkmcnt(10)
    v_mfma_f32_16x16x32_bf16 v[48:51], a[8:11], v[136:139], v[48:51]
    ds_read_b64_tr_b16 v[128:129], v18 offset:15480
    v_mfma_f32_16x16x32_bf16 v[52:55], a[12:15], v[136:139], v[52:55]
    ds_read_b64_tr_b16 v[130:131], v19 offset:15480
    s_waitcnt lgkmcnt(10)
    v_mfma_f32_16x16x32_bf16 v[56:59], a[8:11], v[140:143], v[56:59]
    ds_read_b64_tr_b16 v[132:133], v22 offset:15392
    v_mfma_f32_16x16x32_bf16 v[60:63], a[12:15], v[140:143], v[60:63]
    ds_read_b64_tr_b16 v[134:135], v23 offset:15392
    s_waitcnt lgkmcnt(10)
    v_mfma_f32_16x16x32_bf16 v[64:67], a[8:11], v[144:147], v[64:67]
    ds_read_b128 v[136:139], v148 offset:64
    v_mfma_f32_16x16x32_bf16 v[68:71], a[12:15], v[144:147], v[68:71]
    s_waitcnt vmcnt(9)
    s_barrier
    ds_read_b128 a[16:19], v12 offset:4096
    s_waitcnt lgkmcnt(10)
    v_mfma_f32_16x16x32_bf16 v[72:75], a[8:11], v[116:119], v[72:75]
    ds_read_b128 a[20:23], v14 offset:4096
    ds_read_b64_tr_b16 v[140:141], v18 offset:20480
    v_mfma_f32_16x16x32_bf16 v[76:79], a[12:15], v[116:119], v[76:79]
    ds_read_b64_tr_b16 v[142:143], v19 offset:20480
    s_add_u32 m0, s89, 12288
    s_waitcnt lgkmcnt(11)
    v_mfma_f32_16x16x32_bf16 v[80:83], a[8:11], v[120:123], v[80:83]
    buffer_load_dwordx4 v2, s[8:11], s71 offen offset:0 lds
    v_mfma_f32_16x16x32_bf16 v[84:87], a[12:15], v[120:123], v[84:87]
    ds_read_b64_tr_b16 v[144:145], v18 offset:20520
    ds_read_b64_tr_b16 v[146:147], v19 offset:20520
    s_waitcnt lgkmcnt(11)
    v_mfma_f32_16x16x32_bf16 v[88:91], a[8:11], v[124:127], v[88:91]
    ds_read_b64_tr_b16 v[116:117], v18 offset:20560
    v_mfma_f32_16x16x32_bf16 v[92:95], a[12:15], v[124:127], v[92:95]
    ds_read_b64_tr_b16 v[118:119], v19 offset:20560
    s_waitcnt lgkmcnt(11)
    v_mfma_f32_16x16x32_bf16 v[96:99], a[8:11], v[128:131], v[96:99]
    buffer_load_dwordx4 v3, s[8:11], s71 offen offset:1024 lds
    v_mfma_f32_16x16x32_bf16 v[100:103], a[12:15], v[128:131], v[100:103]
    ds_read_b64_tr_b16 v[120:121], v18 offset:20600
    ds_read_b64_tr_b16 v[122:123], v19 offset:20600
    s_waitcnt lgkmcnt(11)
    v_mfma_f32_16x16x32_bf16 v[104:107], a[8:11], v[132:135], v[104:107]
    ds_read_b64_tr_b16 v[124:125], v22 offset:20512
    v_mfma_f32_16x16x32_bf16 v[108:111], a[12:15], v[132:135], v[108:111]
    ds_read_b64_tr_b16 v[126:127], v23 offset:20512
    s_waitcnt lgkmcnt(12)
    s_cmp_lg_u32 s46, 0
    s_cbranch_scc1 Lng_10
    v_mfma_f32_16x16x32_bf16 v[112:115], a[8:11], v[136:139], v[112:115]
Lng_10:
    buffer_load_dwordx4 v4, s[8:11], s71 offen offset:2048 lds
    ds_read_b64_tr_b16 v[128:129], v18 offset:30720
    ds_read_b64_tr_b16 v[130:131], v19 offset:30720
    s_waitcnt lgkmcnt(10)
    v_mfma_f32_16x16x32_bf16 v[32:35], a[16:19], v[140:143], v[32:35]
    ds_read_b64_tr_b16 v[132:133], v18 offset:30760
    v_mfma_f32_16x16x32_bf16 v[36:39], a[20:23], v[140:143], v[36:39]
    ds_read_b64_tr_b16 v[134:135], v19 offset:30760
    s_waitcnt lgkmcnt(10)
    v_mfma_f32_16x16x32_bf16 v[40:43], a[16:19], v[144:147], v[40:43]
    ds_read_b64_tr_b16 v[136:137], v18 offset:30800
    ds_read_b64_tr_b16 v[138:139], v19 offset:30800
    v_mfma_f32_16x16x32_bf16 v[44:47], a[20:23], v[144:147], v[44:47]
    buffer_load_dwordx4 v5, s[8:11], s71 offen offset:3072 lds
    s_waitcnt lgkmcnt(10)
    v_mfma_f32_16x16x32_bf16 v[48:51], a[16:19], v[116:119], v[48:51]
    ds_read_b64_tr_b16 v[140:141], v18 offset:30840
    v_mfma_f32_16x16x32_bf16 v[52:55], a[20:23], v[116:119], v[52:55]
    ds_read_b64_tr_b16 v[142:143], v19 offset:30840
    s_waitcnt lgkmcnt(10)
    v_mfma_f32_16x16x32_bf16 v[56:59], a[16:19], v[120:123], v[56:59]
    ds_read_b64_tr_b16 v[144:145], v22 offset:30752
    ds_read_b64_tr_b16 v[146:147], v23 offset:30752
    s_add_u32 m0, s90, 61440
    v_mfma_f32_16x16x32_bf16 v[60:63], a[20:23], v[120:123], v[60:63]
    buffer_load_dwordx4 v6, s[16:19], s81 offen offset:0 lds
    s_waitcnt lgkmcnt(10)
    v_mfma_f32_16x16x32_bf16 v[64:67], a[16:19], v[124:127], v[64:67]
    v_add_u32 v148, s69, v11
    ds_read_b128 v[116:119], v148 offset:0
    v_mfma_f32_16x16x32_bf16 v[68:71], a[20:23], v[124:127], v[68:71]
    ds_read_b128 a[24:27], v13 offset:4096
    s_waitcnt lgkmcnt(10)
    v_mfma_f32_16x16x32_bf16 v[72:75], a[16:19], v[128:131], v[72:75]
    ds_read_b128 a[28:31], v15 offset:4096
    ds_read_b64_tr_b16 v[120:121], v18 offset:25600
    ds_read_b64_tr_b16 v[122:123], v19 offset:25600
    v_mfma_f32_16x16x32_bf16 v[76:79], a[20:23], v[128:131], v[76:79]
    buffer_load_dwordx4 v7, s[16:19], s81 offen offset:1024 lds
    s_waitcnt lgkmcnt(11)
    v_mfma_f32_16x16x32_bf16 v[80:83], a[16:19], v[132:135], v[80:83]
    ds_read_b64_tr_b16 v[124:125], v18 offset:25640
    v_mfma_f32_16x16x32_bf16 v[84:87], a[20:23], v[132:135], v[84:87]
    ds_read_b64_tr_b16 v[126:127], v19 offset:25640
    s_waitcnt lgkmcnt(11)
    v_mfma_f32_16x16x32_bf16 v[88:91], a[16:19], v[136:139], v[88:91]
    ds_read_b64_tr_b16 v[128:129], v18 offset:25680
    ds_read_b64_tr_b16 v[130:131], v19 offset:25680
    v_mfma_f32_16x16x32_bf16 v[92:95], a[20:23], v[136:139], v[92:95]
    buffer_load_dwordx4 v8, s[16:19], s81 offen offset:2048 lds
    s_waitcnt lgkmcnt(11)
    v_mfma_f32_16x16x32_bf16 v[96:99], a[16:19], v[140:143], v[96:99]
    ds_read_b64_tr_b16 v[132:133], v18 offset:25720
    v_mfma_f32_16x16x32_bf16 v[100:103], a[20:23], v[140:143], v[100:103]
    ds_read_b64_tr_b16 v[134:135], v19 offset:25720
    s_waitcnt lgkmcnt(11)
    v_mfma_f32_16x16x32_bf16 v[104:107], a[16:19], v[144:147], v[104:107]
    ds_read_b64_tr_b16 v[136:137], v22 offset:25632
    ds_read_b64_tr_b16 v[138:139], v23 offset:25632
    v_mfma_f32_16x16x32_bf16 v[108:111], a[20:23], v[144:147], v[108:111]
    buffer_load_dwordx4 v9, s[16:19], s81 offen offset:3072 lds
    s_waitcnt lgkmcnt(12)
    s_cmp_lg_u32 s46, 0
    s_cbranch_scc1 Lng_11
    v_mfma_f32_16x16x32_bf16 v[112:115], a[16:19], v[116:119], v[112:115]
Lng_11:
    ds_read_b64_tr_b16 v[140:141], v18 offset:35840
    ds_read_b64_tr_b16 v[142:143], v19 offset:35840
    s_waitcnt lgkmcnt(10)
    v_mfma_f32_16x16x32_bf16 v[32:35], a[24:27], v[120:123], v[32:35]
    ds_read_b64_tr_b16 v[144:145], v18 offset:35880
    v_mfma_f32_16x16x32_bf16 v[36:39], a[28:31], v[120:123], v[36:39]
    ds_read_b64_tr_b16 v[146:147], v19 offset:35880
    s_add_u32 m0, s90, 65536
    s_waitcnt lgkmcnt(10)
    v_mfma_f32_16x16x32_bf16 v[40:43], a[24:27], v[124:127], v[40:43]
    buffer_load_dwordx4 v10, s[16:19], s81 offen lds
    v_mfma_f32_16x16x32_bf16 v[44:47], a[28:31], v[124:127], v[44:47]
    ds_read_b64_tr_b16 v[116:117], v18 offset:35920
    ds_read_b64_tr_b16 v[118:119], v19 offset:35920
    s_waitcnt lgkmcnt(10)
    v_mfma_f32_16x16x32_bf16 v[48:51], a[24:27], v[128:131], v[48:51]
    ds_read_b64_tr_b16 v[120:121], v18 offset:35960
    v_mfma_f32_16x16x32_bf16 v[52:55], a[28:31], v[128:131], v[52:55]
    ds_read_b64_tr_b16 v[122:123], v19 offset:35960
    s_waitcnt lgkmcnt(10)
    v_mfma_f32_16x16x32_bf16 v[56:59], a[24:27], v[132:135], v[56:59]
    ds_read_b64_tr_b16 v[124:125], v22 offset:35872
    v_mfma_f32_16x16x32_bf16 v[60:63], a[28:31], v[132:135], v[60:63]
    ds_read_b64_tr_b16 v[126:127], v23 offset:35872
    s_waitcnt lgkmcnt(10)
    v_mfma_f32_16x16x32_bf16 v[64:67], a[24:27], v[136:139], v[64:67]
    ds_read_b128 v[128:131], v148 offset:64
    v_mfma_f32_16x16x32_bf16 v[68:71], a[28:31], v[136:139], v[68:71]
    s_waitcnt vmcnt(9)
    s_barrier
    ds_read_b128 a[0:3], v12 offset:8192
    s_add_u32 m0, s89, 0
    s_waitcnt lgkmcnt(10)
    v_mfma_f32_16x16x32_bf16 v[72:75], a[24:27], v[140:143], v[72:75]
    buffer_load_dwordx4 v2, s[8:11], s72 offen offset:0 lds
    v_mfma_f32_16x16x32_bf16 v[76:79], a[28:31], v[140:143], v[76:79]
    ds_read_b128 a[4:7], v14 offset:8192
    ds_read_b64_tr_b16 v[132:133], v20 offset:0
    ds_read_b64_tr_b16 v[134:135], v21 offset:0
    s_waitcnt lgkmcnt(11)
    v_mfma_f32_16x16x32_bf16 v[80:83], a[24:27], v[144:147], v[80:83]
    ds_read_b64_tr_b16 v[136:137], v20 offset:40
    v_mfma_f32_16x16x32_bf16 v[84:87], a[28:31], v[144:147], v[84:87]
    ds_read_b64_tr_b16 v[138:139], v21 offset:40
    s_waitcnt lgkmcnt(11)
    v_mfma_f32_16x16x32_bf16 v[88:91], a[24:27], v[116:119], v[88:91]
    buffer_load_dwordx4 v3, s[8:11], s72 offen offset:1024 lds
    v_mfma_f32_16x16x32_bf16 v[92:95], a[28:31], v[116:119], v[92:95]
    ds_read_b64_tr_b16 v[140:141], v20 offset:80
    ds_read_b64_tr_b16 v[142:143], v21 offset:80
    s_waitcnt lgkmcnt(11)
    v_mfma_f32_16x16x32_bf16 v[96:99], a[24:27], v[120:123], v[96:99]
    ds_read_b64_tr_b16 v[144:145], v20 offset:120
    v_mfma_f32_16x16x32_bf16 v[100:103], a[28:31], v[120:123], v[100:103]
    ds_read_b64_tr_b16 v[146:147], v21 offset:120
    s_waitcnt lgkmcnt(11)
    v_mfma_f32_16x16x32_bf16 v[104:107], a[24:27], v[124:127], v[104:107]
    buffer_load_dwordx4 v4, s[8:11], s72 offen offset:2048 lds
    v_mfma_f32_16x16x32_bf16 v[108:111], a[28:31], v[124:127], v[108:111]
    ds_read_b64_tr_b16 v[116:117], v24 offset:32
    ds_read_b64_tr_b16 v[118:119], v25 offset:32
    s_waitcnt lgkmcnt(12)
    s_cmp_lg_u32 s46, 0
    s_cbranch_scc1 Lng_12
    v_mfma_f32_16x16x32_bf16 v[112:115], a[24:27], v[128:131], v[112:115]
Lng_12:
    ds_read_b64_tr_b16 v[120:121], v20 offset:10240
    ds_read_b64_tr_b16 v[122:123], v21 offset:10240
    s_waitcnt lgkmcnt(10)
    v_mfma_f32_16x16x32_bf16 v[32:35], a[0:3], v[132:135], v[32:35]
    ds_read_b64_tr_b16 v[124:125], v20 offset:10280
    ds_read_b64_tr_b16 v[126:127], v21 offset:10280
    v_mfma_f32_16x16x32_bf16 v[36:39], a[4:7], v[132:135], v[36:39]
    buffer_load_dwordx4 v5, s[8:11], s72 offen offset:3072 lds
    s_waitcnt lgkmcnt(10)
    v_mfma_f32_16x16x32_bf16 v[40:43], a[0:3], v[136:139], v[40:43]
    ds_read_b64_tr_b16 v[128:129], v20 offset:10320
    v_mfma_f32_16x16x32_bf16 v[44:47], a[4:7], v[136:139], v[44:47]
    ds_read_b64_tr_b16 v[130:131], v21 offset:10320
    s_waitcnt lgkmcnt(10)
    v_mfma_f32_16x16x32_bf16 v[48:51], a[0:3], v[140:143], v[48:51]
    ds_read_b64_tr_b16 v[132:133], v20 offset:10360
    ds_read_b64_tr_b16 v[134:135], v21 offset:10360
    s_add_u32 m0, s90, 0
    v_mfma_f32_16x16x32_bf16 v[52:55], a[4:7], v[140:143], v[52:55]
    buffer_load_dwordx4 v6, s[16:19], s82 offen offset:0 lds
    s_waitcnt lgkmcnt(10)
    v_mfma_f32_16x16x32_bf16 v[56:59], a[0:3], v[144:147], v[56:59]
    ds_read_b64_tr_b16 v[136:137], v24 offset:10272
    v_mfma_f32_16x16x32_bf16 v[60:63], a[4:7], v[144:147], v[60:63]
    ds_read_b64_tr_b16 v[138:139], v25 offset:10272
    s_waitcnt lgkmcnt(10)
    v_mfma_f32_16x16x32_bf16 v[64:67], a[0:3], v[116:119], v[64:67]
    v_add_u32 v148, s70, v11
    ds_read_b128 v[140:143], v148 offset:0
    v_mfma_f32_16x16x32_bf16 v[68:71], a[4:7], v[116:119], v[68:71]
    buffer_load_dwordx4 v7, s[16:19], s82 offen offset:1024 lds
    s_waitcnt lgkmcnt(9)
    v_mfma_f32_16x16x32_bf16 v[72:75], a[0:3], v[120:123], v[72:75]
    ds_read_b128 a[8:11], v13 offset:8192
    ds_read_b128 a[12:15], v15 offset:8192
    v_mfma_f32_16x16x32_bf16 v[76:79], a[4:7], v[120:123], v[76:79]
    ds_read_b64_tr_b16 v[144:145], v20 offset:5120
    ds_read_b64_tr_b16 v[146:147], v21 offset:5120
    s_waitcnt lgkmcnt(11)
    v_mfma_f32_16x16x32_bf16 v[80:83], a[0:3], v[124:127], v[80:83]
    ds_read_b64_tr_b16 v[116:117], v20 offset:5160
    ds_read_b64_tr_b16 v[118:119], v21 offset:5160
    v_mfma_f32_16x16x32_bf16 v[84:87], a[4:7], v[124:127], v[84:87]
    buffer_load_dwordx4 v8, s[16:19], s82 offen offset:2048 lds
    s_waitcnt lgkmcnt(11)
    v_mfma_f32_16x16x32_bf16 v[88:91], a[0:3], v[128:131], v[88:91]
    ds_read_b64_tr_b16 v[120:121], v20 offset:5200
    v_mfma_f32_16x16x32_bf16 v[92:95], a[4:7], v[128:131], v[92:95]
    ds_read_b64_tr_b16 v[122:123], v21 offset:5200
    s_waitcnt lgkmcnt(11)
    v_mfma_f32_16x16x32_bf16 v[96:99], a[0:3], v[132:135], v[96:99]
    ds_read_b64_tr_b16 v[124:125], v20 offset:5240
    ds_read_b64_tr_b16 v[126:127], v21 offset:5240
    v_mfma_f32_16x16x32_bf16 v[100:103], a[4:7], v[132:135], v[100:103]
    buffer_load_dwordx4 v9, s[16:19], s82 offen offset:3072 lds
    s_waitcnt lgkmcnt(11)
    v_mfma_f32_16x16x32_bf16 v[104:107], a[0:3], v[136:139], v[104:107]
    ds_read_b64_tr_b16 v[128:129], v24 offset:5152
    v_mfma_f32_16x16x32_bf16 v[108:111], a[4:7], v[136:139], v[108:111]
    ds_read_b64_tr_b16 v[130:131], v25 offset:5152
    s_waitcnt lgkmcnt(12)
    s_cmp_lg_u32 s46, 0
    s_cbranch_scc1 Lng_13
    v_mfma_f32_16x16x32_bf16 v[112:115], a[0:3], v[140:143], v[112:115]
Lng_13:
    ds_read_b64_tr_b16 v[132:133], v20 offset:15360
    ds_read_b64_tr_b16 v[134:135], v21 offset:15360
    s_add_u32 m0, s90, 4096
    s_waitcnt lgkmcnt(10)
    v_mfma_f32_16x16x32_bf16 v[32:35], a[8:11], v[144:147], v[32:35]
    buffer_load_dwordx4 v10, s[16:19], s82 offen lds
    v_mfma_f32_16x16x32_bf16 v[36:39], a[12:15], v[144:147], v[36:39]
    ds_read_b64_tr_b16 v[136:137], v20 offset:15400
    ds_read_b64_tr_b16 v[138:139], v21 offset:15400
    s_waitcnt lgkmcnt(10)
    v_mfma_f32_16x16x32_bf16 v[40:43], a[8:11], v[116:119], v[40:43]
    ds_read_b64_tr_b16 v[140:141], v20 offset:15440
    v_mfma_f32_16x16x32_bf16 v[44:47], a[12:15], v[116:119], v[44:47]
    ds_read_b64_tr_b16 v[142:143], v21 offset:15440
    s_waitcnt lgkmcnt(10)
    v_mfma_f32_16x16x32_bf16 v[48:51], a[8:11], v[120:123], v[48:51]
    ds_read_b64_tr_b16 v[144:145], v20 offset:15480
    v_mfma_f32_16x16x32_bf16 v[52:55], a[12:15], v[120:123], v[52:55]
    ds_read_b64_tr_b16 v[146:147], v21 offset:15480
    s_waitcnt lgkmcnt(10)
    v_mfma_f32_16x16x32_bf16 v[56:59], a[8:11], v[124:127], v[56:59]
    ds_read_b64_tr_b16 v[116:117], v24 offset:15392
    v_mfma_f32_16x16x32_bf16 v[60:63], a[12:15], v[124:127], v[60:63]
    ds_read_b64_tr_b16 v[118:119], v25 offset:15392
    s_waitcnt lgkmcnt(10)
    v_mfma_f32_16x16x32_bf16 v[64:67], a[8:11], v[128:131], v[64:67]
    ds_read_b128 v[120:123], v148 offset:64
    v_mfma_f32_16x16x32_bf16 v[68:71], a[12:15], v[128:131], v[68:71]
    s_waitcnt vmcnt(9)
    s_barrier
    ds_read_b128 a[16:19], v12 offset:12288
    s_waitcnt lgkmcnt(10)
    v_mfma_f32_16x16x32_bf16 v[72:75], a[8:11], v[132:135], v[72:75]
    ds_read_b128 a[20:23], v14 offset:12288
    ds_read_b64_tr_b16 v[124:125], v20 offset:20480
    v_mfma_f32_16x16x32_bf16 v[76:79], a[12:15], v[132:135], v[76:79]
    ds_read_b64_tr_b16 v[126:127], v21 offset:20480
    s_add_u32 m0, s89, 4096
    s_waitcnt lgkmcnt(11)
    v_mfma_f32_16x16x32_bf16 v[80:83], a[8:11], v[136:139], v[80:83]
    buffer_load_dwordx4 v2, s[8:11], s73 offen offset:0 lds
    v_mfma_f32_16x16x32_bf16 v[84:87], a[12:15], v[136:139], v[84:87]
    ds_read_b64_tr_b16 v[128:129], v20 offset:20520
    ds_read_b64_tr_b16 v[130:131], v21 offset:20520
    s_waitcnt lgkmcnt(11)
    v_mfma_f32_16x16x32_bf16 v[88:91], a[8:11], v[140:143], v[88:91]
    ds_read_b64_tr_b16 v[132:133], v20 offset:20560
    v_mfma_f32_16x16x32_bf16 v[92:95], a[12:15], v[140:143], v[92:95]
    ds_read_b64_tr_b16 v[134:135], v21 offset:20560
    s_waitcnt lgkmcnt(11)
    v_mfma_f32_16x16x32_bf16 v[96:99], a[8:11], v[144:147], v[96:99]
    buffer_load_dwordx4 v3, s[8:11], s73 offen offset:1024 lds
    v_mfma_f32_16x16x32_bf16 v[100:103], a[12:15], v[144:147], v[100:103]
    ds_read_b64_tr_b16 v[136:137], v20 offset:20600
    ds_read_b64_tr_b16 v[138:139], v21 offset:20600
    s_waitcnt lgkmcnt(11)
    v_mfma_f32_16x16x32_bf16 v[104:107], a[8:11], v[116:119], v[104:107]
    ds_read_b64_tr_b16 v[140:141], v24 offset:20512
    v_mfma_f32_16x16x32_bf16 v[108:111], a[12:15], v[116:119], v[108:111]
    ds_read_b64_tr_b16 v[142:143], v25 offset:20512
    s_waitcnt lgkmcnt(12)
    s_cmp_lg_u32 s46, 0
    s_cbranch_scc1 Lng_14
    v_mfma_f32_16x16x32_bf16 v[112:115], a[8:11], v[120:123], v[112:115]
Lng_14:
    buffer_load_dwordx4 v4, s[8:11], s73 offen offset:2048 lds
    ds_read_b64_tr_b16 v[144:145], v20 offset:30720
    ds_read_b64_tr_b16 v[146:147], v21 offset:30720
    s_waitcnt lgkmcnt(10)
    v_mfma_f32_16x16x32_bf16 v[32:35], a[16:19], v[124:127], v[32:35]
    ds_read_b64_tr_b16 v[116:117], v20 offset:30760
    v_mfma_f32_16x16x32_bf16 v[36:39], a[20:23], v[124:127], v[36:39]
    ds_read_b64_tr_b16 v[118:119], v21 offset:30760
    s_waitcnt lgkmcnt(10)
    v_mfma_f32_16x16x32_bf16 v[40:43], a[16:19], v[128:131], v[40:43]
    ds_read_b64_tr_b16 v[120:121], v20 offset:30800
    ds_read_b64_tr_b16 v[122:123], v21 offset:30800
    v_mfma_f32_16x16x32_bf16 v[44:47], a[20:23], v[128:131], v[44:47]
    buffer_load_dwordx4 v5, s[8:11], s73 offen offset:3072 lds
    s_waitcnt lgkmcnt(10)
    v_mfma_f32_16x16x32_bf16 v[48:51], a[16:19], v[132:135], v[48:51]
    ds_read_b64_tr_b16 v[124:125], v20 offset:30840
    v_mfma_f32_16x16x32_bf16 v[52:55], a[20:23], v[132:135], v[52:55]
    ds_read_b64_tr_b16 v[126:127], v21 offset:30840
    s_waitcnt lgkmcnt(10)
    v_mfma_f32_16x16x32_bf16 v[56:59], a[16:19], v[136:139], v[56:59]
    ds_read_b64_tr_b16 v[128:129], v24 offset:30752
    ds_read_b64_tr_b16 v[130:131], v25 offset:30752
    s_add_u32 m0, s90, 20480
    v_mfma_f32_16x16x32_bf16 v[60:63], a[20:23], v[136:139], v[60:63]
    buffer_load_dwordx4 v6, s[16:19], s83 offen offset:0 lds
    s_waitcnt lgkmcnt(10)
    v_mfma_f32_16x16x32_bf16 v[64:67], a[16:19], v[140:143], v[64:67]
    v_add_u32 v148, s71, v11
    ds_read_b128 v[132:135], v148 offset:0
    v_mfma_f32_16x16x32_bf16 v[68:71], a[20:23], v[140:143], v[68:71]
    ds_read_b128 a[24:27], v13 offset:12288
    s_waitcnt lgkmcnt(10)
    v_mfma_f32_16x16x32_bf16 v[72:75], a[16:19], v[144:147], v[72:75]
    ds_read_b128 a[28:31], v15 offset:12288
    ds_read_b64_tr_b16 v[136:137], v20 offset:25600
    ds_read_b64_tr_b16 v[138:139], v21 offset:25600
    v_mfma_f32_16x16x32_bf16 v[76:79], a[20:23], v[144:147], v[76:79]
    buffer_load_dwordx4 v7, s[16:19], s83 offen offset:1024 lds
    s_waitcnt lgkmcnt(11)
    v_mfma_f32_16x16x32_bf16 v[80:83], a[16:19], v[116:119], v[80:83]
    ds_read_b64_tr_b16 v[140:141], v20 offset:25640
    v_mfma_f32_16x16x32_bf16 v[84:87], a[20:23], v[116:119], v[84:87]
    ds_read_b64_tr_b16 v[142:143], v21 offset:25640
    s_waitcnt lgkmcnt(11)
    v_mfma_f32_16x16x32_bf16 v[88:91], a[16:19], v[120:123], v[88:91]
    ds_read_b64_tr_b16 v[144:145], v20 offset:25680
    ds_read_b64_tr_b16 v[146:147], v21 offset:25680
    v_mfma_f32_16x16x32_bf16 v[92:95], a[20:23], v[120:123], v[92:95]
    buffer_load_dwordx4 v8, s[16:19], s83 offen offset:2048 lds
    s_waitcnt lgkmcnt(11)
    v_mfma_f32_16x16x32_bf16 v[96:99], a[16:19], v[124:127], v[96:99]
    ds_read_b64_tr_b16 v[116:117], v20 offset:25720
    v_mfma_f32_16x16x32_bf16 v[100:103], a[20:23], v[124:127], v[100:103]
    ds_read_b64_tr_b16 v[118:119], v21 offset:25720
    s_waitcnt lgkmcnt(11)
    v_mfma_f32_16x16x32_bf16 v[104:107], a[16:19], v[128:131], v[104:107]
    ds_read_b64_tr_b16 v[120:121], v24 offset:25632
    ds_read_b64_tr_b16 v[122:123], v25 offset:25632
    v_mfma_f32_16x16x32_bf16 v[108:111], a[20:23], v[128:131], v[108:111]
    buffer_load_dwordx4 v9, s[16:19], s83 offen offset:3072 lds
    s_waitcnt lgkmcnt(12)
    s_cmp_lg_u32 s46, 0
    s_cbranch_scc1 Lng_15
    v_mfma_f32_16x16x32_bf16 v[112:115], a[16:19], v[132:135], v[112:115]
Lng_15:
    ds_read_b64_tr_b16 v[124:125], v20 offset:35840
    ds_read_b64_tr_b16 v[126:127], v21 offset:35840
    s_waitcnt lgkmcnt(10)
    v_mfma_f32_16x16x32_bf16 v[32:35], a[24:27], v[136:139], v[32:35]
    ds_read_b64_tr_b16 v[128:129], v20 offset:35880
    v_mfma_f32_16x16x32_bf16 v[36:39], a[28:31], v[136:139], v[36:39]
    ds_read_b64_tr_b16 v[130:131], v21 offset:35880
    s_add_u32 m0, s90, 24576
    s_waitcnt lgkmcnt(10)
    v_mfma_f32_16x16x32_bf16 v[40:43], a[24:27], v[140:143], v[40:43]
    buffer_load_dwordx4 v10, s[16:19], s83 offen lds
    v_mfma_f32_16x16x32_bf16 v[44:47], a[28:31], v[140:143], v[44:47]
    ds_read_b64_tr_b16 v[132:133], v20 offset:35920
    ds_read_b64_tr_b16 v[134:135], v21 offset:35920
    s_waitcnt lgkmcnt(10)
    v_mfma_f32_16x16x32_bf16 v[48:51], a[24:27], v[144:147], v[48:51]
    ds_read_b64_tr_b16 v[136:137], v20 offset:35960
    v_mfma_f32_16x16x32_bf16 v[52:55], a[28:31], v[144:147], v[52:55]
    ds_read_b64_tr_b16 v[138:139], v21 offset:35960
    s_waitcnt lgkmcnt(10)
    v_mfma_f32_16x16x32_bf16 v[56:59], a[24:27], v[116:119], v[56:59]
    ds_read_b64_tr_b16 v[140:141], v24 offset:35872
    v_mfma_f32_16x16x32_bf16 v[60:63], a[28:31], v[116:119], v[60:63]
    ds_read_b64_tr_b16 v[142:143], v25 offset:35872
    s_waitcnt lgkmcnt(10)
    v_mfma_f32_16x16x32_bf16 v[64:67], a[24:27], v[120:123], v[64:67]
    ds_read_b128 v[144:147], v148 offset:64
    v_mfma_f32_16x16x32_bf16 v[68:71], a[28:31], v[120:123], v[68:71]
    s_waitcnt vmcnt(9)
    s_barrier
    ds_read_b128 a[0:3], v12 offset:0
    s_waitcnt lgkmcnt(10)
    v_mfma_f32_16x16x32_bf16 v[72:75], a[24:27], v[124:127], v[72:75]
    ds_read_b128 a[4:7], v14 offset:0
    ds_read_b64_tr_b16 v[116:117], v18 offset:0
    v_mfma_f32_16x16x32_bf16 v[76:79], a[28:31], v[124:127], v[76:79]
    ds_read_b64_tr_b16 v[118:119], v19 offset:0
    s_waitcnt lgkmcnt(11)
    v_mfma_f32_16x16x32_bf16 v[80:83], a[24:27], v[128:131], v[80:83]
    ds_read_b64_tr_b16 v[120:121], v18 offset:40
    v_mfma_f32_16x16x32_bf16 v[84:87], a[28:31], v[128:131], v[84:87]
    ds_read_b64_tr_b16 v[122:123], v19 offset:40
    s_waitcnt lgkmcnt(11)
    v_mfma_f32_16x16x32_bf16 v[88:91], a[24:27], v[132:135], v[88:91]
    ds_read_b64_tr_b16 v[124:125], v18 offset:80
    v_mfma_f32_16x16x32_bf16 v[92:95], a[28:31], v[132:135], v[92:95]
    ds_read_b64_tr_b16 v[126:127], v19 offset:80
    s_waitcnt lgkmcnt(11)
    v_mfma_f32_16x16x32_bf16 v[96:99], a[24:27], v[136:139], v[96:99]
    ds_read_b64_tr_b16 v[128:129], v18 offset:120
    v_mfma_f32_16x16x32_bf16 v[100:103], a[28:31], v[136:139], v[100:103]
    ds_read_b64_tr_b16 v[130:131], v19 offset:120
    s_waitcnt lgkmcnt(11)
    v_mfma_f32_16x16x32_bf16 v[104:107], a[24:27], v[140:143], v[104:107]
    ds_read_b64_tr_b16 v[132:133], v22 offset:32
    v_mfma_f32_16x16x32_bf16 v[108:111], a[28:31], v[140:143], v[108:111]
    ds_read_b64_tr_b16 v[134:135], v23 offset:32
    s_waitcnt lgkmcnt(12)
    s_cmp_lg_u32 s46, 0
    s_cbranch_scc1 Lng_16
    v_mfma_f32_16x16x32_bf16 v[112:115], a[24:27], v[144:147], v[112:115]
Lng_16:
    ds_read_b64_tr_b16 v[136:137], v18 offset:10240
    ds_read_b64_tr_b16 v[138:139], v19 offset:10240
    s_waitcnt lgkmcnt(10)
    v_mfma_f32_16x16x32_bf16 v[32:35], a[0:3], v[116:119], v[32:35]
    ds_read_b64_tr_b16 v[140:141], v18 offset:10280
    ds_read_b64_tr_b16 v[142:143], v19 offset:10280
    s_add_u32 m0, s89, 10240
    v_mfma_f32_16x16x32_bf16 v[36:39], a[4:7], v[116:119], v[36:39]
    buffer_load_dwordx4 v238, s[8:11], s56 offen offset:0 lds
    s_waitcnt lgkmcnt(10)
    v_mfma_f32_16x16x32_bf16 v[40:43], a[0:3], v[120:123], v[40:43]
    ds_read_b64_tr_b16 v[144:145], v18 offset:10320
    v_mfma_f32_16x16x32_bf16 v[44:47], a[4:7], v[120:123], v[44:47]
    ds_read_b64_tr_b16 v[146:147], v19 offset:10320
    s_waitcnt lgkmcnt(10)
    v_mfma_f32_16x16x32_bf16 v[48:51], a[0:3], v[124:127], v[48:51]
    ds_read_b64_tr_b16 v[116:117], v18 offset:10360
    ds_read_b64_tr_b16 v[118:119], v19 offset:10360
    s_add_u32 s56, s56, 9152
    v_mfma_f32_16x16x32_bf16 v[52:55], a[4:7], v[124:127], v[52:55]
    buffer_load_dwordx4 v238, s[8:11], s56 offen offset:1088 lds
    s_waitcnt lgkmcnt(10)
    v_mfma_f32_16x16x32_bf16 v[56:59], a[0:3], v[128:131], v[56:59]
    ds_read_b64_tr_b16 v[120:121], v22 offset:10272
    v_mfma_f32_16x16x32_bf16 v[60:63], a[4:7], v[128:131], v[60:63]
    ds_read_b64_tr_b16 v[122:123], v23 offset:10272
    s_waitcnt lgkmcnt(10)
    v_mfma_f32_16x16x32_bf16 v[64:67], a[0:3], v[132:135], v[64:67]
    v_add_u32 v148, s72, v11
    ds_read_b128 v[124:127], v148 offset:0
    s_add_u32 s56, s56, 9152
    v_mfma_f32_16x16x32_bf16 v[68:71], a[4:7], v[132:135], v[68:71]
    buffer_load_dwordx4 v238, s[8:11], s56 offen offset:2176 lds
    s_waitcnt lgkmcnt(9)
    v_mfma_f32_16x16x32_bf16 v[72:75], a[0:3], v[136:139], v[72:75]
    ds_read_b128 a[8:11], v13 offset:0
    ds_read_b128 a[12:15], v15 offset:0
    v_mfma_f32_16x16x32_bf16 v[76:79], a[4:7], v[136:139], v[76:79]
    ds_read_b64_tr_b16 v[128:129], v18 offset:5120
    ds_read_b64_tr_b16 v[130:131], v19 offset:5120
    s_waitcnt lgkmcnt(11)
    v_mfma_f32_16x16x32_bf16 v[80:83], a[0:3], v[140:143], v[80:83]
    ds_read_b64_tr_b16 v[132:133], v18 offset:5160
    ds_read_b64_tr_b16 v[134:135], v19 offset:5160
    s_add_u32 s56, s56, 9152
    v_mfma_f32_16x16x32_bf16 v[84:87], a[4:7], v[140:143], v[84:87]
    buffer_load_dwordx4 v238, s[8:11], s56 offen offset:3264 lds
    s_waitcnt lgkmcnt(11)
    v_mfma_f32_16x16x32_bf16 v[88:91], a[0:3], v[144:147], v[88:91]
    ds_read_b64_tr_b16 v[136:137], v18 offset:5200
    v_mfma_f32_16x16x32_bf16 v[92:95], a[4:7], v[144:147], v[92:95]
    ds_read_b64_tr_b16 v[138:139], v19 offset:5200
    s_waitcnt lgkmcnt(11)
    v_mfma_f32_16x16x32_bf16 v[96:99], a[0:3], v[116:119], v[96:99]
    ds_read_b64_tr_b16 v[140:141], v18 offset:5240
    ds_read_b64_tr_b16 v[142:143], v19 offset:5240
    s_add_u32 m0, s89, 14528
    v_mfma_f32_16x16x32_bf16 v[100:103], a[4:7], v[116:119], v[100:103]
    s_mov_b64 exec, 0x3ff
    buffer_load_dwordx4 v238, s[24:27], s57 offen lds
    s_mov_b64 exec, -1
    s_waitcnt lgkmcnt(11)
    v_mfma_f32_16x16x32_bf16 v[104:107], a[0:3], v[120:123], v[104:107]
    ds_read_b64_tr_b16 v[144:145], v22 offset:5152
    v_mfma_f32_16x16x32_bf16 v[108:111], a[4:7], v[120:123], v[108:111]
    ds_read_b64_tr_b16 v[146:147], v23 offset:5152
    s_waitcnt lgkmcnt(12)
    s_cmp_lg_u32 s46, 0
    s_cbranch_scc1 Lng_17
    v_mfma_f32_16x16x32_bf16 v[112:115], a[0:3], v[124:127], v[112:115]
Lng_17:
    ds_read_b64_tr_b16 v[116:117], v18 offset:15360
    ds_read_b64_tr_b16 v[118:119], v19 offset:15360
    s_waitcnt lgkmcnt(10)
    v_mfma_f32_16x16x32_bf16 v[32:35], a[8:11], v[128:131], v[32:35]
    s_getpc_b64 s[92:93]
Lct_18:
    s_sub_u32 s92, s92, Lct_18-Lpc
    s_subb_u32 s93, s93, 0
    s_lshr_b32 s7, s2, 3
    s_lshl_b32 s7, s7, 2
    s_add_u32 s7, s7, s3
    s_lshl_b32 s7, s7, 7
    v_lshl_add_u32 v149, v1, 14, s7
    v_min_u32 v149, Lcode_end-Lpc, v149
    s_mov_b64 exec, 15
    global_load_dword v149, v149, s[92:93]
    s_mov_b64 exec, -1
    v_mfma_f32_16x16x32_bf16 v[36:39], a[12:15], v[128:131], v[36:39]
    ds_read_b64_tr_b16 v[120:121], v18 offset:15400
    ds_read_b64_tr_b16 v[122:123], v19 offset:15400
    s_waitcnt lgkmcnt(10)
    v_mfma_f32_16x16x32_bf16 v[40:43], a[8:11], v[132:135], v[40:43]
    ds_read_b64_tr_b16 v[124:125], v18 offset:15440
    v_mfma_f32_16x16x32_bf16 v[44:47], a[12:15], v[132:135], v[44:47]
    ds_read_b64_tr_b16 v[126:127], v19 offset:15440
    s_waitcnt lgkmcnt(10)
    v_mfma_f32_16x16x32_bf16 v[48:51], a[8:11], v[136:139], v[48:51]
    s_mov_b64 exec, 0xffff
    buffer_load_dword v151, v224, s[20:23], 0 offen sc1
    s_mov_b64 exec, -1
    v_mfma_f32_16x16x32_bf16 v[52:55], a[12:15], v[136:139], v[52:55]
    ds_read_b64_tr_b16 v[128:129], v18 offset:15480
    ds_read_b64_tr_b16 v[130:131], v19 offset:15480
    s_waitcnt lgkmcnt(10)
    v_mfma_f32_16x16x32_bf16 v[56:59], a[8:11], v[140:143], v[56:59]
    ds_read_b64_tr_b16 v[132:133], v22 offset:15392
    v_mfma_f32_16x16x32_bf16 v[60:63], a[12:15], v[140:143], v[60:63]
    ds_read_b64_tr_b16 v[134:135], v23 offset:15392
    s_waitcnt lgkmcnt(10)
    v_mfma_f32_16x16x32_bf16 v[64:67], a[8:11], v[144:147], v[64:67]
    ds_read_b128 v[136:139], v148 offset:64
    v_mfma_f32_16x16x32_bf16 v[68:71], a[12:15], v[144:147], v[68:71]
    s_waitcnt vmcnt(7)
    s_barrier
    ds_read_b128 a[16:19], v12 offset:4096
    s_waitcnt vmcnt(0)
    s_mov_b64 exec, 0xffff
    s_mov_b32 s96, 0
    s_branch LK_fc_20
LK_fl_19:
    buffer_load_dword v151, v224, s[20:23], 0 offen sc1
    s_add_u32 s96, s96, 1
    s_waitcnt vmcnt(0)
LK_fc_20:
    v_cmp_ne_u32 vcc, s6, v151
    s_cmp_gt_u32 s96, 0x20000
    s_cbranch_scc1 LK_fe_21
    s_cbranch_vccnz LK_fl_19
LK_fe_21:
    s_mov_b64 exec, -1
    s_waitcnt lgkmcnt(10)
    v_mfma_f32_16x16x32_bf16 v[72:75], a[8:11], v[116:119], v[72:75]
    ds_read_b128 a[20:23], v14 offset:4096
    ds_read_b64_tr_b16 v[140:141], v18 offset:20480
    v_mfma_f32_16x16x32_bf16 v[76:79], a[12:15], v[116:119], v[76:79]
    ds_read_b64_tr_b16 v[142:143], v19 offset:20480
    s_mul_i32 s50, s84, 10240
    s_add_u32 s50, s50, 11534336
    s_waitcnt lgkmcnt(11)
    v_mfma_f32_16x16x32_bf16 v[80:83], a[8:11], v[120:123], v[80:83]
    buffer_load_dwordx4 a[160:163], v26, s[20:23], s50 offen offset:0 sc1
    v_mfma_f32_16x16x32_bf16 v[84:87], a[12:15], v[120:123], v[84:87]
    ds_read_b64_tr_b16 v[144:145], v18 offset:20520
    ds_read_b64_tr_b16 v[146:147], v19 offset:20520
    s_waitcnt lgkmcnt(11)
    v_mfma_f32_16x16x32_bf16 v[88:91], a[8:11], v[124:127], v[88:91]
    ds_read_b64_tr_b16 v[116:117], v18 offset:20560
    v_mfma_f32_16x16x32_bf16 v[92:95], a[12:15], v[124:127], v[92:95]
    ds_read_b64_tr_b16 v[118:119], v19 offset:20560
    s_waitcnt lgkmcnt(11)
    v_mfma_f32_16x16x32_bf16 v[96:99], a[8:11], v[128:131], v[96:99]
    buffer_load_dwordx4 a[164:167], v26, s[20:23], s50 offen offset:2048 sc1
    v_mfma_f32_16x16x32_bf16 v[100:103], a[12:15], v[128:131], v[100:103]
    ds_read_b64_tr_b16 v[120:121], v18 offset:20600
    ds_read_b64_tr_b16 v[122:123], v19 offset:20600
    s_waitcnt lgkmcnt(11)
    v_mfma_f32_16x16x32_bf16 v[104:107], a[8:11], v[132:135], v[104:107]
    ds_read_b64_tr_b16 v[124:125], v22 offset:20512
    v_mfma_f32_16x16x32_bf16 v[108:111], a[12:15], v[132:135], v[108:111]
    ds_read_b64_tr_b16 v[126:127], v23 offset:20512
    s_waitcnt lgkmcnt(12)
    s_cmp_lg_u32 s46, 0
    s_cbranch_scc1 Lng_22
    v_mfma_f32_16x16x32_bf16 v[112:115], a[8:11], v[136:139], v[112:115]
Lng_22:
    buffer_load_dwordx4 a[168:171], v27, s[20:23], s50 offen offset:0 sc1
    ds_read_b64_tr_b16 v[128:129], v18 offset:30720
    ds_read_b64_tr_b16 v[130:131], v19 offset:30720
    s_waitcnt lgkmcnt(10)
    v_mfma_f32_16x16x32_bf16 v[32:35], a[16:19], v[140:143], v[32:35]
    ds_read_b64_tr_b16 v[132:133], v18 offset:30760
    v_mfma_f32_16x16x32_bf16 v[36:39], a[20:23], v[140:143], v[36:39]
    ds_read_b64_tr_b16 v[134:135], v19 offset:30760
    s_waitcnt lgkmcnt(10)
    v_mfma_f32_16x16x32_bf16 v[40:43], a[16:19], v[144:147], v[40:43]
    ds_read_b64_tr_b16 v[136:137], v18 offset:30800
    ds_read_b64_tr_b16 v[138:139], v19 offset:30800
    v_mfma_f32_16x16x32_bf16 v[44:47], a[20:23], v[144:147], v[44:47]
    buffer_load_dwordx4 a[172:175], v27, s[20:23], s50 offen offset:2048 sc1
    s_waitcnt lgkmcnt(10)
    v_mfma_f32_16x16x32_bf16 v[48:51], a[16:19], v[116:119], v[48:51]
    ds_read_b64_tr_b16 v[140:141], v18 offset:30840
    v_mfma_f32_16x16x32_bf16 v[52:55], a[20:23], v[116:119], v[52:55]
    ds_read_b64_tr_b16 v[142:143], v19 offset:30840
    s_waitcnt lgkmcnt(10)
    v_mfma_f32_16x16x32_bf16 v[56:59], a[16:19], v[120:123], v[56:59]
    ds_read_b64_tr_b16 v[144:145], v22 offset:30752
    ds_read_b64_tr_b16 v[146:147], v23 offset:30752
    v_mfma_f32_16x16x32_bf16 v[60:63], a[20:23], v[120:123], v[60:63]
    buffer_load_dwordx4 a[176:179], v28, s[20:23], s50 offen offset:0 sc1
    s_waitcnt lgkmcnt(10)
    v_mfma_f32_16x16x32_bf16 v[64:67], a[16:19], v[124:127], v[64:67]
    v_add_u32 v148, s73, v11
    ds_read_b128 v[116:119], v148 offset:0
    v_mfma_f32_16x16x32_bf16 v[68:71], a[20:23], v[124:127], v[68:71]
    ds_read_b128 a[24:27], v13 offset:4096
    s_waitcnt lgkmcnt(10)
    v_mfma_f32_16x16x32_bf16 v[72:75], a[16:19], v[128:131], v[72:75]
    ds_read_b128 a[28:31], v15 offset:4096
    ds_read_b64_tr_b16 v[120:121], v18 offset:25600
    ds_read_b64_tr_b16 v[122:123], v19 offset:25600
    v_mfma_f32_16x16x32_bf16 v[76:79], a[20:23], v[128:131], v[76:79]
    buffer_load_dwordx4 a[180:183], v26, s[20:23], s50 offen offset:1024 sc1
    s_waitcnt lgkmcnt(11)
    v_mfma_f32_16x16x32_bf16 v[80:83], a[16:19], v[132:135], v[80:83]
    ds_read_b64_tr_b16 v[124:125], v18 offset:25640
    v_mfma_f32_16x16x32_bf16 v[84:87], a[20:23], v[132:135], v[84:87]
    ds_read_b64_tr_b16 v[126:127], v19 offset:25640
    s_waitcnt lgkmcnt(11)
    v_mfma_f32_16x16x32_bf16 v[88:91], a[16:19], v[136:139], v[88:91]
    ds_read_b64_tr_b16 v[128:129], v18 offset:25680
    ds_read_b64_tr_b16 v[130:131], v19 offset:25680
    v_mfma_f32_16x16x32_bf16 v[92:95], a[20:23], v[136:139], v[92:95]
    buffer_load_dwordx4 a[184:187], v26, s[20:23], s50 offen offset:3072 sc1
    s_waitcnt lgkmcnt(11)
    v_mfma_f32_16x16x32_bf16 v[96:99], a[16:19], v[140:143], v[96:99]
    ds_read_b64_tr_b16 v[132:133], v18 offset:25720
    v_mfma_f32_16x16x32_bf16 v[100:103], a[20:23], v[140:143], v[100:103]
    ds_read_b64_tr_b16 v[134:135], v19 offset:25720
    s_waitcnt lgkmcnt(11)
    v_mfma_f32_16x16x32_bf16 v[104:107], a[16:19], v[144:147], v[104:107]
    ds_read_b64_tr_b16 v[136:137], v22 offset:25632
    ds_read_b64_tr_b16 v[138:139], v23 offset:25632
    v_mfma_f32_16x16x32_bf16 v[108:111], a[20:23], v[144:147], v[108:111]
    buffer_load_dwordx4 a[188:191], v27, s[20:23], s50 offen offset:1024 sc1
    s_waitcnt lgkmcnt(12)
    s_cmp_lg_u32 s46, 0
    s_cbranch_scc1 Lng_23
    v_mfma_f32_16x16x32_bf16 v[112:115], a[16:19], v[116:119], v[112:115]
Lng_23:
    ds_read_b64_tr_b16 v[140:141], v18 offset:35840
    ds_read_b64_tr_b16 v[142:143], v19 offset:35840
    s_waitcnt lgkmcnt(10)
    v_mfma_f32_16x16x32_bf16 v[32:35], a[24:27], v[120:123], v[32:35]
    ds_read_b64_tr_b16 v[144:145], v18 offset:35880
    v_mfma_f32_16x16x32_bf16 v[36:39], a[28:31], v[120:123], v[36:39]
    ds_read_b64_tr_b16 v[146:147], v19 offset:35880
    s_waitcnt lgkmcnt(10)
    v_mfma_f32_16x16x32_bf16 v[40:43], a[24:27], v[124:127], v[40:43]
    buffer_load_dwordx4 a[192:195], v27, s[20:23], s50 offen offset:3072 sc1
    v_mfma_f32_16x16x32_bf16 v[44:47], a[28:31], v[124:127], v[44:47]
    ds_read_b64_tr_b16 v[116:117], v18 offset:35920
    ds_read_b64_tr_b16 v[118:119], v19 offset:35920
    s_waitcnt lgkmcnt(10)
    v_mfma_f32_16x16x32_bf16 v[48:51], a[24:27], v[128:131], v[48:51]
    ds_read_b64_tr_b16 v[120:121], v18 offset:35960
    v_mfma_f32_16x16x32_bf16 v[52:55], a[28:31], v[128:131], v[52:55]
    ds_read_b64_tr_b16 v[122:123], v19 offset:35960
    s_waitcnt lgkmcnt(10)
    v_mfma_f32_16x16x32_bf16 v[56:59], a[24:27], v[132:135], v[56:59]
    buffer_load_dwordx4 a[196:199], v28, s[20:23], s50 offen offset:1024 sc1
    v_mfma_f32_16x16x32_bf16 v[60:63], a[28:31], v[132:135], v[60:63]
    ds_read_b64_tr_b16 v[124:125], v22 offset:35872
    ds_read_b64_tr_b16 v[126:127], v23 offset:35872
    s_waitcnt lgkmcnt(10)
    v_mfma_f32_16x16x32_bf16 v[64:67], a[24:27], v[136:139], v[64:67]
    ds_read_b128 v[128:131], v148 offset:64
    v_mfma_f32_16x16x32_bf16 v[68:71], a[28:31], v[136:139], v[68:71]
    s_mul_i32 s50, s85, 10240
    s_add_u32 s50, s50, 11534336
    s_waitcnt lgkmcnt(9)
    v_mfma_f32_16x16x32_bf16 v[72:75], a[24:27], v[140:143], v[72:75]
    buffer_load_dwordx4 a[200:203], v26, s[20:23], s50 offen offset:0 sc1
    v_mfma_f32_16x16x32_bf16 v[76:79], a[28:31], v[140:143], v[76:79]
    s_waitcnt lgkmcnt(7)
    v_mfma_f32_16x16x32_bf16 v[80:83], a[24:27], v[144:147], v[80:83]
    v_mfma_f32_16x16x32_bf16 v[84:87], a[28:31], v[144:147], v[84:87]
    s_waitcnt lgkmcnt(5)
    v_mfma_f32_16x16x32_bf16 v[88:91], a[24:27], v[116:119], v[88:91]
    buffer_load_dwordx4 a[204:207], v26, s[20:23], s50 offen offset:2048 sc1
    v_mfma_f32_16x16x32_bf16 v[92:95], a[28:31], v[116:119], v[92:95]
    s_waitcnt lgkmcnt(3)
    v_mfma_f32_16x16x32_bf16 v[96:99], a[24:27], v[120:123], v[96:99]
    v_mfma_f32_16x16x32_bf16 v[100:103], a[28:31], v[120:123], v[100:103]
    s_waitcnt lgkmcnt(1)
    v_mfma_f32_16x16x32_bf16 v[104:107], a[24:27], v[124:127], v[104:107]
    buffer_load_dwordx4 a[208:211], v27, s[20:23], s50 offen offset:0 sc1
    v_mfma_f32_16x16x32_bf16 v[108:111], a[28:31], v[124:127], v[108:111]
    s_waitcnt lgkmcnt(0)
    s_cmp_lg_u32 s46, 0
    s_cbranch_scc1 Lng_24
    v_mfma_f32_16x16x32_bf16 v[112:115], a[24:27], v[128:131], v[112:115]
Lng_24:
    s_mov_b32 s92, 1069066811
    s_movk_i32 s93, 0xff
    v_pk_mul_f32 v[196:197], v[32:33], s[92:93] op_sel_hi:[1,0]
    v_max_f32 v32, 0x358637bd, v32
    v_max_f32 v33, 0x358637bd, v33
    v_exp_f32_e64 v196, v196 clamp
    v_exp_f32_e64 v197, v197 clamp
    v_pk_mul_f32 v[198:199], v[34:35], s[92:93] op_sel_hi:[1,0]
    v_max_f32 v34, 0x358637bd, v34
    v_max_f32 v35, 0x358637bd, v35
    v_exp_f32_e64 v198, v198 clamp
    v_exp_f32_e64 v199, v199 clamp
    v_pk_add_f32 v[32:33], v[32:33], v[196:197]
    v_pk_add_f32 v[34:35], v[34:35], v[198:199]
    v_cvt_pk_bf16_f32 v72, v72, v73
    v_cvt_pk_bf16_f32 v73, v74, v75
    v_cvt_pk_bf16_f32 v74, v76, v77
    v_cvt_pk_bf16_f32 v75, v78, v79
    ds_write_b128 v219, v[72:75] offset:5120
    v_pk_mul_f32 v[196:197], v[36:37], s[92:93] op_sel_hi:[1,0]
    v_max_f32 v36, 0x358637bd, v36
    v_max_f32 v37, 0x358637bd, v37
    v_exp_f32_e64 v196, v196 clamp
    v_exp_f32_e64 v197, v197 clamp
    v_pk_mul_f32 v[198:199], v[38:39], s[92:93] op_sel_hi:[1,0]
    v_max_f32 v38, 0x358637bd, v38
    v_max_f32 v39, 0x358637bd, v39
    v_exp_f32_e64 v198, v198 clamp
    v_exp_f32_e64 v199, v199 clamp
    v_pk_add_f32 v[36:37], v[36:37], v[196:197]
    v_pk_add_f32 v[38:39], v[38:39], v[198:199]
    v_cvt_pk_bf16_f32 v32, v32, v33
    v_cvt_pk_bf16_f32 v33, v34, v35
    v_cvt_pk_bf16_f32 v34, v36, v37
    v_cvt_pk_bf16_f32 v35, v38, v39
    ds_write_b128 v219, v[32:35] offset:0
    buffer_load_dwordx4 a[212:215], v27, s[20:23], s50 offen offset:2048 sc1
    buffer_load_dwordx4 a[216:219], v28, s[20:23], s50 offen offset:0 sc1
    v_pk_mul_f32 v[196:197], v[40:41], s[92:93] op_sel_hi:[1,0]
    v_max_f32 v40, 0x358637bd, v40
    v_max_f32 v41, 0x358637bd, v41
    v_exp_f32_e64 v196, v196 clamp
    v_exp_f32_e64 v197, v197 clamp
    v_pk_mul_f32 v[198:199], v[42:43], s[92:93] op_sel_hi:[1,0]
    v_max_f32 v42, 0x358637bd, v42
    v_max_f32 v43, 0x358637bd, v43
    v_exp_f32_e64 v198, v198 clamp
    v_exp_f32_e64 v199, v199 clamp
    v_pk_add_f32 v[40:41], v[40:41], v[196:197]
    v_pk_add_f32 v[42:43], v[42:43], v[198:199]
    v_cvt_pk_bf16_f32 v80, v80, v81
    v_cvt_pk_bf16_f32 v81, v82, v83
    v_cvt_pk_bf16_f32 v82, v84, v85
    v_cvt_pk_bf16_f32 v83, v86, v87
    ds_write_b128 v219, v[80:83] offset:6144
    v_pk_mul_f32 v[196:197], v[44:45], s[92:93] op_sel_hi:[1,0]
    v_max_f32 v44, 0x358637bd, v44
    v_max_f32 v45, 0x358637bd, v45
    v_exp_f32_e64 v196, v196 clamp
    v_exp_f32_e64 v197, v197 clamp
    v_pk_mul_f32 v[198:199], v[46:47], s[92:93] op_sel_hi:[1,0]
    v_max_f32 v46, 0x358637bd, v46
    v_max_f32 v47, 0x358637bd, v47
    v_exp_f32_e64 v198, v198 clamp
    v_exp_f32_e64 v199, v199 clamp
    v_pk_add_f32 v[44:45], v[44:45], v[196:197]
    v_pk_add_f32 v[46:47], v[46:47], v[198:199]
    v_cvt_pk_bf16_f32 v40, v40, v41
    v_cvt_pk_bf16_f32 v41, v42, v43
    v_cvt_pk_bf16_f32 v42, v44, v45
    v_cvt_pk_bf16_f32 v43, v46, v47
    ds_write_b128 v219, v[40:43] offset:1024
    buffer_load_dwordx4 a[220:223], v26, s[20:23], s50 offen offset:1024 sc1
    buffer_load_dwordx4 a[224:227], v26, s[20:23], s50 offen offset:3072 sc1
    v_pk_mul_f32 v[196:197], v[48:49], s[92:93] op_sel_hi:[1,0]
    v_max_f32 v48, 0x358637bd, v48
    v_max_f32 v49, 0x358637bd, v49
    v_exp_f32_e64 v196, v196 clamp
    v_exp_f32_e64 v197, v197 clamp
    v_pk_mul_f32 v[198:199], v[50:51], s[92:93] op_sel_hi:[1,0]
    v_max_f32 v50, 0x358637bd, v50
    v_max_f32 v51, 0x358637bd, v51
    v_exp_f32_e64 v198, v198 clamp
    v_exp_f32_e64 v199, v199 clamp
    v_pk_add_f32 v[48:49], v[48:49], v[196:197]
    v_pk_add_f32 v[50:51], v[50:51], v[198:199]
    v_cvt_pk_bf16_f32 v88, v88, v89
    v_cvt_pk_bf16_f32 v89, v90, v91
    v_cvt_pk_bf16_f32 v90, v92, v93
    v_cvt_pk_bf16_f32 v91, v94, v95
    ds_write_b128 v219, v[88:91] offset:7168
    v_pk_mul_f32 v[196:197], v[52:53], s[92:93] op_sel_hi:[1,0]
    v_max_f32 v52, 0x358637bd, v52
    v_max_f32 v53, 0x358637bd, v53
    v_exp_f32_e64 v196, v196 clamp
    v_exp_f32_e64 v197, v197 clamp
    v_pk_mul_f32 v[198:199], v[54:55], s[92:93] op_sel_hi:[1,0]
    v_max_f32 v54, 0x358637bd, v54
    v_max_f32 v55, 0x358637bd, v55
    v_exp_f32_e64 v198, v198 clamp
    v_exp_f32_e64 v199, v199 clamp
    v_pk_add_f32 v[52:53], v[52:53], v[196:197]
    v_pk_add_f32 v[54:55], v[54:55], v[198:199]
    v_cvt_pk_bf16_f32 v48, v48, v49
    v_cvt_pk_bf16_f32 v49, v50, v51
    v_cvt_pk_bf16_f32 v50, v52, v53
    v_cvt_pk_bf16_f32 v51, v54, v55
    ds_write_b128 v219, v[48:51] offset:2048
    buffer_load_dwordx4 a[228:231], v27, s[20:23], s50 offen offset:1024 sc1
    buffer_load_dwordx4 a[232:235], v27, s[20:23], s50 offen offset:3072 sc1
    v_pk_mul_f32 v[196:197], v[56:57], s[92:93] op_sel_hi:[1,0]
    v_max_f32 v56, 0x358637bd, v56
    v_max_f32 v57, 0x358637bd, v57
    v_exp_f32_e64 v196, v196 clamp
    v_exp_f32_e64 v197, v197 clamp
    v_pk_mul_f32 v[198:199], v[58:59], s[92:93] op_sel_hi:[1,0]
    v_max_f32 v58, 0x358637bd, v58
    v_max_f32 v59, 0x358637bd, v59
    v_exp_f32_e64 v198, v198 clamp
    v_exp_f32_e64 v199, v199 clamp
    v_pk_add_f32 v[56:57], v[56:57], v[196:197]
    v_pk_add_f32 v[58:59], v[58:59], v[198:199]
    v_cvt_pk_bf16_f32 v96, v96, v97
    v_cvt_pk_bf16_f32 v97, v98, v99
    v_cvt_pk_bf16_f32 v98, v100, v101
    v_cvt_pk_bf16_f32 v99, v102, v103
    ds_write_b128 v219, v[96:99] offset:8192
    v_pk_mul_f32 v[196:197], v[60:61], s[92:93] op_sel_hi:[1,0]
    v_max_f32 v60, 0x358637bd, v60
    v_max_f32 v61, 0x358637bd, v61
    v_exp_f32_e64 v196, v196 clamp
    v_exp_f32_e64 v197, v197 clamp
    v_pk_mul_f32 v[198:199], v[62:63], s[92:93] op_sel_hi:[1,0]
    v_max_f32 v62, 0x358637bd, v62
    v_max_f32 v63, 0x358637bd, v63
    v_exp_f32_e64 v198, v198 clamp
    v_exp_f32_e64 v199, v199 clamp
    v_pk_add_f32 v[60:61], v[60:61], v[196:197]
    v_pk_add_f32 v[62:63], v[62:63], v[198:199]
    v_cvt_pk_bf16_f32 v56, v56, v57
    v_cvt_pk_bf16_f32 v57, v58, v59
    v_cvt_pk_bf16_f32 v58, v60, v61
    v_cvt_pk_bf16_f32 v59, v62, v63
    ds_write_b128 v219, v[56:59] offset:3072
    buffer_load_dwordx4 a[236:239], v28, s[20:23], s50 offen offset:1024 sc1
    s_lshl_b32 s95, s84, 10
    s_add_u32 s95, s95, 8388608
    buffer_load_dwordx4 a[80:83], v29, s[20:23], s95 offen sc1
    v_pk_mul_f32 v[196:197], v[64:65], s[92:93] op_sel_hi:[1,0]
    v_max_f32 v64, 0x358637bd, v64
    v_max_f32 v65, 0x358637bd, v65
    v_exp_f32_e64 v196, v196 clamp
    v_exp_f32_e64 v197, v197 clamp
    v_pk_mul_f32 v[198:199], v[66:67], s[92:93] op_sel_hi:[1,0]
    v_max_f32 v66, 0x358637bd, v66
    v_max_f32 v67, 0x358637bd, v67
    v_exp_f32_e64 v198, v198 clamp
    v_exp_f32_e64 v199, v199 clamp
    v_pk_add_f32 v[64:65], v[64:65], v[196:197]
    v_pk_add_f32 v[66:67], v[66:67], v[198:199]
    v_cvt_pk_bf16_f32 v104, v104, v105
    v_cvt_pk_bf16_f32 v105, v106, v107
    v_cvt_pk_bf16_f32 v106, v108, v109
    v_cvt_pk_bf16_f32 v107, v110, v111
    ds_write_b128 v219, v[104:107] offset:9216
    v_pk_mul_f32 v[196:197], v[68:69], s[92:93] op_sel_hi:[1,0]
    v_max_f32 v68, 0x358637bd, v68
    v_max_f32 v69, 0x358637bd, v69
    v_exp_f32_e64 v196, v196 clamp
    v_exp_f32_e64 v197, v197 clamp
    v_pk_mul_f32 v[198:199], v[70:71], s[92:93] op_sel_hi:[1,0]
    v_max_f32 v70, 0x358637bd, v70
    v_max_f32 v71, 0x358637bd, v71
    v_exp_f32_e64 v198, v198 clamp
    v_exp_f32_e64 v199, v199 clamp
    v_pk_add_f32 v[68:69], v[68:69], v[196:197]
    v_pk_add_f32 v[70:71], v[70:71], v[198:199]
    v_cvt_pk_bf16_f32 v64, v64, v65
    v_cvt_pk_bf16_f32 v65, v66, v67
    v_cvt_pk_bf16_f32 v66, v68, v69
    v_cvt_pk_bf16_f32 v67, v70, v71
    ds_write_b128 v219, v[64:67] offset:4096
    s_add_u32 s95, s95, 20480
    buffer_load_dwordx4 a[84:87], v29, s[20:23], s95 offen sc1
    s_add_u32 s95, s95, 20480
    buffer_load_dwordx4 a[88:91], v29, s[20:23], s95 offen sc1
    s_waitcnt lgkmcnt(0)
    s_barrier
    ds_read_b128 v[44:47], v220 offset:9216
    ds_read_b128 v[32:35], v221 offset:0
    ds_read_b128 v[36:39], v220 offset:4096
    ds_read_b128 v[40:43], v221 offset:5120
    ds_read_b128 v[60:63], v220 offset:25600
    ds_read_b128 v[48:51], v221 offset:16384
    ds_read_b128 v[52:55], v220 offset:20480
    ds_read_b128 v[56:59], v221 offset:21504
    ds_read_b128 v[76:79], v220 offset:41984
    ds_read_b128 v[64:67], v221 offset:32768
    ds_read_b128 v[68:71], v220 offset:36864
    ds_read_b128 v[72:75], v221 offset:37888
    ds_read_b128 v[92:95], v220 offset:58368
    ds_read_b128 v[80:83], v221 offset:49152
    ds_read_b128 v[84:87], v220 offset:53248
    ds_read_b128 v[88:91], v221 offset:54272
    s_add_u32 s95, s95, 20480
    buffer_load_dwordx4 a[92:95], v29, s[20:23], s95 offen sc1
    s_add_u32 s95, s95, 20480
    buffer_load_dwordx4 a[96:99], v29, s[20:23], s95 offen sc1
    s_lshl_b32 s95, s85, 10
    s_add_u32 s95, s95, 8388608
    buffer_load_dwordx4 a[100:103], v29, s[20:23], s95 offen sc1
    s_waitcnt lgkmcnt(12)
    v_cndmask_b32 v44, v236, v44, s[60:61]
    v_cndmask_b32 v45, v236, v45, s[60:61]
    v_cndmask_b32 v46, v236, v46, s[60:61]
    v_cndmask_b32 v47, v236, v47, s[60:61]
    v_mfma_f32_16x16x32_bf16 v[96:99], v[32:35], v[40:43], 0
    v_mfma_f32_16x16x32_bf16 v[100:103], v[36:39], v[40:43], 0
    v_mfma_f32_16x16x32_bf16 v[104:107], v[32:35], v[44:47], 0
    v_mfma_f32_16x16x32_bf16 v[108:111], v[36:39], v[44:47], 0
    s_add_u32 s95, s95, 20480
    buffer_load_dwordx4 a[104:107], v29, s[20:23], s95 offen sc1
    s_waitcnt lgkmcnt(8)
    v_cndmask_b32 v60, v236, v60, s[60:61]
    v_cndmask_b32 v61, v236, v61, s[60:61]
    v_cndmask_b32 v62, v236, v62, s[60:61]
    v_cndmask_b32 v63, v236, v63, s[60:61]
    v_mfma_f32_16x16x32_bf16 v[96:99], v[48:51], v[56:59], v[96:99]
    v_mfma_f32_16x16x32_bf16 v[100:103], v[52:55], v[56:59], v[100:103]
    v_mfma_f32_16x16x32_bf16 v[104:107], v[48:51], v[60:63], v[104:107]
    v_mfma_f32_16x16x32_bf16 v[108:111], v[52:55], v[60:63], v[108:111]
    s_add_u32 s95, s95, 20480
    buffer_load_dwordx4 a[108:111], v29, s[20:23], s95 offen sc1
    s_waitcnt lgkmcnt(4)
    v_cndmask_b32 v76, v236, v76, s[60:61]
    v_cndmask_b32 v77, v236, v77, s[60:61]
    v_cndmask_b32 v78, v236, v78, s[60:61]
    v_cndmask_b32 v79, v236, v79, s[60:61]
    v_mfma_f32_16x16x32_bf16 v[96:99], v[64:67], v[72:75], v[96:99]
    v_mfma_f32_16x16x32_bf16 v[100:103], v[68:71], v[72:75], v[100:103]
    v_mfma_f32_16x16x32_bf16 v[104:107], v[64:67], v[76:79], v[104:107]
    v_mfma_f32_16x16x32_bf16 v[108:111], v[68:71], v[76:79], v[108:111]
    s_add_u32 s95, s95, 20480
    buffer_load_dwordx4 a[112:115], v29, s[20:23], s95 offen sc1
    s_waitcnt lgkmcnt(0)
    v_cndmask_b32 v92, v236, v92, s[60:61]
    v_cndmask_b32 v93, v236, v93, s[60:61]
    v_cndmask_b32 v94, v236, v94, s[60:61]
    v_cndmask_b32 v95, v236, v95, s[60:61]
    v_mfma_f32_16x16x32_bf16 v[96:99], v[80:83], v[88:91], v[96:99]
    v_mfma_f32_16x16x32_bf16 v[100:103], v[84:87], v[88:91], v[100:103]
    v_mfma_f32_16x16x32_bf16 v[104:107], v[80:83], v[92:95], v[104:107]
    v_mfma_f32_16x16x32_bf16 v[108:111], v[84:87], v[92:95], v[108:111]
    s_nop 4
    v_bfi_b32 v96, s93, v237, v96
    v_bfi_b32 v98, s93, v237, v98
    v_bfi_b32 v100, s93, v237, v100
    v_bfi_b32 v102, s93, v237, v102
    v_bfi_b32 v104, s93, v237, v104
    v_bfi_b32 v106, s93, v237, v106
    v_bfi_b32 v108, s93, v237, v108
    v_bfi_b32 v110, s93, v237, v110
    buffer_store_dwordx4 v[96:99], v215, s[20:23], s35 offen sc1
    buffer_store_dwordx4 v[100:103], v216, s[20:23], s35 offen offset:1344 sc1
    buffer_store_dwordx4 v[104:107], v217, s[20:23], s35 offen sc1
    buffer_store_dwordx4 v[108:111], v218, s[20:23], s35 offen offset:1344 sc1
    s_add_u32 s95, s95, 20480
    buffer_load_dwordx4 a[116:119], v29, s[20:23], s95 offen sc1
    s_lshl_b32 s95, s86, 10
    s_add_u32 s95, s95, 8388608
    buffer_load_dwordx4 a[120:123], v29, s[20:23], s95 offen sc1
    s_add_u32 s95, s95, 20480
    buffer_load_dwordx4 a[124:127], v29, s[20:23], s95 offen sc1
    s_add_u32 s7, s89, 10240
    v_lshrrev_b32 v196, 4, v1
    v_lshl_add_u32 v196, v196, 3, s7
    v_and_b32 v197, 15, v1
    v_mul_u32_u24 v197, 272, v197
    v_add_u32 v197, v197, v196
    ds_read_b64 a[136:137], v197 offset:0
    ds_read_b64 a[146:147], v196 offset:4288
    ds_read_b64 a[138:139], v197 offset:32
    ds_read_b64 a[148:149], v196 offset:4320
    ds_read_b64 a[140:141], v197 offset:64
    ds_read_b64 a[150:151], v196 offset:4352
    ds_read_b64 a[142:143], v197 offset:96
    ds_read_b64 a[152:153], v196 offset:4384
    ds_read_b64 a[144:145], v197 offset:128
    ds_read_b64 a[154:155], v196 offset:4416
    s_cmp_lg_u32 s46, 0
    s_cbranch_scc1 LA_ng
    v_cvt_pk_bf16_f32 v197, v112, v113
    v_lshlrev_b32 v112, 16, v197
    v_and_b32 v113, 0xffff0000, v197
    v_mul_f32 v112, 0xbfb8aa3b, v112
    v_mul_f32 v113, 0xbfb8aa3b, v113
    v_exp_f32 v112, v112
    v_exp_f32 v113, v113
    s_nop 0
    v_add_f32 v112, 1.0, v112
    v_add_f32 v113, 1.0, v113
    v_rcp_f32 v112, v112
    v_rcp_f32 v113, v113
    s_nop 0
    v_cvt_pk_bf16_f32 v197, v112, v113
    v_lshl_or_b32 v112, v197, 16, v237
    v_and_b32 v113, 0xffff0000, v197
    v_or_b32 v113, v113, v237
    v_cvt_pk_bf16_f32 v197, v114, v115
    v_lshlrev_b32 v114, 16, v197
    v_and_b32 v115, 0xffff0000, v197
    v_mul_f32 v114, 0xbfb8aa3b, v114
    v_mul_f32 v115, 0xbfb8aa3b, v115
    v_exp_f32 v114, v114
    v_exp_f32 v115, v115
    s_nop 0
    v_add_f32 v114, 1.0, v114
    v_add_f32 v115, 1.0, v115
    v_rcp_f32 v114, v114
    v_rcp_f32 v115, v115
    s_nop 0
    v_cvt_pk_bf16_f32 v197, v114, v115
    v_lshl_or_b32 v114, v197, 16, v237
    v_and_b32 v115, 0xffff0000, v197
    v_or_b32 v115, v115, v237
    buffer_store_dwordx4 v[112:115], v212, s[20:23], s41 offen sc1
LA_ng:
    s_add_u32 s95, s95, 20480
    buffer_load_dwordx4 a[128:131], v29, s[20:23], s95 offen sc1
    s_add_u32 s95, s95, 20480
    buffer_load_dwordx4 a[132:135], v29, s[20:23], s95 offen sc1
    s_add_u32 s95, s95, 20480
    buffer_load_dwordx4 v[152:155], v29, s[20:23], s95 offen sc1
    v_mov_b32 v11, v223
    v_mov_b32 v12, v224
    s_add_u32 s79, s29, 0
    s_and_b32 s79, s79, 3
    s_add_u32 s80, s29, 1
    s_and_b32 s80, s80, 3
    s_add_u32 s81, s29, 2
    s_and_b32 s81, s81, 3
    s_add_u32 s82, s29, 3
    s_and_b32 s82, s82, 3
    s_mul_i32 s31, s79, 61440
    v_add_u32 v2, s31, v220
    s_mul_i32 s31, s80, 61440
    v_add_u32 v3, s31, v220
    s_mul_i32 s31, s81, 61440
    v_add_u32 v4, s31, v220
    s_mul_i32 s31, s82, 61440
    v_add_u32 v5, s31, v220
    s_mul_i32 s7, s28, 245760
    s_lshl_b32 s92, s84, 11
    s_add_u32 s64, s7, s92
    s_lshl_b32 s95, s87, 10
    s_add_u32 s95, s95, 8388608
    buffer_load_dwordx4 v[156:159], v29, s[20:23], s95 offen sc1
    s_add_u32 s95, s95, 20480
    buffer_load_dwordx4 v[160:163], v29, s[20:23], s95 offen sc1
    s_add_u32 s95, s95, 20480
    buffer_load_dwordx4 v[164:167], v29, s[20:23], s95 offen sc1
    s_add_u32 s95, s95, 20480
    buffer_load_dwordx4 v[168:171], v29, s[20:23], s95 offen sc1
    s_add_u32 s95, s95, 20480
    buffer_load_dwordx4 v[172:175], v29, s[20:23], s95 offen sc1
    s_lshl_b32 s95, s88, 10
    s_add_u32 s95, s95, 8388608
    buffer_load_dwordx4 v[176:179], v29, s[20:23], s95 offen sc1
    s_add_u32 s95, s95, 20480
    buffer_load_dwordx4 v[180:183], v29, s[20:23], s95 offen sc1
    s_add_u32 s95, s95, 20480
    buffer_load_dwordx4 v[184:187], v29, s[20:23], s95 offen sc1
    s_add_u32 s95, s95, 20480
    buffer_load_dwordx4 v[188:191], v29, s[20:23], s95 offen sc1
    s_add_u32 s95, s95, 20480
    buffer_load_dwordx4 v[192:195], v29, s[20:23], s95 offen sc1
    s_mul_i32 s50, s87, 10240
    s_add_u32 s50, s50, 11534336
    buffer_load_dwordx4 a[40:43], v26, s[20:23], s50 offen offset:0 sc1
    buffer_load_dwordx4 a[44:47], v26, s[20:23], s50 offen offset:2048 sc1
    s_cmp_lg_u32 s3, 0
    s_cbranch_scc1 LA_ge
    s_mov_b32 s96, 0
LA_gr:
    s_mov_b32 s7, s36
    buffer_load_dwordx4 v[32:35], v222, s[20:23], s7 offen sc1
    s_add_u32 s7, s7, 6720
    buffer_load_dwordx4 v[36:39], v222, s[20:23], s7 offen sc1
    s_add_u32 s7, s7, 6720
    buffer_load_dwordx4 v[40:43], v222, s[20:23], s7 offen sc1
    s_add_u32 s7, s7, 6720
    buffer_load_dwordx4 v[44:47], v222, s[20:23], s7 offen sc1
    s_add_u32 s7, s7, 6720
    buffer_load_dwordx4 v[48:51], v222, s[20:23], s7 offen sc1
    s_add_u32 s7, s7, 6720
    buffer_load_dwordx4 v[52:55], v222, s[20:23], s7 offen sc1
    s_add_u32 s7, s7, 6720
    buffer_load_dwordx4 v[56:59], v222, s[20:23], s7 offen sc1
    s_add_u32 s7, s7, 6720
    buffer_load_dwordx4 v[60:63], v222, s[20:23], s7 offen sc1
    s_waitcnt vmcnt(0)
    v_xor_b32 v32, v32, v237
    v_xor_b32 v34, v34, v237
    v_or_b32 v196, v32, v34
    v_xor_b32 v36, v36, v237
    v_xor_b32 v38, v38, v237
    v_pk_add_f32 v[32:33], v[32:33], v[36:37]
    v_or3_b32 v196, v196, v36, v38
    v_pk_add_f32 v[34:35], v[34:35], v[38:39]
    v_xor_b32 v40, v40, v237
    v_xor_b32 v42, v42, v237
    v_pk_add_f32 v[32:33], v[32:33], v[40:41]
    v_or3_b32 v196, v196, v40, v42
    v_pk_add_f32 v[34:35], v[34:35], v[42:43]
    v_xor_b32 v44, v44, v237
    v_xor_b32 v46, v46, v237
    v_pk_add_f32 v[32:33], v[32:33], v[44:45]
    v_or3_b32 v196, v196, v44, v46
    v_pk_add_f32 v[34:35], v[34:35], v[46:47]
    v_xor_b32 v48, v48, v237
    v_xor_b32 v50, v50, v237
    v_pk_add_f32 v[32:33], v[32:33], v[48:49]
    v_or3_b32 v196, v196, v48, v50
    v_pk_add_f32 v[34:35], v[34:35], v[50:51]
    v_xor_b32 v52, v52, v237
    v_xor_b32 v54, v54, v237
    v_pk_add_f32 v[32:33], v[32:33], v[52:53]
    v_or3_b32 v196, v196, v52, v54
    v_pk_add_f32 v[34:35], v[34:35], v[54:55]
    v_xor_b32 v56, v56, v237
    v_xor_b32 v58, v58, v237
    v_pk_add_f32 v[32:33], v[32:33], v[56:57]
    v_or3_b32 v196, v196, v56, v58
    v_pk_add_f32 v[34:35], v[34:35], v[58:59]
    v_xor_b32 v60, v60, v237
    v_xor_b32 v62, v62, v237
    v_pk_add_f32 v[32:33], v[32:33], v[60:61]
    v_or3_b32 v196, v196, v60, v62
    v_pk_add_f32 v[34:35], v[34:35], v[62:63]
    v_and_b32 v196, 0xff, v196
    v_cmp_ne_u32 vcc, 0, v196
    s_add_u32 s96, s96, 1
    s_cmp_gt_u32 s96, 0x20000
    s_cbranch_scc1 LA_gd
    s_cbranch_vccnz LA_gr
LA_gd:
    v_mov_b64 v[36:37], v[32:33]
    v_mov_b64 v[38:39], v[34:35]
    s_nop 0
    v_permlane32_swap_b32 v32, v36
    v_permlane32_swap_b32 v33, v37
    v_permlane32_swap_b32 v34, v38
    v_permlane32_swap_b32 v35, v39
    v_pk_add_f32 v[32:33], v[32:33], v[36:37]
    v_pk_add_f32 v[34:35], v[34:35], v[38:39]
    v_cvt_pk_bf16_f32 v36, v32, v33
    v_cvt_pk_bf16_f32 v37, v34, v35
    v_lshl_or_b32 v32, v36, 16, v237
    v_and_b32 v33, 0xffff0000, v36
    v_lshl_or_b32 v34, v37, 16, v237
    v_and_b32 v35, 0xffff0000, v37
    s_mov_b32 exec_hi, 0
    buffer_store_dwordx4 v[32:35], v220, s[20:23], s34 offen sc1
    s_mov_b32 exec_hi, -1
LA_ge:
    s_barrier
    buffer_load_dwordx4 a[48:51], v27, s[20:23], s50 offen offset:0 sc1
    buffer_load_dwordx4 a[52:55], v27, s[20:23], s50 offen offset:2048 sc1
    buffer_load_dwordx4 a[56:59], v28, s[20:23], s50 offen offset:0 sc1
    buffer_load_dwordx4 a[60:63], v26, s[20:23], s50 offen offset:1024 sc1
    buffer_load_dwordx4 a[64:67], v26, s[20:23], s50 offen offset:3072 sc1
    buffer_load_dwordx4 a[68:71], v27, s[20:23], s50 offen offset:1024 sc1
    buffer_load_dwordx4 a[72:75], v27, s[20:23], s50 offen offset:3072 sc1
    buffer_load_dwordx4 a[76:79], v28, s[20:23], s50 offen offset:1024 sc1
    s_mul_i32 s50, s86, 10240
    s_add_u32 s50, s50, 11534336
    buffer_load_dwordx4 a[0:3], v26, s[20:23], s50 offen offset:0 sc1
    buffer_load_dwordx4 a[4:7], v26, s[20:23], s50 offen offset:2048 sc1
    buffer_load_dwordx4 a[8:11], v27, s[20:23], s50 offen offset:0 sc1
    buffer_load_dwordx4 a[12:15], v27, s[20:23], s50 offen offset:2048 sc1
    buffer_load_dwordx4 a[16:19], v28, s[20:23], s50 offen offset:0 sc1
    buffer_load_dwordx4 a[20:23], v26, s[20:23], s50 offen offset:1024 sc1
    buffer_load_dwordx4 a[24:27], v26, s[20:23], s50 offen offset:3072 sc1
    buffer_load_dwordx4 a[28:31], v27, s[20:23], s50 offen offset:1024 sc1
    buffer_load_dwordx4 a[32:35], v27, s[20:23], s50 offen offset:3072 sc1
    buffer_load_dwordx4 a[36:39], v28, s[20:23], s50 offen offset:1024 sc1
    s_mul_i32 s50, s88, 10240
    s_add_u32 s50, s50, 11534336
    buffer_load_dwordx4 a[156:159], v26, s[20:23], s50 offen offset:1024 sc1
    buffer_load_dwordx4 a[240:243], v26, s[20:23], s50 offen offset:3072 sc1
    buffer_load_dwordx4 a[244:247], v27, s[20:23], s50 offen offset:1024 sc1
    buffer_load_dwordx4 a[248:251], v27, s[20:23], s50 offen offset:3072 sc1
    buffer_load_dwordx4 a[252:255], v28, s[20:23], s50 offen offset:1024 sc1
    s_cmp_eq_u32 s3, 0
    s_cselect_b32 s7, 0, 1073741824
    s_mov_b64 exec, 0xff00000
    v_mov_b32 v15, 0
    buffer_atomic_add v15, v12, s[20:23], s7 offen sc0 sc1
    s_mov_b64 exec, -1
    s_waitcnt vmcnt(0)
    s_branch LK2
.p2align 12
.fill 640, 4, 0xbf800000
LB_rest:
    s_mov_b32 s16, s52
    s_and_b32 s17, s53, 0xffff
    s_mov_b32 s20, s62
    s_and_b32 s21, s63, 0xffff
    s_mov_b32 s22, 13238272
    s_mov_b32 s23, 0x20000
    s_add_u32 s92, s62, 11272192
    s_addc_u32 s93, s63, 0
    s_load_dword s6, s[92:93], 0
    s_add_u32 s66, s65, 128
    s_cmp_eq_u32 s66, 640
    s_cselect_b32 s66, 0, s66
    s_add_u32 s67, s66, 128
    s_cmp_eq_u32 s67, 640
    s_cselect_b32 s67, 0, s67
    s_add_u32 s68, s67, 128
    s_cmp_eq_u32 s68, 640
    s_cselect_b32 s68, 0, s68
    s_add_u32 s69, s64, 640
    s_add_u32 s70, s65, 640
    s_add_u32 s71, s66, 640
    s_add_u32 s72, s67, 640
    s_add_u32 s73, s68, 640
    v_and_b32 v52, 15, v1
    v_lshrrev_b32 v53, 4, v1
    v_lshrrev_b32 v54, 1, v52
    v_xor_b32 v54, v54, v53
    v_lshlrev_b32 v54, 4, v54
    v_lshl_add_u32 v56, v52, 7, v54
    v_xor_b32 v57, 64, v56
    v_add_u32 v16, s89, v56
    v_add_u32 v17, s89, v57
    v_bfe_u32 v54, v1, 2, 2
    v_lshl_add_u32 v54, v53, 3, v54
    v_and_b32 v55, 1, v53
    v_lshlrev_b32 v55, 2, v55
    v_add_u32 v58, v54, v55
    v_xor_b32 v55, 4, v55
    v_add_u32 v59, v54, v55
    v_mul_u32_u24 v58, 160, v58
    v_mul_u32_u24 v59, 160, v59
    v_and_b32 v60, 3, v1
    v_mul_u32_u24 v61, 40, v60
    v_add_u32 v62, v58, v61
    v_add_u32 v63, v59, v61
    v_add_u32 v22, 65536, v62
    v_add_u32 v23, 65536, v63
    v_add_u32 v24, 106496, v62
    v_add_u32 v25, 106496, v63
    s_mul_i32 s92, s29, 204800
    v_lshl_add_u32 v26, v1, 4, s92
    v_add_u32 v27, 4096, v26
    v_add_u32 v28, 8192, v26
    s_lshr_b32 s92, s92, 1
    v_lshl_add_u32 v29, v1, 4, s92
    v_add_u32 v18, 65536, v56
    v_add_u32 v19, 65536, v57
    v_add_u32 v20, 106496, v56
    v_add_u32 v21, 106496, v57
    s_lshl_b32 s92, s5, 5
    s_add_u32 s93, s92, 15
    s_sub_u32 s93, s93, s4
    s_mul_i32 s60, s93, 640
    s_add_u32 s60, s60, 10747904
    v_add_u32 v184, 0, v1
    v_mul_u32_u24 v185, 6554, v184
    v_lshrrev_b32 v185, 16, v185
    v_mul_u32_u24 v186, 10, v185
    v_sub_u32 v186, v184, v186
    v_lshrrev_b32 v187, 1, v185
    v_and_b32 v187, 4, v187
    v_xor_b32 v185, v185, v187
    v_mul_u32_u24 v185, 3840, v185
    v_lshl_add_u32 v186, v186, 4, s95
    v_add_u32 v11, v185, v186
    v_add_u32 v184, 64, v1
    v_mul_u32_u24 v185, 6554, v184
    v_lshrrev_b32 v185, 16, v185
    v_mul_u32_u24 v186, 10, v185
    v_sub_u32 v186, v184, v186
    v_lshrrev_b32 v187, 1, v185
    v_and_b32 v187, 4, v187
    v_xor_b32 v185, v185, v187
    v_mul_u32_u24 v185, 3840, v185
    v_lshl_add_u32 v186, v186, 4, s95
    v_subrev_u32 v185, 1024, v185
    v_add_u32 v12, v185, v186
    v_add_u32 v184, 128, v1
    v_mul_u32_u24 v185, 6554, v184
    v_lshrrev_b32 v185, 16, v185
    v_mul_u32_u24 v186, 10, v185
    v_sub_u32 v186, v184, v186
    v_lshrrev_b32 v187, 1, v185
    v_and_b32 v187, 4, v187
    v_xor_b32 v185, v185, v187
    v_mul_u32_u24 v185, 3840, v185
    v_lshl_add_u32 v186, v186, 4, s95
    v_subrev_u32 v185, 2048, v185
    v_add_u32 v13, v185, v186
    v_add_u32 v184, 192, v1
    v_mul_u32_u24 v185, 6554, v184
    v_lshrrev_b32 v185, 16, v185
    v_mul_u32_u24 v186, 10, v185
    v_sub_u32 v186, v184, v186
    v_lshrrev_b32 v187, 1, v185
    v_and_b32 v187, 4, v187
    v_xor_b32 v185, v185, v187
    v_mul_u32_u24 v185, 3840, v185
    v_lshl_add_u32 v186, v186, 4, s95
    v_subrev_u32 v185, 3072, v185
    v_add_u32 v14, v185, v186
    v_add_u32 v184, 256, v1
    v_mul_u32_u24 v185, 6554, v184
    v_lshrrev_b32 v185, 16, v185
    v_mul_u32_u24 v186, 10, v185
    v_sub_u32 v186, v184, v186
    v_lshrrev_b32 v187, 1, v185
    v_and_b32 v187, 4, v187
    v_xor_b32 v185, v185, v187
    v_mul_u32_u24 v185, 3840, v185
    v_lshl_add_u32 v186, v186, 4, s95
    v_add_u32 v15, v185, v186
    s_mul_i32 s76, s66, 1920
    s_mul_i32 s77, s67, 1920
    s_mul_i32 s78, s68, 1920
    s_mul_i32 s79, s69, 1920
    s_mul_i32 s80, s70, 1920
    s_mul_i32 s81, s71, 1920
    s_mul_i32 s82, s72, 1920
    s_mul_i32 s83, s73, 1920
    s_cmp_ge_u32 s3, 2
    s_cselect_b32 s74, s75, s74
    s_cselect_b32 s75, s77, s76
    s_cselect_b32 s76, s79, s78
    s_cselect_b32 s77, s81, s80
    s_cselect_b32 s78, s83, s82
    v_lshrrev_b32 v192, 5, v0
    v_mul_u32_u24 v192, 27, v192
    v_and_b32 v193, 31, v0
    v_add3_u32 v192, v192, v193, 0
    v_add_u32 v192, 0, v192
    v_cmp_gt_u32 s[34:35], 27, v193
    v_cmp_gt_u32 vcc, 420, v192
    s_nop 0
    s_and_b64 vcc, vcc, s[34:35]
    v_mul_u32_u24 v193, 3121, v192
    v_lshrrev_b32 v193, 16, v193
    v_mul_u32_u24 v194, 21, v193
    v_sub_u32 v192, v192, v194
    v_mul_u32_u24 v194, 13108, v193
    v_lshrrev_b32 v194, 16, v194
    v_mul_u32_u24 v195, 5, v194
    v_sub_u32 v193, v193, v195
    v_mul_u32_u24 v194, 21, v194
    v_add_u32 v192, v192, v194
    v_mul_u32_u24 v192, 48, v192
    v_lshl_add_u32 v192, v193, 3, v192
    v_add_u32 v192, 147456, v192
    v_mov_b32 v193, 162816
    v_cndmask_b32 v192, v193, v192, vcc
    v_accvgpr_write_b32 a248, v192
    v_lshrrev_b32 v192, 5, v0
    v_mul_u32_u24 v192, 27, v192
    v_and_b32 v193, 31, v0
    v_add3_u32 v192, v192, v193, 0
    v_add_u32 v192, 216, v192
    v_cmp_gt_u32 s[34:35], 27, v193
    v_cmp_gt_u32 vcc, 420, v192
    s_nop 0
    s_and_b64 vcc, vcc, s[34:35]
    v_mul_u32_u24 v193, 3121, v192
    v_lshrrev_b32 v193, 16, v193
    v_mul_u32_u24 v194, 21, v193
    v_sub_u32 v192, v192, v194
    v_mul_u32_u24 v194, 13108, v193
    v_lshrrev_b32 v194, 16, v194
    v_mul_u32_u24 v195, 5, v194
    v_sub_u32 v193, v193, v195
    v_mul_u32_u24 v194, 21, v194
    v_add_u32 v192, v192, v194
    v_mul_u32_u24 v192, 48, v192
    v_lshl_add_u32 v192, v193, 3, v192
    v_add_u32 v192, 147456, v192
    v_mov_b32 v193, 162816
    v_cndmask_b32 v192, v193, v192, vcc
    v_accvgpr_write_b32 a255, v192
    s_add_u32 s92, s60, 640
    s_add_u32 s36, s62, s92
    s_addc_u32 s37, s63, 0
    s_and_b32 s37, s37, 0xffff
    s_movk_i32 s38, 10240
    s_mov_b32 s39, 0x20000
    s_movk_i32 s41, 3840
    s_movk_i32 s46, 7680
    s_movk_i32 s92, 80
    v_cmp_gt_u32 s[34:35], s92, v0
    v_lshlrev_b32 v192, 3, v0
    v_mov_b32 v193, 1073741824
    v_cndmask_b32 v192, v193, v192, s[34:35]
    v_accvgpr_write_b32 a247, v192
    v_min_u32 v192, 79, v0
    v_lshlrev_b32 v192, 3, v192
    v_add_u32 v192, 10240, v192
    v_accvgpr_write_b32 a246, v192
    v_and_b32 v184, 15, v1
    v_lshrrev_b32 v185, 4, v1
    v_mul_u32_u24 v186, 48, v184
    v_add_u32 v186, 147456, v186
    v_accvgpr_write_b32 a245, v186
    v_lshrrev_b32 v186, 4, v0
    v_mul_u32_u24 v186, 640, v186
    v_lshl_add_u32 v186, v184, 3, v186
    v_add_u32 v186, 152576, v186
    v_accvgpr_write_b32 a251, v186
    v_mul_u32_u24 v186, 640, v185
    v_lshl_add_u32 v186, v184, 3, v186
    v_add_u32 v186, s89, v186
    v_accvgpr_write_b32 a244, v186
    v_lshlrev_b32 v186, 3, v184
    v_add_u32 v186, 162816, v186
    v_accvgpr_write_b32 a249, v186
    v_mul_u32_u24 v186, 21, v185
    v_and_b32 v187, 3, v184
    v_add_u32 v186, v186, v187
    v_mul_u32_u24 v186, 48, v186
    v_add_u32 v186, 147456, v186
    v_mov_b32 v188, 151552
    v_lshrrev_b32 v187, 2, v184
    v_cmp_eq_u32 vcc, v187, v185
    s_nop 1
    v_cndmask_b32 v186, v188, v186, vcc
    v_accvgpr_write_b32 a250, v186
    v_bfe_u32 v186, v184, 1, 2
    v_xor_b32 v186, v186, v185
    v_lshlrev_b32 v186, 4, v186
    v_lshl_add_u32 v186, v184, 6, v186
    s_add_u32 s92, s89, 10240
    v_add_u32 v186, s92, v186
    v_accvgpr_write_b32 a240, v186
    v_bfe_u32 v186, v1, 2, 2
    v_lshrrev_b32 v187, 1, v185
    v_lshl_add_u32 v188, v187, 3, v186
    v_lshlrev_b32 v188, 6, v188
    v_and_b32 v189, 1, v185
    v_lshl_add_u32 v188, v189, 3, v188
    v_add_u32 v188, s92, v188
    v_lshrrev_b32 v186, 1, v186
    v_and_b32 v185, 3, v1
    v_xor_b32 v186, v186, v185
    v_lshl_add_u32 v185, v186, 4, v188
    v_accvgpr_write_b32 a241, v185
    v_xor_b32 v186, 2, v186
    v_lshl_add_u32 v185, v186, 4, v188
    v_add_u32 v185, 256, v185
    v_accvgpr_write_b32 a242, v185
    v_mul_u32_u24 v189, 61440, v189
    v_lshl_add_u32 v189, v187, 8, v189
    v_lshl_add_u32 v189, v184, 4, v189
    v_accvgpr_write_b32 a243, v189
    s_lshl_b32 s92, s4, 3
    s_lshl_b32 s93, s3, 1
    s_add_u32 s92, s92, s93
    s_mul_i32 s92, s92, 61440
    s_mul_i32 s93, s5, 2560
    s_add_u32 s54, s92, s93
    s_add_u32 s55, s54, 20480
    s_add_u32 s56, s54, 40960
    s_add_u32 s57, s56, 61440
    s_waitcnt lgkmcnt(0)
    s_add_u32 s6, s6, 0x9e3779b1
    s_and_b32 s47, s6, 0xff
    s_waitcnt vmcnt(9)
    s_add_u32 m0, s89, 4096
    s_nop 0
    buffer_load_dwordx4 v2, s[8:11], s65 offen offset:0 lds
    buffer_load_dwordx4 v3, s[8:11], s65 offen offset:1024 lds
    v_mul_f32 v178, 1069066811, v178
    v_exp_f32 v178, v178
    s_nop 0
    v_cvt_pk_bf16_f32 v178, v178, v178
    v_lshlrev_b32 v178, 16, v178
    v_mul_f32 v192, v178, v176
    v_mul_f32 v193, v178, v177
    v_mul_f32 v192, 1069066811, v192
    v_mul_f32 v193, 0.15915494, v193
    v_exp_f32 v192, v192
    v_fract_f32 v193, v193
    v_cos_f32 v194, v193
    v_sin_f32 v195, v193
    s_nop 0
    v_mul_f32 v180, v192, v194
    v_mul_f32 v195, v192, v195
    v_sub_f32 v181, 0, v195
    v_add_f32 v192, -1.0, v180
    v_mul_f32 v193, v176, v176
    v_fma_f32 v193, v177, v177, v193
    v_rcp_f32 v193, v193
    v_mul_f32 v188, v192, v176
    v_fma_f32 v188, v195, v177, v188
    v_mul_f32 v189, v195, v176
    v_fma_f32 v189, -v192, v177, v189
    v_add_f32 v193, v193, v193
    v_mul_f32 v188, v188, v193
    v_mul_f32 v189, v189, v193
    v_pk_mul_f32 v[182:183], v[180:181], v[180:181] op_sel_hi:[1,0]
    v_pk_fma_f32 v[182:183], v[180:181], v[180:181], v[182:183] op_sel:[1,1,0] op_sel_hi:[0,1,1] neg_lo:[0,1,0]
    v_pk_mul_f32 v[184:185], v[180:181], v[182:183] op_sel_hi:[1,0]
    v_pk_fma_f32 v[184:185], v[180:181], v[182:183], v[184:185] op_sel:[1,1,0] op_sel_hi:[0,1,1] neg_lo:[0,1,0]
    v_pk_mul_f32 v[186:187], v[182:183], v[182:183] op_sel_hi:[1,0]
    v_pk_fma_f32 v[186:187], v[182:183], v[182:183], v[186:187] op_sel:[1,1,0] op_sel_hi:[0,1,1] neg_lo:[0,1,0]
    v_pk_mul_f32 v[250:251], v[186:187], v[186:187] op_sel_hi:[1,0]
    v_pk_fma_f32 v[250:251], v[186:187], v[186:187], v[250:251] op_sel:[1,1,0] op_sel_hi:[0,1,1] neg_lo:[0,1,0]
    v_mul_u32_u24 v192, 48, v0
    v_add_u32 v192, 147456, v192
    v_cmp_gt_u32 vcc, 80, v0
    s_nop 0
    s_and_saveexec_b64 s[92:93], vcc
    s_cbranch_execz LB_nopar
    v_lshlrev_b32 v194, 3, v0
    v_mov_b32 v202, s47
    v_mov_b32 v203, s47
    s_mul_i32 s94, s4, 1280
    s_add_u32 s94, s94, s60
    buffer_store_dwordx2 v[202:203], v194, s[20:23], s94 offen offset:640 sc1
    v_mov_b64 v[190:191], 0
    v_mov_b64 v[204:205], 0
    v_mov_b64 v[206:207], 0
    v_lshlrev_b32 v195, 4, v0
    v_add_u32 v195, 151296, v195
    ds_write_b128 v195, v[204:207]
    ds_write_b128 v192, v[180:183] offset:0
    ds_write_b128 v192, v[184:187] offset:16
    ds_write_b128 v192, v[188:191] offset:32
    v_pk_mul_f32 v[196:197], v[250:251], v[250:251] op_sel_hi:[1,0]
    v_pk_fma_f32 v[196:197], v[250:251], v[250:251], v[196:197] op_sel:[1,1,0] op_sel_hi:[0,1,1] neg_lo:[0,1,0]
    v_pk_mul_f32 v[198:199], v[196:197], v[196:197] op_sel_hi:[1,0]
    v_pk_fma_f32 v[198:199], v[196:197], v[196:197], v[198:199] op_sel:[1,1,0] op_sel_hi:[0,1,1] neg_lo:[0,1,0]
    v_pk_mul_f32 v[196:197], v[198:199], v[198:199] op_sel_hi:[1,0]
    v_pk_fma_f32 v[196:197], v[198:199], v[198:199], v[196:197] op_sel:[1,1,0] op_sel_hi:[0,1,1] neg_lo:[0,1,0]
    v_pk_mul_f32 v[248:249], v[196:197], v[196:197] op_sel_hi:[1,0]
    v_pk_fma_f32 v[248:249], v[196:197], v[196:197], v[248:249] op_sel:[1,1,0] op_sel_hi:[0,1,1] neg_lo:[0,1,0]
LB_nopar:
    s_mov_b64 exec, s[92:93]
    buffer_load_dwordx4 v4, s[8:11], s65 offen offset:2048 lds
    buffer_load_dwordx4 v5, s[8:11], s65 offen offset:3072 lds
    s_waitcnt lgkmcnt(0)
    s_waitcnt vmcnt(4)
    s_barrier
    ds_read_b128 a[0:3], v16 offset:0
    ds_read_b128 a[4:7], v16 offset:2048
    ds_read_b128 v[152:155], v18 offset:0
    ds_read_b128 v[156:159], v18 offset:10240
    ds_read_b128 v[160:163], v18 offset:2048
    ds_read_b128 v[164:167], v18 offset:12288
    ds_read_b128 v[168:171], v18 offset:4096
    ds_read_b128 v[172:175], v18 offset:14336
    s_waitcnt lgkmcnt(5)
    v_mfma_f32_16x16x32_bf16 v[32:35], a[0:3], v[152:155], 0
    s_add_u32 m0, s90, 20480
    s_mov_b32 s24, s48
    v_mfma_f32_16x16x32_bf16 v[36:39], a[4:7], v[152:155], 0
    buffer_load_dwordx4 v6, s[12:15], s65 offen offset:0 lds
    s_waitcnt lgkmcnt(4)
    v_mfma_f32_16x16x32_bf16 v[40:43], a[0:3], v[156:159], 0
    ds_read_b128 v[152:155], v18 offset:6144
    v_mfma_f32_16x16x32_bf16 v[44:47], a[4:7], v[156:159], 0
    buffer_load_dwordx4 v7, s[12:15], s65 offen offset:1024 lds
    s_waitcnt lgkmcnt(4)
    v_mfma_f32_16x16x32_bf16 v[48:51], a[0:3], v[160:163], 0
    ds_read_b128 v[156:159], v18 offset:16384
    s_and_b32 s25, s49, 0xffff
    v_mfma_f32_16x16x32_bf16 v[52:55], a[4:7], v[160:163], 0
    buffer_load_dwordx4 v8, s[12:15], s65 offen offset:2048 lds
    s_waitcnt lgkmcnt(4)
    v_mfma_f32_16x16x32_bf16 v[56:59], a[0:3], v[164:167], 0
    ds_read_b128 v[160:163], v18 offset:8192
    s_mov_b32 s26, 1280
    v_mfma_f32_16x16x32_bf16 v[60:63], a[4:7], v[164:167], 0
    buffer_load_dwordx4 v9, s[12:15], s65 offen offset:3072 lds
    s_waitcnt lgkmcnt(4)
    v_mfma_f32_16x16x32_bf16 v[64:67], a[0:3], v[168:171], 0
    ds_read_b128 v[164:167], v18 offset:18432
    s_add_u32 m0, s90, 24576
    v_mfma_f32_16x16x32_bf16 v[68:71], a[4:7], v[168:171], 0
    buffer_load_dwordx4 v10, s[12:15], s65 offen lds
    s_waitcnt lgkmcnt(4)
    v_mfma_f32_16x16x32_bf16 v[72:75], a[0:3], v[172:175], 0
    ds_read_b128 a[8:11], v17 offset:0
    ds_read_b128 a[12:15], v17 offset:2048
    ds_read_b128 v[168:171], v19 offset:0
    s_add_u32 m0, s89, 8192
    s_mov_b32 s27, 0x20000
    v_mfma_f32_16x16x32_bf16 v[76:79], a[4:7], v[172:175], 0
    buffer_load_dwordx4 v2, s[8:11], s66 offen offset:0 lds
    s_waitcnt lgkmcnt(6)
    v_mfma_f32_16x16x32_bf16 v[80:83], a[0:3], v[152:155], 0
    ds_read_b128 v[172:175], v19 offset:10240
    s_add_u32 s7, s3, s29
    v_mfma_f32_16x16x32_bf16 v[84:87], a[4:7], v[152:155], 0
    buffer_load_dwordx4 v3, s[8:11], s66 offen offset:1024 lds
    s_waitcnt lgkmcnt(6)
    v_mfma_f32_16x16x32_bf16 v[88:91], a[0:3], v[156:159], 0
    ds_read_b128 v[152:155], v19 offset:2048
    v_mfma_f32_16x16x32_bf16 v[92:95], a[4:7], v[156:159], 0
    buffer_load_dwordx4 v4, s[8:11], s66 offen offset:2048 lds
    s_waitcnt lgkmcnt(6)
    v_mfma_f32_16x16x32_bf16 v[96:99], a[0:3], v[160:163], 0
    ds_read_b128 v[156:159], v19 offset:12288
    s_and_b32 s7, s7, 3
    v_mfma_f32_16x16x32_bf16 v[100:103], a[4:7], v[160:163], 0
    buffer_load_dwordx4 v5, s[8:11], s66 offen offset:3072 lds
    s_waitcnt lgkmcnt(6)
    v_mfma_f32_16x16x32_bf16 v[104:107], a[0:3], v[164:167], 0
    ds_read_b128 v[160:163], v19 offset:4096
    s_add_u32 m0, s90, 40960
    s_lshl_b32 s61, s28, 2
    v_mfma_f32_16x16x32_bf16 v[108:111], a[4:7], v[164:167], 0
    buffer_load_dwordx4 v6, s[12:15], s66 offen offset:0 lds
    s_waitcnt lgkmcnt(4)
    v_mfma_f32_16x16x32_bf16 v[32:35], a[8:11], v[168:171], v[32:35]
    ds_read_b128 v[164:167], v19 offset:14336
    v_mfma_f32_16x16x32_bf16 v[36:39], a[12:15], v[168:171], v[36:39]
    buffer_load_dwordx4 v7, s[12:15], s66 offen offset:1024 lds
    s_waitcnt lgkmcnt(4)
    v_mfma_f32_16x16x32_bf16 v[40:43], a[8:11], v[172:175], v[40:43]
    ds_read_b128 v[168:171], v19 offset:6144
    s_add_u32 s7, s7, s61
    v_mfma_f32_16x16x32_bf16 v[44:47], a[12:15], v[172:175], v[44:47]
    buffer_load_dwordx4 v8, s[12:15], s66 offen offset:2048 lds
    s_waitcnt lgkmcnt(4)
    v_mfma_f32_16x16x32_bf16 v[48:51], a[8:11], v[152:155], v[48:51]
    ds_read_b128 v[172:175], v19 offset:16384
    s_lshr_b32 s61, s7, 1
    v_mfma_f32_16x16x32_bf16 v[52:55], a[12:15], v[152:155], v[52:55]
    buffer_load_dwordx4 v9, s[12:15], s66 offen offset:3072 lds
    s_waitcnt lgkmcnt(4)
    v_mfma_f32_16x16x32_bf16 v[56:59], a[8:11], v[156:159], v[56:59]
    ds_read_b128 v[152:155], v19 offset:8192
    s_add_u32 m0, s90, 45056
    v_mfma_f32_16x16x32_bf16 v[60:63], a[12:15], v[156:159], v[60:63]
    buffer_load_dwordx4 v10, s[12:15], s66 offen lds
    s_waitcnt lgkmcnt(4)
    v_mfma_f32_16x16x32_bf16 v[64:67], a[8:11], v[160:163], v[64:67]
    ds_read_b128 v[156:159], v19 offset:18432
    s_lshl_b32 s61, s61, 5
    v_mfma_f32_16x16x32_bf16 v[68:71], a[12:15], v[160:163], v[68:71]
    s_waitcnt vmcnt(9)
    s_barrier
    ds_read_b128 a[16:19], v16 offset:4096
    s_waitcnt lgkmcnt(5)
    v_mfma_f32_16x16x32_bf16 v[72:75], a[8:11], v[164:167], v[72:75]
    ds_read_b128 a[20:23], v16 offset:6144
    s_and_b32 s40, s7, 1
    v_mfma_f32_16x16x32_bf16 v[76:79], a[12:15], v[164:167], v[76:79]
    ds_read_b128 v[160:163], v18 offset:20480
    s_waitcnt lgkmcnt(6)
    v_mfma_f32_16x16x32_bf16 v[80:83], a[8:11], v[168:171], v[80:83]
    ds_read_b128 v[164:167], v18 offset:30720
    s_add_u32 m0, s89, 12288
    v_mfma_f32_16x16x32_bf16 v[84:87], a[12:15], v[168:171], v[84:87]
    buffer_load_dwordx4 v2, s[8:11], s67 offen offset:0 lds
    s_waitcnt lgkmcnt(6)
    v_mfma_f32_16x16x32_bf16 v[88:91], a[8:11], v[172:175], v[88:91]
    ds_read_b128 v[168:171], v18 offset:22528
    s_lshl_b32 s40, s40, 1
    v_mfma_f32_16x16x32_bf16 v[92:95], a[12:15], v[172:175], v[92:95]
    ds_read_b128 v[172:175], v18 offset:32768
    s_waitcnt lgkmcnt(7)
    v_mfma_f32_16x16x32_bf16 v[96:99], a[8:11], v[152:155], v[96:99]
    s_add_u32 s61, s61, s40
    v_mfma_f32_16x16x32_bf16 v[100:103], a[12:15], v[152:155], v[100:103]
    buffer_load_dwordx4 v3, s[8:11], s67 offen offset:1024 lds
    s_waitcnt lgkmcnt(6)
    v_mfma_f32_16x16x32_bf16 v[104:107], a[8:11], v[156:159], v[104:107]
    ds_read_b128 v[152:155], v18 offset:24576
    v_mfma_f32_16x16x32_bf16 v[108:111], a[12:15], v[156:159], v[108:111]
    ds_read_b128 v[156:159], v18 offset:34816
    s_waitcnt lgkmcnt(5)
    v_mfma_f32_16x16x32_bf16 v[32:35], a[16:19], v[160:163], v[32:35]
    s_mul_i32 s61, s61, 1280
    v_mfma_f32_16x16x32_bf16 v[36:39], a[20:23], v[160:163], v[36:39]
    buffer_load_dwordx4 v4, s[8:11], s67 offen offset:2048 lds
    s_waitcnt lgkmcnt(4)
    v_mfma_f32_16x16x32_bf16 v[40:43], a[16:19], v[164:167], v[40:43]
    ds_read_b128 v[160:163], v18 offset:26624
    v_mfma_f32_16x16x32_bf16 v[44:47], a[20:23], v[164:167], v[44:47]
    ds_read_b128 v[164:167], v18 offset:36864
    s_mul_i32 s40, s29, 160
    s_waitcnt lgkmcnt(5)
    v_mfma_f32_16x16x32_bf16 v[48:51], a[16:19], v[168:171], v[48:51]
    v_mfma_f32_16x16x32_bf16 v[52:55], a[20:23], v[168:171], v[52:55]
    buffer_load_dwordx4 v5, s[8:11], s67 offen offset:3072 lds
    s_waitcnt lgkmcnt(4)
    v_mfma_f32_16x16x32_bf16 v[56:59], a[16:19], v[172:175], v[56:59]
    ds_read_b128 v[168:171], v18 offset:28672
    s_add_u32 s61, s61, s40
    v_mfma_f32_16x16x32_bf16 v[60:63], a[20:23], v[172:175], v[60:63]
    ds_read_b128 v[172:175], v18 offset:38912
    s_waitcnt lgkmcnt(5)
    v_mfma_f32_16x16x32_bf16 v[64:67], a[16:19], v[152:155], v[64:67]
    s_add_u32 m0, s90, 61440
    v_mfma_f32_16x16x32_bf16 v[68:71], a[20:23], v[152:155], v[68:71]
    buffer_load_dwordx4 v6, s[12:15], s67 offen offset:0 lds
    s_waitcnt lgkmcnt(4)
    v_mfma_f32_16x16x32_bf16 v[72:75], a[16:19], v[156:159], v[72:75]
    ds_read_b128 a[24:27], v17 offset:4096
    ds_read_b128 a[28:31], v17 offset:6144
    v_bfe_u32 v184, v1, 5, 1
    v_mfma_f32_16x16x32_bf16 v[76:79], a[20:23], v[156:159], v[76:79]
    ds_read_b128 v[152:155], v19 offset:20480
    s_waitcnt lgkmcnt(6)
    v_mfma_f32_16x16x32_bf16 v[80:83], a[16:19], v[160:163], v[80:83]
    ds_read_b128 v[156:159], v19 offset:30720
    v_bfe_u32 v185, v1, 4, 1
    v_mfma_f32_16x16x32_bf16 v[84:87], a[20:23], v[160:163], v[84:87]
    buffer_load_dwordx4 v7, s[12:15], s67 offen offset:1024 lds
    s_waitcnt lgkmcnt(6)
    v_mfma_f32_16x16x32_bf16 v[88:91], a[16:19], v[164:167], v[88:91]
    ds_read_b128 v[160:163], v19 offset:22528
    v_mfma_f32_16x16x32_bf16 v[92:95], a[20:23], v[164:167], v[92:95]
    ds_read_b128 v[164:167], v19 offset:32768
    v_lshl_add_u32 v184, v185, 2, v184
    s_waitcnt lgkmcnt(7)
    v_mfma_f32_16x16x32_bf16 v[96:99], a[16:19], v[168:171], v[96:99]
    v_mfma_f32_16x16x32_bf16 v[100:103], a[20:23], v[168:171], v[100:103]
    buffer_load_dwordx4 v8, s[12:15], s67 offen offset:2048 lds
    s_waitcnt lgkmcnt(6)
    v_mfma_f32_16x16x32_bf16 v[104:107], a[16:19], v[172:175], v[104:107]
    ds_read_b128 v[168:171], v19 offset:24576
    v_mul_u32_u24 v184, 1280, v184
    v_mfma_f32_16x16x32_bf16 v[108:111], a[20:23], v[172:175], v[108:111]
    ds_read_b128 v[172:175], v19 offset:34816
    s_waitcnt lgkmcnt(5)
    v_mfma_f32_16x16x32_bf16 v[32:35], a[24:27], v[152:155], v[32:35]
    v_mfma_f32_16x16x32_bf16 v[36:39], a[28:31], v[152:155], v[36:39]
    buffer_load_dwordx4 v9, s[12:15], s67 offen offset:3072 lds
    s_waitcnt lgkmcnt(4)
    v_mfma_f32_16x16x32_bf16 v[40:43], a[24:27], v[156:159], v[40:43]
    ds_read_b128 v[152:155], v19 offset:26624
    v_lshrrev_b32 v185, 4, v1
    v_mfma_f32_16x16x32_bf16 v[44:47], a[28:31], v[156:159], v[44:47]
    ds_read_b128 v[156:159], v19 offset:36864
    s_waitcnt lgkmcnt(5)
    v_mfma_f32_16x16x32_bf16 v[48:51], a[24:27], v[160:163], v[48:51]
    s_add_u32 m0, s90, 65536
    v_mul_u32_u24 v185, 17, v185
    v_mfma_f32_16x16x32_bf16 v[52:55], a[28:31], v[160:163], v[52:55]
    buffer_load_dwordx4 v10, s[12:15], s67 offen lds
    s_waitcnt lgkmcnt(4)
    v_mfma_f32_16x16x32_bf16 v[56:59], a[24:27], v[164:167], v[56:59]
    ds_read_b128 v[160:163], v19 offset:28672
    v_mfma_f32_16x16x32_bf16 v[60:63], a[28:31], v[164:167], v[60:63]
    ds_read_b128 v[164:167], v19 offset:38912
    v_sub_u32 v185, v1, v185
    s_waitcnt lgkmcnt(5)
    v_mfma_f32_16x16x32_bf16 v[64:67], a[24:27], v[168:171], v[64:67]
    v_mfma_f32_16x16x32_bf16 v[68:71], a[28:31], v[168:171], v[68:71]
    s_waitcnt vmcnt(9)
    s_barrier
    ds_read_b128 a[32:35], v16 offset:8192
    s_waitcnt lgkmcnt(5)
    v_mfma_f32_16x16x32_bf16 v[72:75], a[24:27], v[172:175], v[72:75]
    ds_read_b128 a[36:39], v16 offset:10240
    v_med3_i32 v185, v185, 0, 9
    v_mfma_f32_16x16x32_bf16 v[76:79], a[28:31], v[172:175], v[76:79]
    ds_read_b128 v[168:171], v20 offset:0
    s_waitcnt lgkmcnt(6)
    v_mfma_f32_16x16x32_bf16 v[80:83], a[24:27], v[152:155], v[80:83]
    ds_read_b128 v[172:175], v20 offset:10240
    s_add_u32 m0, s89, 0
    v_mfma_f32_16x16x32_bf16 v[84:87], a[28:31], v[152:155], v[84:87]
    buffer_load_dwordx4 v2, s[8:11], s68 offen offset:0 lds
    s_waitcnt lgkmcnt(6)
    v_mfma_f32_16x16x32_bf16 v[88:91], a[24:27], v[156:159], v[88:91]
    ds_read_b128 v[152:155], v20 offset:2048
    v_lshl_add_u32 v184, v185, 4, v184
    v_mfma_f32_16x16x32_bf16 v[92:95], a[28:31], v[156:159], v[92:95]
    ds_read_b128 v[156:159], v20 offset:12288
    s_waitcnt lgkmcnt(7)
    v_mfma_f32_16x16x32_bf16 v[96:99], a[24:27], v[160:163], v[96:99]
    v_accvgpr_write_b32 a252, v184
    v_mfma_f32_16x16x32_bf16 v[100:103], a[28:31], v[160:163], v[100:103]
    buffer_load_dwordx4 v3, s[8:11], s68 offen offset:1024 lds
    s_waitcnt lgkmcnt(6)
    v_mfma_f32_16x16x32_bf16 v[104:107], a[24:27], v[164:167], v[104:107]
    ds_read_b128 v[160:163], v20 offset:4096
    v_mfma_f32_16x16x32_bf16 v[108:111], a[28:31], v[164:167], v[108:111]
    ds_read_b128 v[164:167], v20 offset:14336
    s_waitcnt lgkmcnt(5)
    v_mfma_f32_16x16x32_bf16 v[32:35], a[32:35], v[168:171], v[32:35]
    s_lshr_b32 s92, s28, 1
    v_mfma_f32_16x16x32_bf16 v[36:39], a[36:39], v[168:171], v[36:39]
    buffer_load_dwordx4 v4, s[8:11], s68 offen offset:2048 lds
    s_waitcnt lgkmcnt(4)
    v_mfma_f32_16x16x32_bf16 v[40:43], a[32:35], v[172:175], v[40:43]
    ds_read_b128 v[168:171], v20 offset:6144
    v_mfma_f32_16x16x32_bf16 v[44:47], a[36:39], v[172:175], v[44:47]
    ds_read_b128 v[172:175], v20 offset:16384
    v_lshl_add_u32 v184, v1, 4, s92
    s_waitcnt lgkmcnt(5)
    v_mfma_f32_16x16x32_bf16 v[48:51], a[32:35], v[152:155], v[48:51]
    v_mfma_f32_16x16x32_bf16 v[52:55], a[36:39], v[152:155], v[52:55]
    buffer_load_dwordx4 v5, s[8:11], s68 offen offset:3072 lds
    s_waitcnt lgkmcnt(4)
    v_mfma_f32_16x16x32_bf16 v[56:59], a[32:35], v[156:159], v[56:59]
    ds_read_b128 v[152:155], v20 offset:8192
    v_mul_u32_u24 v184, 128, v184
    v_mfma_f32_16x16x32_bf16 v[60:63], a[36:39], v[156:159], v[60:63]
    ds_read_b128 v[156:159], v20 offset:18432
    s_waitcnt lgkmcnt(5)
    v_mfma_f32_16x16x32_bf16 v[64:67], a[32:35], v[160:163], v[64:67]
    s_add_u32 m0, s90, 0
    v_mfma_f32_16x16x32_bf16 v[68:71], a[36:39], v[160:163], v[68:71]
    buffer_load_dwordx4 v6, s[12:15], s68 offen offset:0 lds
    s_waitcnt lgkmcnt(4)
    v_mfma_f32_16x16x32_bf16 v[72:75], a[32:35], v[164:167], v[72:75]
    ds_read_b128 a[40:43], v17 offset:8192
    ds_read_b128 a[44:47], v17 offset:10240
    v_add_u32 v186, 11108352, v184
    v_mfma_f32_16x16x32_bf16 v[76:79], a[36:39], v[164:167], v[76:79]
    ds_read_b128 v[160:163], v21 offset:0
    s_waitcnt lgkmcnt(6)
    v_mfma_f32_16x16x32_bf16 v[80:83], a[32:35], v[168:171], v[80:83]
    ds_read_b128 v[164:167], v21 offset:10240
    s_and_b32 s93, s28, 1
    v_mfma_f32_16x16x32_bf16 v[84:87], a[36:39], v[168:171], v[84:87]
    buffer_load_dwordx4 v7, s[12:15], s68 offen offset:1024 lds
    s_waitcnt lgkmcnt(6)
    v_mfma_f32_16x16x32_bf16 v[88:91], a[32:35], v[172:175], v[88:91]
    ds_read_b128 v[168:171], v21 offset:2048
    v_mfma_f32_16x16x32_bf16 v[92:95], a[36:39], v[172:175], v[92:95]
    ds_read_b128 v[172:175], v21 offset:12288
    s_mul_i32 s93, s93, 8192
    s_waitcnt lgkmcnt(7)
    v_mfma_f32_16x16x32_bf16 v[96:99], a[32:35], v[152:155], v[96:99]
    v_mfma_f32_16x16x32_bf16 v[100:103], a[36:39], v[152:155], v[100:103]
    buffer_load_dwordx4 v8, s[12:15], s68 offen offset:2048 lds
    s_waitcnt lgkmcnt(6)
    v_mfma_f32_16x16x32_bf16 v[104:107], a[32:35], v[156:159], v[104:107]
    ds_read_b128 v[152:155], v21 offset:4096
    s_add_u32 s93, s93, 11059200
    v_mfma_f32_16x16x32_bf16 v[108:111], a[36:39], v[156:159], v[108:111]
    ds_read_b128 v[156:159], v21 offset:14336
    s_waitcnt lgkmcnt(5)
    v_mfma_f32_16x16x32_bf16 v[32:35], a[40:43], v[160:163], v[32:35]
    v_mfma_f32_16x16x32_bf16 v[36:39], a[44:47], v[160:163], v[36:39]
    buffer_load_dwordx4 v9, s[12:15], s68 offen offset:3072 lds
    s_waitcnt lgkmcnt(4)
    v_mfma_f32_16x16x32_bf16 v[40:43], a[40:43], v[164:167], v[40:43]
    ds_read_b128 v[160:163], v21 offset:6144
    v_add_u32 v184, s93, v184
    v_mfma_f32_16x16x32_bf16 v[44:47], a[44:47], v[164:167], v[44:47]
    ds_read_b128 v[164:167], v21 offset:16384
    s_waitcnt lgkmcnt(5)
    v_mfma_f32_16x16x32_bf16 v[48:51], a[40:43], v[168:171], v[48:51]
    s_add_u32 m0, s90, 4096
    s_lshl_b32 s92, s29, 1
    v_mfma_f32_16x16x32_bf16 v[52:55], a[44:47], v[168:171], v[52:55]
    buffer_load_dwordx4 v10, s[12:15], s68 offen lds
    s_waitcnt lgkmcnt(4)
    v_mfma_f32_16x16x32_bf16 v[56:59], a[40:43], v[172:175], v[56:59]
    ds_read_b128 v[168:171], v21 offset:8192
    v_mfma_f32_16x16x32_bf16 v[60:63], a[44:47], v[172:175], v[60:63]
    ds_read_b128 v[172:175], v21 offset:18432
    v_lshrrev_b32 v187, 1, v1
    s_waitcnt lgkmcnt(5)
    v_mfma_f32_16x16x32_bf16 v[64:67], a[40:43], v[152:155], v[64:67]
    v_mfma_f32_16x16x32_bf16 v[68:71], a[44:47], v[152:155], v[68:71]
    s_waitcnt vmcnt(9)
    s_barrier
    ds_read_b128 a[48:51], v16 offset:12288
    s_waitcnt lgkmcnt(5)
    v_mfma_f32_16x16x32_bf16 v[72:75], a[40:43], v[156:159], v[72:75]
    ds_read_b128 a[52:55], v16 offset:14336
    v_lshl_add_u32 v187, v187, 4, s92
    v_mfma_f32_16x16x32_bf16 v[76:79], a[44:47], v[156:159], v[76:79]
    ds_read_b128 v[152:155], v20 offset:20480
    s_waitcnt lgkmcnt(6)
    v_mfma_f32_16x16x32_bf16 v[80:83], a[40:43], v[160:163], v[80:83]
    ds_read_b128 v[156:159], v20 offset:30720
    s_add_u32 m0, s89, 4096
    v_mfma_f32_16x16x32_bf16 v[84:87], a[44:47], v[160:163], v[84:87]
    buffer_load_dwordx4 v2, s[8:11], s69 offen offset:0 lds
    s_waitcnt lgkmcnt(6)
    v_mfma_f32_16x16x32_bf16 v[88:91], a[40:43], v[164:167], v[88:91]
    ds_read_b128 v[160:163], v20 offset:22528
    v_and_b32 v185, 1, v1
    v_mfma_f32_16x16x32_bf16 v[92:95], a[44:47], v[164:167], v[92:95]
    ds_read_b128 v[164:167], v20 offset:32768
    s_waitcnt lgkmcnt(7)
    v_mfma_f32_16x16x32_bf16 v[96:99], a[40:43], v[168:171], v[96:99]
    v_add_u32 v187, v187, v185
    v_mfma_f32_16x16x32_bf16 v[100:103], a[44:47], v[168:171], v[100:103]
    buffer_load_dwordx4 v3, s[8:11], s69 offen offset:1024 lds
    s_waitcnt lgkmcnt(6)
    v_mfma_f32_16x16x32_bf16 v[104:107], a[40:43], v[172:175], v[104:107]
    ds_read_b128 v[168:171], v20 offset:24576
    v_mfma_f32_16x16x32_bf16 v[108:111], a[44:47], v[172:175], v[108:111]
    ds_read_b128 v[172:175], v20 offset:34816
    s_waitcnt lgkmcnt(5)
    v_mfma_f32_16x16x32_bf16 v[32:35], a[48:51], v[152:155], v[32:35]
    v_mul_u32_u24 v187, 128, v187
    v_mfma_f32_16x16x32_bf16 v[36:39], a[52:55], v[152:155], v[36:39]
    buffer_load_dwordx4 v4, s[8:11], s69 offen offset:2048 lds
    s_waitcnt lgkmcnt(4)
    v_mfma_f32_16x16x32_bf16 v[40:43], a[48:51], v[156:159], v[40:43]
    ds_read_b128 v[152:155], v20 offset:26624
    v_mfma_f32_16x16x32_bf16 v[44:47], a[52:55], v[156:159], v[44:47]
    ds_read_b128 v[156:159], v20 offset:36864
    v_add_u32 v187, 11091968, v187
    s_waitcnt lgkmcnt(5)
    v_mfma_f32_16x16x32_bf16 v[48:51], a[48:51], v[160:163], v[48:51]
    v_mfma_f32_16x16x32_bf16 v[52:55], a[52:55], v[160:163], v[52:55]
    buffer_load_dwordx4 v5, s[8:11], s69 offen offset:3072 lds
    s_waitcnt lgkmcnt(4)
    v_mfma_f32_16x16x32_bf16 v[56:59], a[48:51], v[164:167], v[56:59]
    ds_read_b128 v[160:163], v20 offset:28672
    v_cmp_gt_u32 vcc, 16, v1
    v_mfma_f32_16x16x32_bf16 v[60:63], a[52:55], v[164:167], v[60:63]
    ds_read_b128 v[164:167], v20 offset:38912
    s_waitcnt lgkmcnt(5)
    v_mfma_f32_16x16x32_bf16 v[64:67], a[48:51], v[168:171], v[64:67]
    s_add_u32 m0, s90, 20480
    v_mfma_f32_16x16x32_bf16 v[68:71], a[52:55], v[168:171], v[68:71]
    buffer_load_dwordx4 v6, s[12:15], s69 offen offset:0 lds
    s_waitcnt lgkmcnt(4)
    v_mfma_f32_16x16x32_bf16 v[72:75], a[48:51], v[172:175], v[72:75]
    ds_read_b128 a[56:59], v17 offset:12288
    ds_read_b128 a[60:63], v17 offset:14336
    v_cndmask_b32 v187, v184, v187, vcc
    v_mfma_f32_16x16x32_bf16 v[76:79], a[52:55], v[172:175], v[76:79]
    ds_read_b128 v[168:171], v21 offset:20480
    s_waitcnt lgkmcnt(6)
    v_mfma_f32_16x16x32_bf16 v[80:83], a[48:51], v[152:155], v[80:83]
    ds_read_b128 v[172:175], v21 offset:30720
    v_subrev_u32 v184, 40960, v186
    v_mfma_f32_16x16x32_bf16 v[84:87], a[52:55], v[152:155], v[84:87]
    buffer_load_dwordx4 v7, s[12:15], s69 offen offset:1024 lds
    s_waitcnt lgkmcnt(6)
    v_mfma_f32_16x16x32_bf16 v[88:91], a[48:51], v[156:159], v[88:91]
    ds_read_b128 v[152:155], v21 offset:22528
    v_mfma_f32_16x16x32_bf16 v[92:95], a[52:55], v[156:159], v[92:95]
    ds_read_b128 v[156:159], v21 offset:32768
    v_cmp_gt_u32 vcc, 20, v1
    s_waitcnt lgkmcnt(7)
    v_mfma_f32_16x16x32_bf16 v[96:99], a[48:51], v[160:163], v[96:99]
    v_mfma_f32_16x16x32_bf16 v[100:103], a[52:55], v[160:163], v[100:103]
    buffer_load_dwordx4 v8, s[12:15], s69 offen offset:2048 lds
    s_waitcnt lgkmcnt(6)
    v_mfma_f32_16x16x32_bf16 v[104:107], a[48:51], v[164:167], v[104:107]
    ds_read_b128 v[160:163], v21 offset:24576
    v_cndmask_b32 v187, v184, v187, vcc
    v_mfma_f32_16x16x32_bf16 v[108:111], a[52:55], v[164:167], v[108:111]
    ds_read_b128 v[164:167], v21 offset:34816
    s_waitcnt lgkmcnt(5)
    v_mfma_f32_16x16x32_bf16 v[32:35], a[56:59], v[168:171], v[32:35]
    v_mfma_f32_16x16x32_bf16 v[36:39], a[60:63], v[168:171], v[36:39]
    buffer_load_dwordx4 v9, s[12:15], s69 offen offset:3072 lds
    s_waitcnt lgkmcnt(4)
    v_mfma_f32_16x16x32_bf16 v[40:43], a[56:59], v[172:175], v[40:43]
    ds_read_b128 v[168:171], v21 offset:26624
    v_subrev_u32 v186, 32768, v186
    v_mfma_f32_16x16x32_bf16 v[44:47], a[60:63], v[172:175], v[44:47]
    ds_read_b128 v[172:175], v21 offset:36864
    s_waitcnt lgkmcnt(5)
    v_mfma_f32_16x16x32_bf16 v[48:51], a[56:59], v[152:155], v[48:51]
    s_add_u32 m0, s90, 24576
    v_accvgpr_write_b32 a253, v186
    v_mfma_f32_16x16x32_bf16 v[52:55], a[60:63], v[152:155], v[52:55]
    buffer_load_dwordx4 v10, s[12:15], s69 offen lds
    s_waitcnt lgkmcnt(4)
    v_mfma_f32_16x16x32_bf16 v[56:59], a[56:59], v[156:159], v[56:59]
    ds_read_b128 v[152:155], v21 offset:28672
    v_mfma_f32_16x16x32_bf16 v[60:63], a[60:63], v[156:159], v[60:63]
    ds_read_b128 v[156:159], v21 offset:38912
    v_accvgpr_write_b32 a254, v187
    s_waitcnt lgkmcnt(5)
    v_mfma_f32_16x16x32_bf16 v[64:67], a[56:59], v[160:163], v[64:67]
    v_mfma_f32_16x16x32_bf16 v[68:71], a[60:63], v[160:163], v[68:71]
    s_waitcnt vmcnt(9)
    s_barrier
    ds_read_b128 a[64:67], v16 offset:0
    s_waitcnt lgkmcnt(5)
    v_mfma_f32_16x16x32_bf16 v[72:75], a[56:59], v[164:167], v[72:75]
    ds_read_b128 a[68:71], v16 offset:2048
    s_add_u32 s79, s29, 0
    v_mfma_f32_16x16x32_bf16 v[76:79], a[60:63], v[164:167], v[76:79]
    ds_read_b128 v[160:163], v18 offset:0
    s_waitcnt lgkmcnt(6)
    v_mfma_f32_16x16x32_bf16 v[80:83], a[56:59], v[168:171], v[80:83]
    ds_read_b128 v[164:167], v18 offset:10240
    s_add_u32 m0, s89, 8192
    v_mfma_f32_16x16x32_bf16 v[84:87], a[60:63], v[168:171], v[84:87]
    buffer_load_dwordx4 v2, s[8:11], s70 offen offset:0 lds
    s_waitcnt lgkmcnt(6)
    v_mfma_f32_16x16x32_bf16 v[88:91], a[56:59], v[172:175], v[88:91]
    ds_read_b128 v[168:171], v18 offset:2048
    s_and_b32 s79, s79, 3
    v_mfma_f32_16x16x32_bf16 v[92:95], a[60:63], v[172:175], v[92:95]
    ds_read_b128 v[172:175], v18 offset:12288
    s_waitcnt lgkmcnt(7)
    v_mfma_f32_16x16x32_bf16 v[96:99], a[56:59], v[152:155], v[96:99]
    v_mfma_f32_16x16x32_bf16 v[100:103], a[60:63], v[152:155], v[100:103]
    buffer_load_dwordx4 v3, s[8:11], s70 offen offset:1024 lds
    s_waitcnt lgkmcnt(6)
    v_mfma_f32_16x16x32_bf16 v[104:107], a[56:59], v[156:159], v[104:107]
    ds_read_b128 v[152:155], v18 offset:4096
    s_add_u32 s80, s29, 1
    v_mfma_f32_16x16x32_bf16 v[108:111], a[60:63], v[156:159], v[108:111]
    ds_read_b128 v[156:159], v18 offset:14336
    s_waitcnt lgkmcnt(5)
    v_mfma_f32_16x16x32_bf16 v[32:35], a[64:67], v[160:163], v[32:35]
    s_and_b32 s80, s80, 3
    v_mfma_f32_16x16x32_bf16 v[36:39], a[68:71], v[160:163], v[36:39]
    buffer_load_dwordx4 v4, s[8:11], s70 offen offset:2048 lds
    s_waitcnt lgkmcnt(4)
    v_mfma_f32_16x16x32_bf16 v[40:43], a[64:67], v[164:167], v[40:43]
    ds_read_b128 v[160:163], v18 offset:6144
    v_mfma_f32_16x16x32_bf16 v[44:47], a[68:71], v[164:167], v[44:47]
    ds_read_b128 v[164:167], v18 offset:16384
    s_add_u32 s81, s29, 2
    s_waitcnt lgkmcnt(5)
    v_mfma_f32_16x16x32_bf16 v[48:51], a[64:67], v[168:171], v[48:51]
    v_mfma_f32_16x16x32_bf16 v[52:55], a[68:71], v[168:171], v[52:55]
    buffer_load_dwordx4 v5, s[8:11], s70 offen offset:3072 lds
    s_waitcnt lgkmcnt(4)
    v_mfma_f32_16x16x32_bf16 v[56:59], a[64:67], v[172:175], v[56:59]
    ds_read_b128 v[168:171], v18 offset:8192
    s_and_b32 s81, s81, 3
    v_mfma_f32_16x16x32_bf16 v[60:63], a[68:71], v[172:175], v[60:63]
    ds_read_b128 v[172:175], v18 offset:18432
    s_waitcnt lgkmcnt(5)
    v_mfma_f32_16x16x32_bf16 v[64:67], a[64:67], v[152:155], v[64:67]
    s_add_u32 m0, s90, 40960
    v_mfma_f32_16x16x32_bf16 v[68:71], a[68:71], v[152:155], v[68:71]
    buffer_load_dwordx4 v6, s[12:15], s70 offen offset:0 lds
    s_waitcnt lgkmcnt(4)
    v_mfma_f32_16x16x32_bf16 v[72:75], a[64:67], v[156:159], v[72:75]
    ds_read_b128 a[72:75], v17 offset:0
    ds_read_b128 a[76:79], v17 offset:2048
    s_add_u32 s82, s29, 3
    v_mfma_f32_16x16x32_bf16 v[76:79], a[68:71], v[156:159], v[76:79]
    ds_read_b128 v[152:155], v19 offset:0
    s_waitcnt lgkmcnt(6)
    v_mfma_f32_16x16x32_bf16 v[80:83], a[64:67], v[160:163], v[80:83]
    ds_read_b128 v[156:159], v19 offset:10240
    s_and_b32 s82, s82, 3
    v_mfma_f32_16x16x32_bf16 v[84:87], a[68:71], v[160:163], v[84:87]
    buffer_load_dwordx4 v7, s[12:15], s70 offen offset:1024 lds
    s_waitcnt lgkmcnt(6)
    v_mfma_f32_16x16x32_bf16 v[88:91], a[64:67], v[164:167], v[88:91]
    ds_read_b128 v[160:163], v19 offset:2048
    v_mfma_f32_16x16x32_bf16 v[92:95], a[68:71], v[164:167], v[92:95]
    ds_read_b128 v[164:167], v19 offset:12288
    s_lshl_b32 s92, s101, 2
    s_waitcnt lgkmcnt(7)
    v_mfma_f32_16x16x32_bf16 v[96:99], a[64:67], v[168:171], v[96:99]
    v_mfma_f32_16x16x32_bf16 v[100:103], a[68:71], v[168:171], v[100:103]
    buffer_load_dwordx4 v8, s[12:15], s70 offen offset:2048 lds
    s_waitcnt lgkmcnt(6)
    v_mfma_f32_16x16x32_bf16 v[104:107], a[64:67], v[172:175], v[104:107]
    ds_read_b128 v[168:171], v19 offset:4096
    s_lshr_b32 s30, 0x3210, s92
    v_mfma_f32_16x16x32_bf16 v[108:111], a[68:71], v[172:175], v[108:111]
    ds_read_b128 v[172:175], v19 offset:14336
    s_waitcnt lgkmcnt(5)
    v_mfma_f32_16x16x32_bf16 v[32:35], a[72:75], v[152:155], v[32:35]
    v_mfma_f32_16x16x32_bf16 v[36:39], a[76:79], v[152:155], v[36:39]
    buffer_load_dwordx4 v9, s[12:15], s70 offen offset:3072 lds
    s_waitcnt lgkmcnt(4)
    v_mfma_f32_16x16x32_bf16 v[40:43], a[72:75], v[156:159], v[40:43]
    ds_read_b128 v[152:155], v19 offset:6144
    s_and_b32 s30, s30, 15
    v_mfma_f32_16x16x32_bf16 v[44:47], a[76:79], v[156:159], v[44:47]
    ds_read_b128 v[156:159], v19 offset:16384
    s_waitcnt lgkmcnt(5)
    v_mfma_f32_16x16x32_bf16 v[48:51], a[72:75], v[160:163], v[48:51]
    s_add_u32 m0, s90, 45056
    s_add_u32 s30, s30, s29
    v_mfma_f32_16x16x32_bf16 v[52:55], a[76:79], v[160:163], v[52:55]
    buffer_load_dwordx4 v10, s[12:15], s70 offen lds
    s_waitcnt lgkmcnt(4)
    v_mfma_f32_16x16x32_bf16 v[56:59], a[72:75], v[164:167], v[56:59]
    ds_read_b128 v[160:163], v19 offset:8192
    v_mfma_f32_16x16x32_bf16 v[60:63], a[76:79], v[164:167], v[60:63]
    ds_read_b128 v[164:167], v19 offset:18432
    s_sub_u32 s93, s30, 10
    s_waitcnt lgkmcnt(5)
    v_mfma_f32_16x16x32_bf16 v[64:67], a[72:75], v[168:171], v[64:67]
    v_mfma_f32_16x16x32_bf16 v[68:71], a[76:79], v[168:171], v[68:71]
    s_waitcnt vmcnt(9)
    s_barrier
    ds_read_b128 a[80:83], v16 offset:4096
    s_waitcnt lgkmcnt(5)
    v_mfma_f32_16x16x32_bf16 v[72:75], a[72:75], v[172:175], v[72:75]
    ds_read_b128 a[84:87], v16 offset:6144
    s_cmp_ge_u32 s30, 10
    s_cselect_b32 s30, s93, s30
    v_mfma_f32_16x16x32_bf16 v[76:79], a[76:79], v[172:175], v[76:79]
    ds_read_b128 v[168:171], v18 offset:20480
    s_waitcnt lgkmcnt(6)
    v_mfma_f32_16x16x32_bf16 v[80:83], a[72:75], v[152:155], v[80:83]
    ds_read_b128 v[172:175], v18 offset:30720
    s_add_u32 m0, s89, 12288
    v_mfma_f32_16x16x32_bf16 v[84:87], a[76:79], v[152:155], v[84:87]
    buffer_load_dwordx4 v2, s[8:11], s71 offen offset:0 lds
    s_waitcnt lgkmcnt(6)
    v_mfma_f32_16x16x32_bf16 v[88:91], a[72:75], v[156:159], v[88:91]
    ds_read_b128 v[152:155], v18 offset:22528
    v_mfma_f32_16x16x32_bf16 v[92:95], a[76:79], v[156:159], v[92:95]
    ds_read_b128 v[156:159], v18 offset:32768
    s_waitcnt lgkmcnt(7)
    v_mfma_f32_16x16x32_bf16 v[96:99], a[72:75], v[160:163], v[96:99]
    v_mfma_f32_16x16x32_bf16 v[100:103], a[76:79], v[160:163], v[100:103]
    buffer_load_dwordx4 v3, s[8:11], s71 offen offset:1024 lds
    s_waitcnt lgkmcnt(6)
    v_mfma_f32_16x16x32_bf16 v[104:107], a[72:75], v[164:167], v[104:107]
    ds_read_b128 v[160:163], v18 offset:24576
    s_sub_u32 s93, s30, 5
    v_mfma_f32_16x16x32_bf16 v[108:111], a[76:79], v[164:167], v[108:111]
    ds_read_b128 v[164:167], v18 offset:34816
    s_waitcnt lgkmcnt(5)
    v_mfma_f32_16x16x32_bf16 v[32:35], a[80:83], v[168:171], v[32:35]
    s_cmp_ge_u32 s30, 5
    s_cselect_b32 s30, s93, s30
    v_mfma_f32_16x16x32_bf16 v[36:39], a[84:87], v[168:171], v[36:39]
    buffer_load_dwordx4 v4, s[8:11], s71 offen offset:2048 lds
    s_waitcnt lgkmcnt(4)
    v_mfma_f32_16x16x32_bf16 v[40:43], a[80:83], v[172:175], v[40:43]
    ds_read_b128 v[168:171], v18 offset:26624
    v_mfma_f32_16x16x32_bf16 v[44:47], a[84:87], v[172:175], v[44:47]
    ds_read_b128 v[172:175], v18 offset:36864
    s_waitcnt lgkmcnt(5)
    v_mfma_f32_16x16x32_bf16 v[48:51], a[80:83], v[152:155], v[48:51]
    v_mfma_f32_16x16x32_bf16 v[52:55], a[84:87], v[152:155], v[52:55]
    buffer_load_dwordx4 v5, s[8:11], s71 offen offset:3072 lds
    s_waitcnt lgkmcnt(4)
    v_mfma_f32_16x16x32_bf16 v[56:59], a[80:83], v[156:159], v[56:59]
    ds_read_b128 v[152:155], v18 offset:28672
    s_mul_i32 s92, s3, 5
    v_mfma_f32_16x16x32_bf16 v[60:63], a[84:87], v[156:159], v[60:63]
    ds_read_b128 v[156:159], v18 offset:38912
    s_waitcnt lgkmcnt(5)
    v_mfma_f32_16x16x32_bf16 v[64:67], a[80:83], v[160:163], v[64:67]
    s_add_u32 m0, s90, 61440
    v_mfma_f32_16x16x32_bf16 v[68:71], a[84:87], v[160:163], v[68:71]
    buffer_load_dwordx4 v6, s[12:15], s71 offen offset:0 lds
    s_waitcnt lgkmcnt(4)
    v_mfma_f32_16x16x32_bf16 v[72:75], a[80:83], v[164:167], v[72:75]
    ds_read_b128 a[88:91], v17 offset:4096
    ds_read_b128 a[92:95], v17 offset:6144
    s_add_u32 s92, s92, s30
    v_mfma_f32_16x16x32_bf16 v[76:79], a[84:87], v[164:167], v[76:79]
    ds_read_b128 v[160:163], v19 offset:20480
    s_waitcnt lgkmcnt(6)
    v_mfma_f32_16x16x32_bf16 v[80:83], a[80:83], v[168:171], v[80:83]
    ds_read_b128 v[164:167], v19 offset:30720
    s_add_u32 s84, s92, 0
    v_mfma_f32_16x16x32_bf16 v[84:87], a[84:87], v[168:171], v[84:87]
    buffer_load_dwordx4 v7, s[12:15], s71 offen offset:1024 lds
    s_waitcnt lgkmcnt(6)
    v_mfma_f32_16x16x32_bf16 v[88:91], a[80:83], v[172:175], v[88:91]
    ds_read_b128 v[168:171], v19 offset:22528
    v_mfma_f32_16x16x32_bf16 v[92:95], a[84:87], v[172:175], v[92:95]
    ds_read_b128 v[172:175], v19 offset:32768
    s_sub_u32 s93, s84, 20
    s_waitcnt lgkmcnt(7)
    v_mfma_f32_16x16x32_bf16 v[96:99], a[80:83], v[152:155], v[96:99]
    v_mfma_f32_16x16x32_bf16 v[100:103], a[84:87], v[152:155], v[100:103]
    buffer_load_dwordx4 v8, s[12:15], s71 offen offset:2048 lds
    s_waitcnt lgkmcnt(6)
    v_mfma_f32_16x16x32_bf16 v[104:107], a[80:83], v[156:159], v[104:107]
    ds_read_b128 v[152:155], v19 offset:24576
    s_cmp_ge_u32 s84, 20
    s_cselect_b32 s84, s93, s84
    v_mfma_f32_16x16x32_bf16 v[108:111], a[84:87], v[156:159], v[108:111]
    ds_read_b128 v[156:159], v19 offset:34816
    s_waitcnt lgkmcnt(5)
    v_mfma_f32_16x16x32_bf16 v[32:35], a[88:91], v[160:163], v[32:35]
    v_mfma_f32_16x16x32_bf16 v[36:39], a[92:95], v[160:163], v[36:39]
    buffer_load_dwordx4 v9, s[12:15], s71 offen offset:3072 lds
    s_waitcnt lgkmcnt(4)
    v_mfma_f32_16x16x32_bf16 v[40:43], a[88:91], v[164:167], v[40:43]
    ds_read_b128 v[160:163], v19 offset:26624
    v_mfma_f32_16x16x32_bf16 v[44:47], a[92:95], v[164:167], v[44:47]
    ds_read_b128 v[164:167], v19 offset:36864
    s_waitcnt lgkmcnt(5)
    v_mfma_f32_16x16x32_bf16 v[48:51], a[88:91], v[168:171], v[48:51]
    s_add_u32 m0, s90, 65536
    s_add_u32 s85, s92, 1
    v_mfma_f32_16x16x32_bf16 v[52:55], a[92:95], v[168:171], v[52:55]
    buffer_load_dwordx4 v10, s[12:15], s71 offen lds
    s_waitcnt lgkmcnt(4)
    v_mfma_f32_16x16x32_bf16 v[56:59], a[88:91], v[172:175], v[56:59]
    ds_read_b128 v[168:171], v19 offset:28672
    v_mfma_f32_16x16x32_bf16 v[60:63], a[92:95], v[172:175], v[60:63]
    ds_read_b128 v[172:175], v19 offset:38912
    s_sub_u32 s93, s85, 20
    s_waitcnt lgkmcnt(5)
    v_mfma_f32_16x16x32_bf16 v[64:67], a[88:91], v[152:155], v[64:67]
    v_mfma_f32_16x16x32_bf16 v[68:71], a[92:95], v[152:155], v[68:71]
    s_waitcnt vmcnt(9)
    s_barrier
    ds_read_b128 a[96:99], v16 offset:8192
    s_waitcnt lgkmcnt(5)
    v_mfma_f32_16x16x32_bf16 v[72:75], a[88:91], v[156:159], v[72:75]
    ds_read_b128 a[100:103], v16 offset:10240
    s_cmp_ge_u32 s85, 20
    s_cselect_b32 s85, s93, s85
    v_mfma_f32_16x16x32_bf16 v[76:79], a[92:95], v[156:159], v[76:79]
    ds_read_b128 v[152:155], v20 offset:0
    s_waitcnt lgkmcnt(6)
    v_mfma_f32_16x16x32_bf16 v[80:83], a[88:91], v[160:163], v[80:83]
    ds_read_b128 v[156:159], v20 offset:10240
    s_add_u32 m0, s89, 0
    v_mfma_f32_16x16x32_bf16 v[84:87], a[92:95], v[160:163], v[84:87]
    buffer_load_dwordx4 v2, s[8:11], s72 offen offset:0 lds
    s_waitcnt lgkmcnt(6)
    v_mfma_f32_16x16x32_bf16 v[88:91], a[88:91], v[164:167], v[88:91]
    ds_read_b128 v[160:163], v20 offset:2048
    v_mfma_f32_16x16x32_bf16 v[92:95], a[92:95], v[164:167], v[92:95]
    ds_read_b128 v[164:167], v20 offset:12288
    s_waitcnt lgkmcnt(7)
    v_mfma_f32_16x16x32_bf16 v[96:99], a[88:91], v[168:171], v[96:99]
    v_mfma_f32_16x16x32_bf16 v[100:103], a[92:95], v[168:171], v[100:103]
    buffer_load_dwordx4 v3, s[8:11], s72 offen offset:1024 lds
    s_waitcnt lgkmcnt(6)
    v_mfma_f32_16x16x32_bf16 v[104:107], a[88:91], v[172:175], v[104:107]
    ds_read_b128 v[168:171], v20 offset:4096
    s_add_u32 s86, s92, 2
    v_mfma_f32_16x16x32_bf16 v[108:111], a[92:95], v[172:175], v[108:111]
    ds_read_b128 v[172:175], v20 offset:14336
    s_waitcnt lgkmcnt(5)
    v_mfma_f32_16x16x32_bf16 v[32:35], a[96:99], v[152:155], v[32:35]
    s_sub_u32 s93, s86, 20
    v_mfma_f32_16x16x32_bf16 v[36:39], a[100:103], v[152:155], v[36:39]
    buffer_load_dwordx4 v4, s[8:11], s72 offen offset:2048 lds
    s_waitcnt lgkmcnt(4)
    v_mfma_f32_16x16x32_bf16 v[40:43], a[96:99], v[156:159], v[40:43]
    ds_read_b128 v[152:155], v20 offset:6144
    v_mfma_f32_16x16x32_bf16 v[44:47], a[100:103], v[156:159], v[44:47]
    ds_read_b128 v[156:159], v20 offset:16384
    s_cmp_ge_u32 s86, 20
    s_cselect_b32 s86, s93, s86
    s_waitcnt lgkmcnt(5)
    v_mfma_f32_16x16x32_bf16 v[48:51], a[96:99], v[160:163], v[48:51]
    v_mfma_f32_16x16x32_bf16 v[52:55], a[100:103], v[160:163], v[52:55]
    buffer_load_dwordx4 v5, s[8:11], s72 offen offset:3072 lds
    s_waitcnt lgkmcnt(4)
    v_mfma_f32_16x16x32_bf16 v[56:59], a[96:99], v[164:167], v[56:59]
    ds_read_b128 v[160:163], v20 offset:8192
    v_mfma_f32_16x16x32_bf16 v[60:63], a[100:103], v[164:167], v[60:63]
    ds_read_b128 v[164:167], v20 offset:18432
    s_waitcnt lgkmcnt(5)
    v_mfma_f32_16x16x32_bf16 v[64:67], a[96:99], v[168:171], v[64:67]
    s_add_u32 m0, s90, 0
    v_mfma_f32_16x16x32_bf16 v[68:71], a[100:103], v[168:171], v[68:71]
    buffer_load_dwordx4 v6, s[12:15], s72 offen offset:0 lds
    s_waitcnt lgkmcnt(4)
    v_mfma_f32_16x16x32_bf16 v[72:75], a[96:99], v[172:175], v[72:75]
    ds_read_b128 a[104:107], v17 offset:8192
    ds_read_b128 a[108:111], v17 offset:10240
    s_add_u32 s87, s92, 3
    v_mfma_f32_16x16x32_bf16 v[76:79], a[100:103], v[172:175], v[76:79]
    ds_read_b128 v[168:171], v21 offset:0
    s_waitcnt lgkmcnt(6)
    v_mfma_f32_16x16x32_bf16 v[80:83], a[96:99], v[152:155], v[80:83]
    ds_read_b128 v[172:175], v21 offset:10240
    s_sub_u32 s93, s87, 20
    v_mfma_f32_16x16x32_bf16 v[84:87], a[100:103], v[152:155], v[84:87]
    buffer_load_dwordx4 v7, s[12:15], s72 offen offset:1024 lds
    s_waitcnt lgkmcnt(6)
    v_mfma_f32_16x16x32_bf16 v[88:91], a[96:99], v[156:159], v[88:91]
    ds_read_b128 v[152:155], v21 offset:2048
    v_mfma_f32_16x16x32_bf16 v[92:95], a[100:103], v[156:159], v[92:95]
    ds_read_b128 v[156:159], v21 offset:12288
    s_cmp_ge_u32 s87, 20
    s_cselect_b32 s87, s93, s87
    s_waitcnt lgkmcnt(7)
    v_mfma_f32_16x16x32_bf16 v[96:99], a[96:99], v[160:163], v[96:99]
    v_mfma_f32_16x16x32_bf16 v[100:103], a[100:103], v[160:163], v[100:103]
    buffer_load_dwordx4 v8, s[12:15], s72 offen offset:2048 lds
    s_waitcnt lgkmcnt(6)
    v_mfma_f32_16x16x32_bf16 v[104:107], a[96:99], v[164:167], v[104:107]
    ds_read_b128 v[160:163], v21 offset:4096
    v_mfma_f32_16x16x32_bf16 v[108:111], a[100:103], v[164:167], v[108:111]
    ds_read_b128 v[164:167], v21 offset:14336
    s_waitcnt lgkmcnt(5)
    v_mfma_f32_16x16x32_bf16 v[32:35], a[104:107], v[168:171], v[32:35]
    v_mfma_f32_16x16x32_bf16 v[36:39], a[108:111], v[168:171], v[36:39]
    buffer_load_dwordx4 v9, s[12:15], s72 offen offset:3072 lds
    s_waitcnt lgkmcnt(4)
    v_mfma_f32_16x16x32_bf16 v[40:43], a[104:107], v[172:175], v[40:43]
    ds_read_b128 v[168:171], v21 offset:6144
    s_add_u32 s88, s92, 4
    v_mfma_f32_16x16x32_bf16 v[44:47], a[108:111], v[172:175], v[44:47]
    ds_read_b128 v[172:175], v21 offset:16384
    s_waitcnt lgkmcnt(5)
    v_mfma_f32_16x16x32_bf16 v[48:51], a[104:107], v[152:155], v[48:51]
    s_add_u32 m0, s90, 4096
    s_sub_u32 s93, s88, 20
    v_mfma_f32_16x16x32_bf16 v[52:55], a[108:111], v[152:155], v[52:55]
    buffer_load_dwordx4 v10, s[12:15], s72 offen lds
    s_waitcnt lgkmcnt(4)
    v_mfma_f32_16x16x32_bf16 v[56:59], a[104:107], v[156:159], v[56:59]
    ds_read_b128 v[152:155], v21 offset:8192
    v_mfma_f32_16x16x32_bf16 v[60:63], a[108:111], v[156:159], v[60:63]
    ds_read_b128 v[156:159], v21 offset:18432
    s_cmp_ge_u32 s88, 20
    s_cselect_b32 s88, s93, s88
    s_waitcnt lgkmcnt(5)
    v_mfma_f32_16x16x32_bf16 v[64:67], a[104:107], v[160:163], v[64:67]
    v_mfma_f32_16x16x32_bf16 v[68:71], a[108:111], v[160:163], v[68:71]
    s_waitcnt vmcnt(9)
    s_barrier
    ds_read_b128 a[112:115], v16 offset:12288
    s_waitcnt lgkmcnt(5)
    v_mfma_f32_16x16x32_bf16 v[72:75], a[104:107], v[164:167], v[72:75]
    ds_read_b128 a[116:119], v16 offset:14336
    v_mfma_f32_16x16x32_bf16 v[76:79], a[108:111], v[164:167], v[76:79]
    ds_read_b128 v[160:163], v20 offset:20480
    s_waitcnt lgkmcnt(6)
    v_mfma_f32_16x16x32_bf16 v[80:83], a[104:107], v[168:171], v[80:83]
    ds_read_b128 v[164:167], v20 offset:30720
    s_add_u32 m0, s89, 4096
    v_mfma_f32_16x16x32_bf16 v[84:87], a[108:111], v[168:171], v[84:87]
    buffer_load_dwordx4 v2, s[8:11], s73 offen offset:0 lds
    s_waitcnt lgkmcnt(6)
    v_mfma_f32_16x16x32_bf16 v[88:91], a[104:107], v[172:175], v[88:91]
    ds_read_b128 v[168:171], v20 offset:22528
    v_mfma_f32_16x16x32_bf16 v[92:95], a[108:111], v[172:175], v[92:95]
    ds_read_b128 v[172:175], v20 offset:32768
    s_waitcnt lgkmcnt(7)
    v_mfma_f32_16x16x32_bf16 v[96:99], a[104:107], v[152:155], v[96:99]
    v_mfma_f32_16x16x32_bf16 v[100:103], a[108:111], v[152:155], v[100:103]
    buffer_load_dwordx4 v3, s[8:11], s73 offen offset:1024 lds
    s_waitcnt lgkmcnt(6)
    v_mfma_f32_16x16x32_bf16 v[104:107], a[104:107], v[156:159], v[104:107]
    ds_read_b128 v[152:155], v20 offset:24576
    v_mfma_f32_16x16x32_bf16 v[108:111], a[108:111], v[156:159], v[108:111]
    ds_read_b128 v[156:159], v20 offset:34816
    s_waitcnt lgkmcnt(5)
    v_mfma_f32_16x16x32_bf16 v[32:35], a[112:115], v[160:163], v[32:35]
    v_mfma_f32_16x16x32_bf16 v[36:39], a[116:119], v[160:163], v[36:39]
    buffer_load_dwordx4 v4, s[8:11], s73 offen offset:2048 lds
    s_waitcnt lgkmcnt(4)
    v_mfma_f32_16x16x32_bf16 v[40:43], a[112:115], v[164:167], v[40:43]
    ds_read_b128 v[160:163], v20 offset:26624
    v_mfma_f32_16x16x32_bf16 v[44:47], a[116:119], v[164:167], v[44:47]
    ds_read_b128 v[164:167], v20 offset:36864
    s_waitcnt lgkmcnt(5)
    v_mfma_f32_16x16x32_bf16 v[48:51], a[112:115], v[168:171], v[48:51]
    v_mfma_f32_16x16x32_bf16 v[52:55], a[116:119], v[168:171], v[52:55]
    buffer_load_dwordx4 v5, s[8:11], s73 offen offset:3072 lds
    s_waitcnt lgkmcnt(4)
    v_mfma_f32_16x16x32_bf16 v[56:59], a[112:115], v[172:175], v[56:59]
    ds_read_b128 v[168:171], v20 offset:28672
    v_mfma_f32_16x16x32_bf16 v[60:63], a[116:119], v[172:175], v[60:63]
    ds_read_b128 v[172:175], v20 offset:38912
    s_waitcnt lgkmcnt(5)
    v_mfma_f32_16x16x32_bf16 v[64:67], a[112:115], v[152:155], v[64:67]
    s_add_u32 m0, s90, 20480
    v_mfma_f32_16x16x32_bf16 v[68:71], a[116:119], v[152:155], v[68:71]
    buffer_load_dwordx4 v6, s[12:15], s73 offen offset:0 lds
    s_waitcnt lgkmcnt(4)
    v_mfma_f32_16x16x32_bf16 v[72:75], a[112:115], v[156:159], v[72:75]
    ds_read_b128 a[120:123], v17 offset:12288
    ds_read_b128 a[124:127], v17 offset:14336
    v_mfma_f32_16x16x32_bf16 v[76:79], a[116:119], v[156:159], v[76:79]
    ds_read_b128 v[152:155], v21 offset:20480
    s_waitcnt lgkmcnt(6)
    v_mfma_f32_16x16x32_bf16 v[80:83], a[112:115], v[160:163], v[80:83]
    ds_read_b128 v[156:159], v21 offset:30720
    v_mfma_f32_16x16x32_bf16 v[84:87], a[116:119], v[160:163], v[84:87]
    buffer_load_dwordx4 v7, s[12:15], s73 offen offset:1024 lds
    s_waitcnt lgkmcnt(6)
    v_mfma_f32_16x16x32_bf16 v[88:91], a[112:115], v[164:167], v[88:91]
    ds_read_b128 v[160:163], v21 offset:22528
    v_mfma_f32_16x16x32_bf16 v[92:95], a[116:119], v[164:167], v[92:95]
    ds_read_b128 v[164:167], v21 offset:32768
    s_waitcnt lgkmcnt(7)
    v_mfma_f32_16x16x32_bf16 v[96:99], a[112:115], v[168:171], v[96:99]
    v_mfma_f32_16x16x32_bf16 v[100:103], a[116:119], v[168:171], v[100:103]
    buffer_load_dwordx4 v8, s[12:15], s73 offen offset:2048 lds
    s_waitcnt lgkmcnt(6)
    v_mfma_f32_16x16x32_bf16 v[104:107], a[112:115], v[172:175], v[104:107]
    ds_read_b128 v[168:171], v21 offset:24576
    v_mfma_f32_16x16x32_bf16 v[108:111], a[116:119], v[172:175], v[108:111]
    ds_read_b128 v[172:175], v21 offset:34816
    v_accvgpr_read_b32 v30, a254
    s_mov_b64 exec, 0xffff
    buffer_load_dword v31, v30, s[20:23], 0 offen sc1
    s_mov_b64 exec, -1
    s_waitcnt lgkmcnt(5)
    v_mfma_f32_16x16x32_bf16 v[32:35], a[120:123], v[152:155], v[32:35]
    v_mfma_f32_16x16x32_bf16 v[36:39], a[124:127], v[152:155], v[36:39]
    buffer_load_dwordx4 v9, s[12:15], s73 offen offset:3072 lds
    s_waitcnt lgkmcnt(4)
    v_mfma_f32_16x16x32_bf16 v[40:43], a[120:123], v[156:159], v[40:43]
    ds_read_b128 v[152:155], v21 offset:26624
    v_mfma_f32_16x16x32_bf16 v[44:47], a[124:127], v[156:159], v[44:47]
    ds_read_b128 v[156:159], v21 offset:36864
    s_waitcnt lgkmcnt(5)
    v_mfma_f32_16x16x32_bf16 v[48:51], a[120:123], v[160:163], v[48:51]
    s_add_u32 m0, s90, 24576
    v_mfma_f32_16x16x32_bf16 v[52:55], a[124:127], v[160:163], v[52:55]
    buffer_load_dwordx4 v10, s[12:15], s73 offen lds
    s_waitcnt lgkmcnt(4)
    v_mfma_f32_16x16x32_bf16 v[56:59], a[120:123], v[164:167], v[56:59]
    ds_read_b128 v[160:163], v21 offset:28672
    v_mfma_f32_16x16x32_bf16 v[60:63], a[124:127], v[164:167], v[60:63]
    ds_read_b128 v[164:167], v21 offset:38912
    s_waitcnt lgkmcnt(5)
    v_mfma_f32_16x16x32_bf16 v[64:67], a[120:123], v[168:171], v[64:67]
    v_mfma_f32_16x16x32_bf16 v[68:71], a[124:127], v[168:171], v[68:71]
    s_waitcnt vmcnt(10)
    s_barrier
    ds_read_b128 a[128:131], v16 offset:0
    s_waitcnt lgkmcnt(5)
    v_mfma_f32_16x16x32_bf16 v[72:75], a[120:123], v[172:175], v[72:75]
    ds_read_b128 a[132:135], v16 offset:2048
    v_mfma_f32_16x16x32_bf16 v[76:79], a[124:127], v[172:175], v[76:79]
    ds_read_b128 v[168:171], v18 offset:0
    s_waitcnt lgkmcnt(6)
    v_mfma_f32_16x16x32_bf16 v[80:83], a[120:123], v[152:155], v[80:83]
    ds_read_b128 v[172:175], v18 offset:10240
    s_add_u32 m0, s90, 40960
    v_mfma_f32_16x16x32_bf16 v[84:87], a[124:127], v[152:155], v[84:87]
    buffer_load_dwordx4 v11, s[16:19], s74 offen offset:0 lds
    s_waitcnt lgkmcnt(6)
    v_mfma_f32_16x16x32_bf16 v[88:91], a[120:123], v[156:159], v[88:91]
    ds_read_b128 v[152:155], v18 offset:2048
    v_mfma_f32_16x16x32_bf16 v[92:95], a[124:127], v[156:159], v[92:95]
    ds_read_b128 v[156:159], v18 offset:12288
    s_waitcnt lgkmcnt(7)
    v_mfma_f32_16x16x32_bf16 v[96:99], a[120:123], v[160:163], v[96:99]
    v_mfma_f32_16x16x32_bf16 v[100:103], a[124:127], v[160:163], v[100:103]
    buffer_load_dwordx4 v12, s[16:19], s74 offen offset:1024 lds
    s_waitcnt lgkmcnt(6)
    v_mfma_f32_16x16x32_bf16 v[104:107], a[120:123], v[164:167], v[104:107]
    ds_read_b128 v[160:163], v18 offset:4096
    v_mfma_f32_16x16x32_bf16 v[108:111], a[124:127], v[164:167], v[108:111]
    ds_read_b128 v[164:167], v18 offset:14336
    s_waitcnt lgkmcnt(5)
    v_mfma_f32_16x16x32_bf16 v[32:35], a[128:131], v[168:171], v[32:35]
    v_mfma_f32_16x16x32_bf16 v[36:39], a[132:135], v[168:171], v[36:39]
    buffer_load_dwordx4 v13, s[16:19], s74 offen offset:2048 lds
    s_waitcnt lgkmcnt(4)
    v_mfma_f32_16x16x32_bf16 v[40:43], a[128:131], v[172:175], v[40:43]
    ds_read_b128 v[168:171], v18 offset:6144
    v_mfma_f32_16x16x32_bf16 v[44:47], a[132:135], v[172:175], v[44:47]
    ds_read_b128 v[172:175], v18 offset:16384
    s_waitcnt lgkmcnt(5)
    v_mfma_f32_16x16x32_bf16 v[48:51], a[128:131], v[152:155], v[48:51]
    v_mfma_f32_16x16x32_bf16 v[52:55], a[132:135], v[152:155], v[52:55]
    buffer_load_dwordx4 v14, s[16:19], s74 offen offset:3072 lds
    s_waitcnt lgkmcnt(4)
    v_mfma_f32_16x16x32_bf16 v[56:59], a[128:131], v[156:159], v[56:59]
    ds_read_b128 v[152:155], v18 offset:8192
    v_mfma_f32_16x16x32_bf16 v[60:63], a[132:135], v[156:159], v[60:63]
    ds_read_b128 v[156:159], v18 offset:18432
    s_waitcnt lgkmcnt(5)
    v_mfma_f32_16x16x32_bf16 v[64:67], a[128:131], v[160:163], v[64:67]
    s_add_u32 m0, s90, 45056
    v_mfma_f32_16x16x32_bf16 v[68:71], a[132:135], v[160:163], v[68:71]
    buffer_load_dwordx4 v15, s[16:19], s74 offen lds
    s_waitcnt lgkmcnt(4)
    v_mfma_f32_16x16x32_bf16 v[72:75], a[128:131], v[164:167], v[72:75]
    ds_read_b128 a[136:139], v17 offset:0
    ds_read_b128 a[140:143], v17 offset:2048
    v_mfma_f32_16x16x32_bf16 v[76:79], a[132:135], v[164:167], v[76:79]
    ds_read_b128 v[160:163], v19 offset:0
    s_waitcnt lgkmcnt(6)
    v_mfma_f32_16x16x32_bf16 v[80:83], a[128:131], v[168:171], v[80:83]
    ds_read_b128 v[164:167], v19 offset:10240
    v_mfma_f32_16x16x32_bf16 v[84:87], a[132:135], v[168:171], v[84:87]
    ds_read_b128 v[168:171], v19 offset:2048
    s_waitcnt lgkmcnt(7)
    v_mfma_f32_16x16x32_bf16 v[88:91], a[128:131], v[172:175], v[88:91]
    v_mfma_f32_16x16x32_bf16 v[92:95], a[132:135], v[172:175], v[92:95]
    ds_read_b128 v[172:175], v19 offset:12288
    s_waitcnt lgkmcnt(7)
    v_mfma_f32_16x16x32_bf16 v[96:99], a[128:131], v[152:155], v[96:99]
    v_mfma_f32_16x16x32_bf16 v[100:103], a[132:135], v[152:155], v[100:103]
    ds_read_b128 v[152:155], v19 offset:4096
    s_waitcnt lgkmcnt(7)
    v_mfma_f32_16x16x32_bf16 v[104:107], a[128:131], v[156:159], v[104:107]
    v_mfma_f32_16x16x32_bf16 v[108:111], a[132:135], v[156:159], v[108:111]
    ds_read_b128 v[156:159], v19 offset:14336
    s_waitcnt lgkmcnt(5)
    v_mfma_f32_16x16x32_bf16 v[32:35], a[136:139], v[160:163], v[32:35]
    v_mfma_f32_16x16x32_bf16 v[36:39], a[140:143], v[160:163], v[36:39]
    ds_read_b128 v[160:163], v19 offset:6144
    s_waitcnt lgkmcnt(5)
    v_mfma_f32_16x16x32_bf16 v[40:43], a[136:139], v[164:167], v[40:43]
    v_mfma_f32_16x16x32_bf16 v[44:47], a[140:143], v[164:167], v[44:47]
    ds_read_b128 v[164:167], v19 offset:16384
    s_waitcnt lgkmcnt(5)
    v_mfma_f32_16x16x32_bf16 v[48:51], a[136:139], v[168:171], v[48:51]
    v_mfma_f32_16x16x32_bf16 v[52:55], a[140:143], v[168:171], v[52:55]
    ds_read_b128 v[168:171], v19 offset:8192
    s_waitcnt lgkmcnt(5)
    v_mfma_f32_16x16x32_bf16 v[56:59], a[136:139], v[172:175], v[56:59]
    v_mfma_f32_16x16x32_bf16 v[60:63], a[140:143], v[172:175], v[60:63]
    ds_read_b128 v[172:175], v19 offset:18432
    s_waitcnt lgkmcnt(5)
    v_mfma_f32_16x16x32_bf16 v[64:67], a[136:139], v[152:155], v[64:67]
    v_mfma_f32_16x16x32_bf16 v[68:71], a[140:143], v[152:155], v[68:71]
    s_waitcnt vmcnt(5)
    s_barrier
    ds_read_b128 a[144:147], v16 offset:4096
    s_waitcnt lgkmcnt(5)
    v_mfma_f32_16x16x32_bf16 v[72:75], a[136:139], v[156:159], v[72:75]
    ds_read_b128 a[148:151], v16 offset:6144
    v_mfma_f32_16x16x32_bf16 v[76:79], a[140:143], v[156:159], v[76:79]
    ds_read_b128 v[152:155], v18 offset:20480
    s_waitcnt lgkmcnt(6)
    v_mfma_f32_16x16x32_bf16 v[80:83], a[136:139], v[160:163], v[80:83]
    ds_read_b128 v[156:159], v18 offset:30720
    s_add_u32 m0, s90, 61440
    v_mfma_f32_16x16x32_bf16 v[84:87], a[140:143], v[160:163], v[84:87]
    buffer_load_dwordx4 v11, s[16:19], s75 offen offset:0 lds
    s_waitcnt lgkmcnt(6)
    v_mfma_f32_16x16x32_bf16 v[88:91], a[136:139], v[164:167], v[88:91]
    ds_read_b128 v[160:163], v18 offset:22528
    v_mfma_f32_16x16x32_bf16 v[92:95], a[140:143], v[164:167], v[92:95]
    ds_read_b128 v[164:167], v18 offset:32768
    s_waitcnt lgkmcnt(7)
    v_mfma_f32_16x16x32_bf16 v[96:99], a[136:139], v[168:171], v[96:99]
    v_mfma_f32_16x16x32_bf16 v[100:103], a[140:143], v[168:171], v[100:103]
    buffer_load_dwordx4 v12, s[16:19], s75 offen offset:1024 lds
    s_waitcnt lgkmcnt(6)
    v_mfma_f32_16x16x32_bf16 v[104:107], a[136:139], v[172:175], v[104:107]
    ds_read_b128 v[168:171], v18 offset:24576
    v_mfma_f32_16x16x32_bf16 v[108:111], a[140:143], v[172:175], v[108:111]
    ds_read_b128 v[172:175], v18 offset:34816
    s_waitcnt lgkmcnt(5)
    v_mfma_f32_16x16x32_bf16 v[32:35], a[144:147], v[152:155], v[32:35]
    v_mfma_f32_16x16x32_bf16 v[36:39], a[148:151], v[152:155], v[36:39]
    buffer_load_dwordx4 v13, s[16:19], s75 offen offset:2048 lds
    v_accvgpr_read_b32 v5, a245
    ds_read_b128 v[176:179], v5 offset:0
    ds_read_b128 v[180:183], v5 offset:16
    ds_read_b64 v[216:217], v5 offset:32
    s_waitcnt lgkmcnt(7)
    v_mfma_f32_16x16x32_bf16 v[40:43], a[144:147], v[156:159], v[40:43]
    ds_read_b128 v[152:155], v18 offset:26624
    v_mfma_f32_16x16x32_bf16 v[44:47], a[148:151], v[156:159], v[44:47]
    ds_read_b128 v[156:159], v18 offset:36864
    s_waitcnt lgkmcnt(8)
    v_mfma_f32_16x16x32_bf16 v[48:51], a[144:147], v[160:163], v[48:51]
    v_mfma_f32_16x16x32_bf16 v[52:55], a[148:151], v[160:163], v[52:55]
    buffer_load_dwordx4 v14, s[16:19], s75 offen offset:3072 lds
    ds_read_b128 v[184:187], v5 offset:768
    ds_read_b128 v[188:191], v5 offset:784
    ds_read_b64 v[218:219], v5 offset:800
    s_waitcnt lgkmcnt(10)
    v_mfma_f32_16x16x32_bf16 v[56:59], a[144:147], v[164:167], v[56:59]
    ds_read_b128 v[160:163], v18 offset:28672
    v_mfma_f32_16x16x32_bf16 v[60:63], a[148:151], v[164:167], v[60:63]
    ds_read_b128 v[164:167], v18 offset:38912
    s_waitcnt lgkmcnt(11)
    v_mfma_f32_16x16x32_bf16 v[64:67], a[144:147], v[168:171], v[64:67]
    s_add_u32 m0, s90, 65536
    v_mfma_f32_16x16x32_bf16 v[68:71], a[148:151], v[168:171], v[68:71]
    buffer_load_dwordx4 v15, s[16:19], s75 offen lds
    ds_read_b128 v[192:195], v5 offset:1536
    ds_read_b128 v[196:199], v5 offset:1552
    ds_read_b64 v[220:221], v5 offset:1568
    s_waitcnt lgkmcnt(13)
    v_mfma_f32_16x16x32_bf16 v[72:75], a[144:147], v[172:175], v[72:75]
    ds_read_b128 a[152:155], v17 offset:4096
    ds_read_b128 a[156:159], v17 offset:6144
    v_mfma_f32_16x16x32_bf16 v[76:79], a[148:151], v[172:175], v[76:79]
    ds_read_b128 v[168:171], v19 offset:20480
    s_waitcnt lgkmcnt(12)
    v_mfma_f32_16x16x32_bf16 v[80:83], a[144:147], v[152:155], v[80:83]
    ds_read_b128 v[172:175], v19 offset:30720
    v_mfma_f32_16x16x32_bf16 v[84:87], a[148:151], v[152:155], v[84:87]
    s_getpc_b64 s[92:93]
Lct_25:
    s_sub_u32 s92, s92, Lct_25-Lpc
    s_subb_u32 s93, s93, 0
    s_lshr_b32 s7, s2, 3
    s_lshl_b32 s7, s7, 2
    s_add_u32 s7, s7, s3
    s_lshl_b32 s7, s7, 7
    v_lshl_add_u32 v6, v1, 14, s7
    v_min_u32 v6, Lcode_end-Lpc, v6
    s_mov_b64 exec, 15
    global_load_dword v6, v6, s[92:93]
    s_mov_b64 exec, -1
    ds_read_b128 v[200:203], v5 offset:2304
    ds_read_b128 v[204:207], v5 offset:2320
    ds_read_b64 v[222:223], v5 offset:2336
    s_waitcnt lgkmcnt(15)
    v_mfma_f32_16x16x32_bf16 v[88:91], a[144:147], v[156:159], v[88:91]
    ds_read_b128 v[152:155], v19 offset:22528
    v_mfma_f32_16x16x32_bf16 v[92:95], a[148:151], v[156:159], v[92:95]
    ds_read_b128 v[156:159], v19 offset:32768
    s_waitcnt lgkmcnt(13)
    v_mfma_f32_16x16x32_bf16 v[96:99], a[144:147], v[160:163], v[96:99]
    v_mfma_f32_16x16x32_bf16 v[100:103], a[148:151], v[160:163], v[100:103]
    s_lshl_b32 s7, s5, 4
    s_add_u32 s7, s7, s4
    s_mul_i32 s7, s7, 128
    s_add_u32 s7, s7, 11108352
    s_mov_b64 exec, 1
    buffer_load_dword v7, v1, s[20:23], s7 offen
    s_mov_b64 exec, -1
    ds_read_b128 v[208:211], v5 offset:3072
    ds_read_b128 v[212:215], v5 offset:3088
    ds_read_b64 v[224:225], v5 offset:3104
    v_accvgpr_read_b32 v2, a244
    v_accvgpr_read_b32 v3, a246
    v_accvgpr_read_b32 v4, a247
    s_waitcnt lgkmcnt(15)
    v_mfma_f32_16x16x32_bf16 v[104:107], a[144:147], v[164:167], v[104:107]
    ds_read_b128 v[160:163], v19 offset:24576
    v_mfma_f32_16x16x32_bf16 v[108:111], a[148:151], v[164:167], v[108:111]
    ds_read_b128 v[164:167], v19 offset:34816
    s_mov_b64 exec, 0xffff
    s_mov_b32 s96, 0
    s_branch LK_fc_27
LK_fl_26:
    buffer_load_dword v31, v30, s[20:23], 0 offen sc1
    s_add_u32 s96, s96, 1
    s_waitcnt vmcnt(0)
LK_fc_27:
    v_cmp_ne_u32 vcc, s6, v31
    s_cmp_gt_u32 s96, 0x20000
    s_cbranch_scc1 LK_fe_28
    s_cbranch_vccnz LK_fl_26
LK_fe_28:
    s_mov_b64 exec, -1
    s_waitcnt lgkmcnt(11)
    v_mfma_f32_16x16x32_bf16 v[32:35], a[152:155], v[168:171], v[32:35]
    s_mul_i32 s50, s84, 10240
    s_add_u32 s50, s50, 11534336
    v_mfma_f32_16x16x32_bf16 v[36:39], a[156:159], v[168:171], v[36:39]
    buffer_load_dwordx4 a[160:163], v26, s[20:23], s50 offen offset:0 sc1
    s_waitcnt lgkmcnt(10)
    v_mfma_f32_16x16x32_bf16 v[40:43], a[152:155], v[172:175], v[40:43]
    ds_read_b128 v[168:171], v19 offset:26624
    v_mfma_f32_16x16x32_bf16 v[44:47], a[156:159], v[172:175], v[44:47]
    ds_read_b128 v[172:175], v19 offset:36864
    s_waitcnt lgkmcnt(8)
    v_mfma_f32_16x16x32_bf16 v[48:51], a[152:155], v[152:155], v[48:51]
    v_mfma_f32_16x16x32_bf16 v[52:55], a[156:159], v[152:155], v[52:55]
    buffer_load_dwordx4 a[164:167], v26, s[20:23], s50 offen offset:2048 sc1
    s_waitcnt lgkmcnt(7)
    v_mfma_f32_16x16x32_bf16 v[56:59], a[152:155], v[156:159], v[56:59]
    ds_read_b128 v[152:155], v19 offset:28672
    v_mfma_f32_16x16x32_bf16 v[60:63], a[156:159], v[156:159], v[60:63]
    ds_read_b128 v[156:159], v19 offset:38912
    s_waitcnt lgkmcnt(5)
    v_mfma_f32_16x16x32_bf16 v[64:67], a[152:155], v[160:163], v[64:67]
    v_mfma_f32_16x16x32_bf16 v[68:71], a[156:159], v[160:163], v[68:71]
    buffer_load_dwordx4 a[168:171], v27, s[20:23], s50 offen offset:0 sc1
    s_waitcnt lgkmcnt(4)
    v_mfma_f32_16x16x32_bf16 v[72:75], a[152:155], v[164:167], v[72:75]
    v_mfma_f32_16x16x32_bf16 v[76:79], a[156:159], v[164:167], v[76:79]
    s_waitcnt lgkmcnt(3)
    v_mfma_f32_16x16x32_bf16 v[80:83], a[152:155], v[168:171], v[80:83]
    v_mfma_f32_16x16x32_bf16 v[84:87], a[156:159], v[168:171], v[84:87]
    buffer_load_dwordx4 a[172:175], v27, s[20:23], s50 offen offset:2048 sc1
    s_waitcnt lgkmcnt(2)
    v_mfma_f32_16x16x32_bf16 v[88:91], a[152:155], v[172:175], v[88:91]
    v_mfma_f32_16x16x32_bf16 v[92:95], a[156:159], v[172:175], v[92:95]
    s_waitcnt lgkmcnt(1)
    v_mfma_f32_16x16x32_bf16 v[96:99], a[152:155], v[152:155], v[96:99]
    v_mfma_f32_16x16x32_bf16 v[100:103], a[156:159], v[152:155], v[100:103]
    buffer_load_dwordx4 a[176:179], v28, s[20:23], s50 offen offset:0 sc1
    s_waitcnt lgkmcnt(0)
    v_mfma_f32_16x16x32_bf16 v[104:107], a[152:155], v[156:159], v[104:107]
    v_mfma_f32_16x16x32_bf16 v[108:111], a[156:159], v[156:159], v[108:111]
    v_pk_mul_f32 v[228:229], v[32:33], v[216:217] op_sel_hi:[1,0]
    v_pk_mul_f32 v[230:231], v[32:33], v[216:217] op_sel:[0,1] op_sel_hi:[1,1] neg_lo:[0,1] neg_hi:[0,1]
    v_pk_fma_f32 v[32:33], v[40:41], v[216:217], v[228:229] op_sel:[0,1,0] op_sel_hi:[1,1,1] neg_lo:[0,1,0] neg_hi:[0,1,0]
    v_pk_fma_f32 v[40:41], v[40:41], v[216:217], v[230:231] op_sel_hi:[1,0,1] neg_lo:[0,1,0] neg_hi:[0,1,0]
    v_pk_mul_f32 v[228:229], v[34:35], v[216:217] op_sel_hi:[1,0]
    v_pk_mul_f32 v[230:231], v[34:35], v[216:217] op_sel:[0,1] op_sel_hi:[1,1] neg_lo:[0,1] neg_hi:[0,1]
    v_pk_fma_f32 v[34:35], v[42:43], v[216:217], v[228:229] op_sel:[0,1,0] op_sel_hi:[1,1,1] neg_lo:[0,1,0] neg_hi:[0,1,0]
    v_pk_fma_f32 v[42:43], v[42:43], v[216:217], v[230:231] op_sel_hi:[1,0,1] neg_lo:[0,1,0] neg_hi:[0,1,0]
    v_pk_mul_f32 v[228:229], v[36:37], v[216:217] op_sel_hi:[1,0]
    v_pk_mul_f32 v[230:231], v[36:37], v[216:217] op_sel:[0,1] op_sel_hi:[1,1] neg_lo:[0,1] neg_hi:[0,1]
    v_pk_fma_f32 v[36:37], v[44:45], v[216:217], v[228:229] op_sel:[0,1,0] op_sel_hi:[1,1,1] neg_lo:[0,1,0] neg_hi:[0,1,0]
    v_pk_fma_f32 v[44:45], v[44:45], v[216:217], v[230:231] op_sel_hi:[1,0,1] neg_lo:[0,1,0] neg_hi:[0,1,0]
    v_pk_mul_f32 v[228:229], v[38:39], v[216:217] op_sel_hi:[1,0]
    v_pk_mul_f32 v[230:231], v[38:39], v[216:217] op_sel:[0,1] op_sel_hi:[1,1] neg_lo:[0,1] neg_hi:[0,1]
    v_pk_fma_f32 v[38:39], v[46:47], v[216:217], v[228:229] op_sel:[0,1,0] op_sel_hi:[1,1,1] neg_lo:[0,1,0] neg_hi:[0,1,0]
    v_pk_fma_f32 v[46:47], v[46:47], v[216:217], v[230:231] op_sel_hi:[1,0,1] neg_lo:[0,1,0] neg_hi:[0,1,0]
    v_pk_fma_f32 v[34:35], v[32:33], v[176:177], v[34:35] op_sel_hi:[1,0,1]
    v_pk_fma_f32 v[42:43], v[40:41], v[176:177], v[42:43] op_sel_hi:[1,0,1]
    v_pk_fma_f32 v[34:35], v[40:41], v[176:177], v[34:35] op_sel:[0,1,0] op_sel_hi:[1,1,1] neg_lo:[0,1,0] neg_hi:[0,1,0]
    v_pk_fma_f32 v[42:43], v[32:33], v[176:177], v[42:43] op_sel:[0,1,0] op_sel_hi:[1,1,1]
    v_pk_fma_f32 v[36:37], v[34:35], v[176:177], v[36:37] op_sel_hi:[1,0,1]
    v_pk_fma_f32 v[44:45], v[42:43], v[176:177], v[44:45] op_sel_hi:[1,0,1]
    v_pk_fma_f32 v[36:37], v[42:43], v[176:177], v[36:37] op_sel:[0,1,0] op_sel_hi:[1,1,1] neg_lo:[0,1,0] neg_hi:[0,1,0]
    v_pk_fma_f32 v[44:45], v[34:35], v[176:177], v[44:45] op_sel:[0,1,0] op_sel_hi:[1,1,1]
    v_pk_fma_f32 v[38:39], v[36:37], v[176:177], v[38:39] op_sel_hi:[1,0,1]
    v_pk_fma_f32 v[46:47], v[44:45], v[176:177], v[46:47] op_sel_hi:[1,0,1]
    v_pk_fma_f32 v[38:39], v[44:45], v[176:177], v[38:39] op_sel:[0,1,0] op_sel_hi:[1,1,1] neg_lo:[0,1,0] neg_hi:[0,1,0]
    v_pk_fma_f32 v[46:47], v[36:37], v[176:177], v[46:47] op_sel:[0,1,0] op_sel_hi:[1,1,1]
    v_fma_f32 v216, v182, v38, v39
    v_fma_f32 v217, v182, v46, v47
    v_fma_f32 v216, -v183, v46, v216
    v_fma_f32 v217, v183, v38, v217
    ds_write_b64 v2, v[216:217] offset:10240
    buffer_load_dwordx4 a[180:183], v26, s[20:23], s50 offen offset:1024 sc1
    buffer_load_dwordx4 a[184:187], v26, s[20:23], s50 offen offset:3072 sc1
    v_pk_mul_f32 v[228:229], v[48:49], v[218:219] op_sel_hi:[1,0]
    v_pk_mul_f32 v[230:231], v[48:49], v[218:219] op_sel:[0,1] op_sel_hi:[1,1] neg_lo:[0,1] neg_hi:[0,1]
    v_pk_fma_f32 v[48:49], v[56:57], v[218:219], v[228:229] op_sel:[0,1,0] op_sel_hi:[1,1,1] neg_lo:[0,1,0] neg_hi:[0,1,0]
    v_pk_fma_f32 v[56:57], v[56:57], v[218:219], v[230:231] op_sel_hi:[1,0,1] neg_lo:[0,1,0] neg_hi:[0,1,0]
    v_pk_mul_f32 v[228:229], v[50:51], v[218:219] op_sel_hi:[1,0]
    v_pk_mul_f32 v[230:231], v[50:51], v[218:219] op_sel:[0,1] op_sel_hi:[1,1] neg_lo:[0,1] neg_hi:[0,1]
    v_pk_fma_f32 v[50:51], v[58:59], v[218:219], v[228:229] op_sel:[0,1,0] op_sel_hi:[1,1,1] neg_lo:[0,1,0] neg_hi:[0,1,0]
    v_pk_fma_f32 v[58:59], v[58:59], v[218:219], v[230:231] op_sel_hi:[1,0,1] neg_lo:[0,1,0] neg_hi:[0,1,0]
    v_pk_mul_f32 v[228:229], v[52:53], v[218:219] op_sel_hi:[1,0]
    v_pk_mul_f32 v[230:231], v[52:53], v[218:219] op_sel:[0,1] op_sel_hi:[1,1] neg_lo:[0,1] neg_hi:[0,1]
    v_pk_fma_f32 v[52:53], v[60:61], v[218:219], v[228:229] op_sel:[0,1,0] op_sel_hi:[1,1,1] neg_lo:[0,1,0] neg_hi:[0,1,0]
    v_pk_fma_f32 v[60:61], v[60:61], v[218:219], v[230:231] op_sel_hi:[1,0,1] neg_lo:[0,1,0] neg_hi:[0,1,0]
    v_pk_mul_f32 v[228:229], v[54:55], v[218:219] op_sel_hi:[1,0]
    v_pk_mul_f32 v[230:231], v[54:55], v[218:219] op_sel:[0,1] op_sel_hi:[1,1] neg_lo:[0,1] neg_hi:[0,1]
    v_pk_fma_f32 v[54:55], v[62:63], v[218:219], v[228:229] op_sel:[0,1,0] op_sel_hi:[1,1,1] neg_lo:[0,1,0] neg_hi:[0,1,0]
    v_pk_fma_f32 v[62:63], v[62:63], v[218:219], v[230:231] op_sel_hi:[1,0,1] neg_lo:[0,1,0] neg_hi:[0,1,0]
    v_pk_fma_f32 v[50:51], v[48:49], v[184:185], v[50:51] op_sel_hi:[1,0,1]
    v_pk_fma_f32 v[58:59], v[56:57], v[184:185], v[58:59] op_sel_hi:[1,0,1]
    v_pk_fma_f32 v[50:51], v[56:57], v[184:185], v[50:51] op_sel:[0,1,0] op_sel_hi:[1,1,1] neg_lo:[0,1,0] neg_hi:[0,1,0]
    v_pk_fma_f32 v[58:59], v[48:49], v[184:185], v[58:59] op_sel:[0,1,0] op_sel_hi:[1,1,1]
    v_pk_fma_f32 v[52:53], v[50:51], v[184:185], v[52:53] op_sel_hi:[1,0,1]
    v_pk_fma_f32 v[60:61], v[58:59], v[184:185], v[60:61] op_sel_hi:[1,0,1]
    v_pk_fma_f32 v[52:53], v[58:59], v[184:185], v[52:53] op_sel:[0,1,0] op_sel_hi:[1,1,1] neg_lo:[0,1,0] neg_hi:[0,1,0]
    v_pk_fma_f32 v[60:61], v[50:51], v[184:185], v[60:61] op_sel:[0,1,0] op_sel_hi:[1,1,1]
    v_pk_fma_f32 v[54:55], v[52:53], v[184:185], v[54:55] op_sel_hi:[1,0,1]
    v_pk_fma_f32 v[62:63], v[60:61], v[184:185], v[62:63] op_sel_hi:[1,0,1]
    v_pk_fma_f32 v[54:55], v[60:61], v[184:185], v[54:55] op_sel:[0,1,0] op_sel_hi:[1,1,1] neg_lo:[0,1,0] neg_hi:[0,1,0]
    v_pk_fma_f32 v[62:63], v[52:53], v[184:185], v[62:63] op_sel:[0,1,0] op_sel_hi:[1,1,1]
    v_fma_f32 v218, v190, v54, v55
    v_fma_f32 v219, v190, v62, v63
    v_fma_f32 v218, -v191, v62, v218
    v_fma_f32 v219, v191, v54, v219
    ds_write_b64 v2, v[218:219] offset:10368
    buffer_load_dwordx4 a[188:191], v27, s[20:23], s50 offen offset:1024 sc1
    buffer_load_dwordx4 a[192:195], v27, s[20:23], s50 offen offset:3072 sc1
    v_pk_mul_f32 v[228:229], v[64:65], v[220:221] op_sel_hi:[1,0]
    v_pk_mul_f32 v[230:231], v[64:65], v[220:221] op_sel:[0,1] op_sel_hi:[1,1] neg_lo:[0,1] neg_hi:[0,1]
    v_pk_fma_f32 v[64:65], v[72:73], v[220:221], v[228:229] op_sel:[0,1,0] op_sel_hi:[1,1,1] neg_lo:[0,1,0] neg_hi:[0,1,0]
    v_pk_fma_f32 v[72:73], v[72:73], v[220:221], v[230:231] op_sel_hi:[1,0,1] neg_lo:[0,1,0] neg_hi:[0,1,0]
    v_pk_mul_f32 v[228:229], v[66:67], v[220:221] op_sel_hi:[1,0]
    v_pk_mul_f32 v[230:231], v[66:67], v[220:221] op_sel:[0,1] op_sel_hi:[1,1] neg_lo:[0,1] neg_hi:[0,1]
    v_pk_fma_f32 v[66:67], v[74:75], v[220:221], v[228:229] op_sel:[0,1,0] op_sel_hi:[1,1,1] neg_lo:[0,1,0] neg_hi:[0,1,0]
    v_pk_fma_f32 v[74:75], v[74:75], v[220:221], v[230:231] op_sel_hi:[1,0,1] neg_lo:[0,1,0] neg_hi:[0,1,0]
    v_pk_mul_f32 v[228:229], v[68:69], v[220:221] op_sel_hi:[1,0]
    v_pk_mul_f32 v[230:231], v[68:69], v[220:221] op_sel:[0,1] op_sel_hi:[1,1] neg_lo:[0,1] neg_hi:[0,1]
    v_pk_fma_f32 v[68:69], v[76:77], v[220:221], v[228:229] op_sel:[0,1,0] op_sel_hi:[1,1,1] neg_lo:[0,1,0] neg_hi:[0,1,0]
    v_pk_fma_f32 v[76:77], v[76:77], v[220:221], v[230:231] op_sel_hi:[1,0,1] neg_lo:[0,1,0] neg_hi:[0,1,0]
    v_pk_mul_f32 v[228:229], v[70:71], v[220:221] op_sel_hi:[1,0]
    v_pk_mul_f32 v[230:231], v[70:71], v[220:221] op_sel:[0,1] op_sel_hi:[1,1] neg_lo:[0,1] neg_hi:[0,1]
    v_pk_fma_f32 v[70:71], v[78:79], v[220:221], v[228:229] op_sel:[0,1,0] op_sel_hi:[1,1,1] neg_lo:[0,1,0] neg_hi:[0,1,0]
    v_pk_fma_f32 v[78:79], v[78:79], v[220:221], v[230:231] op_sel_hi:[1,0,1] neg_lo:[0,1,0] neg_hi:[0,1,0]
    v_pk_fma_f32 v[66:67], v[64:65], v[192:193], v[66:67] op_sel_hi:[1,0,1]
    v_pk_fma_f32 v[74:75], v[72:73], v[192:193], v[74:75] op_sel_hi:[1,0,1]
    v_pk_fma_f32 v[66:67], v[72:73], v[192:193], v[66:67] op_sel:[0,1,0] op_sel_hi:[1,1,1] neg_lo:[0,1,0] neg_hi:[0,1,0]
    v_pk_fma_f32 v[74:75], v[64:65], v[192:193], v[74:75] op_sel:[0,1,0] op_sel_hi:[1,1,1]
    v_pk_fma_f32 v[68:69], v[66:67], v[192:193], v[68:69] op_sel_hi:[1,0,1]
    v_pk_fma_f32 v[76:77], v[74:75], v[192:193], v[76:77] op_sel_hi:[1,0,1]
    v_pk_fma_f32 v[68:69], v[74:75], v[192:193], v[68:69] op_sel:[0,1,0] op_sel_hi:[1,1,1] neg_lo:[0,1,0] neg_hi:[0,1,0]
    v_pk_fma_f32 v[76:77], v[66:67], v[192:193], v[76:77] op_sel:[0,1,0] op_sel_hi:[1,1,1]
    v_pk_fma_f32 v[70:71], v[68:69], v[192:193], v[70:71] op_sel_hi:[1,0,1]
    v_pk_fma_f32 v[78:79], v[76:77], v[192:193], v[78:79] op_sel_hi:[1,0,1]
    v_pk_fma_f32 v[70:71], v[76:77], v[192:193], v[70:71] op_sel:[0,1,0] op_sel_hi:[1,1,1] neg_lo:[0,1,0] neg_hi:[0,1,0]
    v_pk_fma_f32 v[78:79], v[68:69], v[192:193], v[78:79] op_sel:[0,1,0] op_sel_hi:[1,1,1]
    v_fma_f32 v220, v198, v70, v71
    v_fma_f32 v221, v198, v78, v79
    v_fma_f32 v220, -v199, v78, v220
    v_fma_f32 v221, v199, v70, v221
    ds_write_b64 v2, v[220:221] offset:10496
    buffer_load_dwordx4 a[196:199], v28, s[20:23], s50 offen offset:1024 sc1
    v_pk_mul_f32 v[228:229], v[80:81], v[222:223] op_sel_hi:[1,0]
    v_pk_mul_f32 v[230:231], v[80:81], v[222:223] op_sel:[0,1] op_sel_hi:[1,1] neg_lo:[0,1] neg_hi:[0,1]
    v_pk_fma_f32 v[80:81], v[88:89], v[222:223], v[228:229] op_sel:[0,1,0] op_sel_hi:[1,1,1] neg_lo:[0,1,0] neg_hi:[0,1,0]
    v_pk_fma_f32 v[88:89], v[88:89], v[222:223], v[230:231] op_sel_hi:[1,0,1] neg_lo:[0,1,0] neg_hi:[0,1,0]
    v_pk_mul_f32 v[228:229], v[82:83], v[222:223] op_sel_hi:[1,0]
    v_pk_mul_f32 v[230:231], v[82:83], v[222:223] op_sel:[0,1] op_sel_hi:[1,1] neg_lo:[0,1] neg_hi:[0,1]
    v_pk_fma_f32 v[82:83], v[90:91], v[222:223], v[228:229] op_sel:[0,1,0] op_sel_hi:[1,1,1] neg_lo:[0,1,0] neg_hi:[0,1,0]
    v_pk_fma_f32 v[90:91], v[90:91], v[222:223], v[230:231] op_sel_hi:[1,0,1] neg_lo:[0,1,0] neg_hi:[0,1,0]
    v_pk_mul_f32 v[228:229], v[84:85], v[222:223] op_sel_hi:[1,0]
    v_pk_mul_f32 v[230:231], v[84:85], v[222:223] op_sel:[0,1] op_sel_hi:[1,1] neg_lo:[0,1] neg_hi:[0,1]
    v_pk_fma_f32 v[84:85], v[92:93], v[222:223], v[228:229] op_sel:[0,1,0] op_sel_hi:[1,1,1] neg_lo:[0,1,0] neg_hi:[0,1,0]
    v_pk_fma_f32 v[92:93], v[92:93], v[222:223], v[230:231] op_sel_hi:[1,0,1] neg_lo:[0,1,0] neg_hi:[0,1,0]
    v_pk_mul_f32 v[228:229], v[86:87], v[222:223] op_sel_hi:[1,0]
    v_pk_mul_f32 v[230:231], v[86:87], v[222:223] op_sel:[0,1] op_sel_hi:[1,1] neg_lo:[0,1] neg_hi:[0,1]
    v_pk_fma_f32 v[86:87], v[94:95], v[222:223], v[228:229] op_sel:[0,1,0] op_sel_hi:[1,1,1] neg_lo:[0,1,0] neg_hi:[0,1,0]
    v_pk_fma_f32 v[94:95], v[94:95], v[222:223], v[230:231] op_sel_hi:[1,0,1] neg_lo:[0,1,0] neg_hi:[0,1,0]
    v_pk_fma_f32 v[82:83], v[80:81], v[200:201], v[82:83] op_sel_hi:[1,0,1]
    v_pk_fma_f32 v[90:91], v[88:89], v[200:201], v[90:91] op_sel_hi:[1,0,1]
    v_pk_fma_f32 v[82:83], v[88:89], v[200:201], v[82:83] op_sel:[0,1,0] op_sel_hi:[1,1,1] neg_lo:[0,1,0] neg_hi:[0,1,0]
    v_pk_fma_f32 v[90:91], v[80:81], v[200:201], v[90:91] op_sel:[0,1,0] op_sel_hi:[1,1,1]
    v_pk_fma_f32 v[84:85], v[82:83], v[200:201], v[84:85] op_sel_hi:[1,0,1]
    v_pk_fma_f32 v[92:93], v[90:91], v[200:201], v[92:93] op_sel_hi:[1,0,1]
    v_pk_fma_f32 v[84:85], v[90:91], v[200:201], v[84:85] op_sel:[0,1,0] op_sel_hi:[1,1,1] neg_lo:[0,1,0] neg_hi:[0,1,0]
    v_pk_fma_f32 v[92:93], v[82:83], v[200:201], v[92:93] op_sel:[0,1,0] op_sel_hi:[1,1,1]
    v_pk_fma_f32 v[86:87], v[84:85], v[200:201], v[86:87] op_sel_hi:[1,0,1]
    v_pk_fma_f32 v[94:95], v[92:93], v[200:201], v[94:95] op_sel_hi:[1,0,1]
    v_pk_fma_f32 v[86:87], v[92:93], v[200:201], v[86:87] op_sel:[0,1,0] op_sel_hi:[1,1,1] neg_lo:[0,1,0] neg_hi:[0,1,0]
    v_pk_fma_f32 v[94:95], v[84:85], v[200:201], v[94:95] op_sel:[0,1,0] op_sel_hi:[1,1,1]
    v_fma_f32 v222, v206, v86, v87
    v_fma_f32 v223, v206, v94, v95
    v_fma_f32 v222, -v207, v94, v222
    v_fma_f32 v223, v207, v86, v223
    ds_write_b64 v2, v[222:223] offset:10624
    v_pk_mul_f32 v[228:229], v[96:97], v[224:225] op_sel_hi:[1,0]
    v_pk_mul_f32 v[230:231], v[96:97], v[224:225] op_sel:[0,1] op_sel_hi:[1,1] neg_lo:[0,1] neg_hi:[0,1]
    v_pk_fma_f32 v[96:97], v[104:105], v[224:225], v[228:229] op_sel:[0,1,0] op_sel_hi:[1,1,1] neg_lo:[0,1,0] neg_hi:[0,1,0]
    v_pk_fma_f32 v[104:105], v[104:105], v[224:225], v[230:231] op_sel_hi:[1,0,1] neg_lo:[0,1,0] neg_hi:[0,1,0]
    v_pk_mul_f32 v[228:229], v[98:99], v[224:225] op_sel_hi:[1,0]
    v_pk_mul_f32 v[230:231], v[98:99], v[224:225] op_sel:[0,1] op_sel_hi:[1,1] neg_lo:[0,1] neg_hi:[0,1]
    v_pk_fma_f32 v[98:99], v[106:107], v[224:225], v[228:229] op_sel:[0,1,0] op_sel_hi:[1,1,1] neg_lo:[0,1,0] neg_hi:[0,1,0]
    v_pk_fma_f32 v[106:107], v[106:107], v[224:225], v[230:231] op_sel_hi:[1,0,1] neg_lo:[0,1,0] neg_hi:[0,1,0]
    v_pk_mul_f32 v[228:229], v[100:101], v[224:225] op_sel_hi:[1,0]
    v_pk_mul_f32 v[230:231], v[100:101], v[224:225] op_sel:[0,1] op_sel_hi:[1,1] neg_lo:[0,1] neg_hi:[0,1]
    v_pk_fma_f32 v[100:101], v[108:109], v[224:225], v[228:229] op_sel:[0,1,0] op_sel_hi:[1,1,1] neg_lo:[0,1,0] neg_hi:[0,1,0]
    v_pk_fma_f32 v[108:109], v[108:109], v[224:225], v[230:231] op_sel_hi:[1,0,1] neg_lo:[0,1,0] neg_hi:[0,1,0]
    v_pk_mul_f32 v[228:229], v[102:103], v[224:225] op_sel_hi:[1,0]
    v_pk_mul_f32 v[230:231], v[102:103], v[224:225] op_sel:[0,1] op_sel_hi:[1,1] neg_lo:[0,1] neg_hi:[0,1]
    v_pk_fma_f32 v[102:103], v[110:111], v[224:225], v[228:229] op_sel:[0,1,0] op_sel_hi:[1,1,1] neg_lo:[0,1,0] neg_hi:[0,1,0]
    v_pk_fma_f32 v[110:111], v[110:111], v[224:225], v[230:231] op_sel_hi:[1,0,1] neg_lo:[0,1,0] neg_hi:[0,1,0]
    v_pk_fma_f32 v[98:99], v[96:97], v[208:209], v[98:99] op_sel_hi:[1,0,1]
    v_pk_fma_f32 v[106:107], v[104:105], v[208:209], v[106:107] op_sel_hi:[1,0,1]
    v_pk_fma_f32 v[98:99], v[104:105], v[208:209], v[98:99] op_sel:[0,1,0] op_sel_hi:[1,1,1] neg_lo:[0,1,0] neg_hi:[0,1,0]
    v_pk_fma_f32 v[106:107], v[96:97], v[208:209], v[106:107] op_sel:[0,1,0] op_sel_hi:[1,1,1]
    v_pk_fma_f32 v[100:101], v[98:99], v[208:209], v[100:101] op_sel_hi:[1,0,1]
    v_pk_fma_f32 v[108:109], v[106:107], v[208:209], v[108:109] op_sel_hi:[1,0,1]
    v_pk_fma_f32 v[100:101], v[106:107], v[208:209], v[100:101] op_sel:[0,1,0] op_sel_hi:[1,1,1] neg_lo:[0,1,0] neg_hi:[0,1,0]
    v_pk_fma_f32 v[108:109], v[98:99], v[208:209], v[108:109] op_sel:[0,1,0] op_sel_hi:[1,1,1]
    v_pk_fma_f32 v[102:103], v[100:101], v[208:209], v[102:103] op_sel_hi:[1,0,1]
    v_pk_fma_f32 v[110:111], v[108:109], v[208:209], v[110:111] op_sel_hi:[1,0,1]
    v_pk_fma_f32 v[102:103], v[108:109], v[208:209], v[102:103] op_sel:[0,1,0] op_sel_hi:[1,1,1] neg_lo:[0,1,0] neg_hi:[0,1,0]
    v_pk_fma_f32 v[110:111], v[100:101], v[208:209], v[110:111] op_sel:[0,1,0] op_sel_hi:[1,1,1]
    v_fma_f32 v224, v214, v102, v103
    v_fma_f32 v225, v214, v110, v111
    v_fma_f32 v224, -v215, v110, v224
    v_fma_f32 v225, v215, v102, v225
    ds_write_b64 v2, v[224:225] offset:10752
    s_waitcnt lgkmcnt(0)
    s_waitcnt vmcnt(17)
    s_barrier
    ds_read_b64_tr_b16 v[152:153], v24 offset:0
    ds_read_b64_tr_b16 v[154:155], v25 offset:0
    ds_read_b64_tr_b16 v[156:157], v24 offset:8
    ds_read_b64_tr_b16 v[158:159], v25 offset:8
    ds_read_b64_tr_b16 v[160:161], v24 offset:16
    ds_read_b64_tr_b16 v[162:163], v25 offset:16
    ds_read_b64_tr_b16 v[164:165], v24 offset:24
    ds_read_b64_tr_b16 v[166:167], v25 offset:24
    ds_read_b64_tr_b16 v[168:169], v24 offset:32
    ds_read_b64_tr_b16 v[170:171], v25 offset:32
    ds_read_b64_tr_b16 v[172:173], v24 offset:5120
    ds_read_b64_tr_b16 v[174:175], v25 offset:5120
    s_cmp_ge_u32 s3, 2
    s_cbranch_scc1 LB_lt
    ds_read2_b64 v[216:219], v3 offset0:0 offset1:80
    ds_read2_b64 v[220:223], v3 offset0:160 offset1:240
    v_add_u32 v3, 16384, v3
    ds_read2_b64 v[224:227], v3 offset0:0 offset1:80
    ds_read2_b64 v[228:231], v3 offset0:160 offset1:240
    v_add_u32 v3, 16384, v3
    ds_read2_b64 v[232:235], v3 offset0:0 offset1:80
    ds_read2_b64 v[236:239], v3 offset0:160 offset1:240
    v_add_u32 v3, 16384, v3
    ds_read2_b64 v[240:243], v3 offset0:0 offset1:80
    ds_read2_b64 v[244:247], v3 offset0:160 offset1:240
    v_mov_b32 v252, 0
    v_mov_b32 v253, 0
    v_mov_b32 v5, s6
    s_movk_i32 s93, 0xff
    s_waitcnt lgkmcnt(7)
    v_pk_fma_f32 v[218:219], v[216:217], v[250:251], v[218:219] op_sel_hi:[1,0,1]
    v_pk_fma_f32 v[218:219], v[216:217], v[250:251], v[218:219] op_sel:[1,1,0] op_sel_hi:[0,1,1] neg_lo:[0,1,0]
    s_waitcnt lgkmcnt(6)
    v_pk_fma_f32 v[220:221], v[218:219], v[250:251], v[220:221] op_sel_hi:[1,0,1]
    v_pk_fma_f32 v[220:221], v[218:219], v[250:251], v[220:221] op_sel:[1,1,0] op_sel_hi:[0,1,1] neg_lo:[0,1,0]
    v_pk_fma_f32 v[222:223], v[220:221], v[250:251], v[222:223] op_sel_hi:[1,0,1]
    v_pk_fma_f32 v[222:223], v[220:221], v[250:251], v[222:223] op_sel:[1,1,0] op_sel_hi:[0,1,1] neg_lo:[0,1,0]
    s_waitcnt lgkmcnt(5)
    v_pk_fma_f32 v[224:225], v[222:223], v[250:251], v[224:225] op_sel_hi:[1,0,1]
    v_pk_fma_f32 v[224:225], v[222:223], v[250:251], v[224:225] op_sel:[1,1,0] op_sel_hi:[0,1,1] neg_lo:[0,1,0]
    v_pk_fma_f32 v[226:227], v[224:225], v[250:251], v[226:227] op_sel_hi:[1,0,1]
    v_pk_fma_f32 v[226:227], v[224:225], v[250:251], v[226:227] op_sel:[1,1,0] op_sel_hi:[0,1,1] neg_lo:[0,1,0]
    s_waitcnt lgkmcnt(4)
    v_pk_fma_f32 v[228:229], v[226:227], v[250:251], v[228:229] op_sel_hi:[1,0,1]
    v_pk_fma_f32 v[228:229], v[226:227], v[250:251], v[228:229] op_sel:[1,1,0] op_sel_hi:[0,1,1] neg_lo:[0,1,0]
    v_pk_fma_f32 v[230:231], v[228:229], v[250:251], v[230:231] op_sel_hi:[1,0,1]
    v_pk_fma_f32 v[230:231], v[228:229], v[250:251], v[230:231] op_sel:[1,1,0] op_sel_hi:[0,1,1] neg_lo:[0,1,0]
    s_waitcnt lgkmcnt(3)
    v_pk_fma_f32 v[232:233], v[230:231], v[250:251], v[232:233] op_sel_hi:[1,0,1]
    v_pk_fma_f32 v[232:233], v[230:231], v[250:251], v[232:233] op_sel:[1,1,0] op_sel_hi:[0,1,1] neg_lo:[0,1,0]
    v_pk_fma_f32 v[234:235], v[232:233], v[250:251], v[234:235] op_sel_hi:[1,0,1]
    v_pk_fma_f32 v[234:235], v[232:233], v[250:251], v[234:235] op_sel:[1,1,0] op_sel_hi:[0,1,1] neg_lo:[0,1,0]
    s_waitcnt lgkmcnt(2)
    v_pk_fma_f32 v[236:237], v[234:235], v[250:251], v[236:237] op_sel_hi:[1,0,1]
    v_pk_fma_f32 v[236:237], v[234:235], v[250:251], v[236:237] op_sel:[1,1,0] op_sel_hi:[0,1,1] neg_lo:[0,1,0]
    v_pk_fma_f32 v[238:239], v[236:237], v[250:251], v[238:239] op_sel_hi:[1,0,1]
    v_pk_fma_f32 v[238:239], v[236:237], v[250:251], v[238:239] op_sel:[1,1,0] op_sel_hi:[0,1,1] neg_lo:[0,1,0]
    s_waitcnt lgkmcnt(1)
    v_pk_fma_f32 v[240:241], v[238:239], v[250:251], v[240:241] op_sel_hi:[1,0,1]
    v_pk_fma_f32 v[240:241], v[238:239], v[250:251], v[240:241] op_sel:[1,1,0] op_sel_hi:[0,1,1] neg_lo:[0,1,0]
    v_pk_fma_f32 v[242:243], v[240:241], v[250:251], v[242:243] op_sel_hi:[1,0,1]
    v_pk_fma_f32 v[242:243], v[240:241], v[250:251], v[242:243] op_sel:[1,1,0] op_sel_hi:[0,1,1] neg_lo:[0,1,0]
    s_waitcnt lgkmcnt(0)
    v_pk_fma_f32 v[244:245], v[242:243], v[250:251], v[244:245] op_sel_hi:[1,0,1]
    v_pk_fma_f32 v[244:245], v[242:243], v[250:251], v[244:245] op_sel:[1,1,0] op_sel_hi:[0,1,1] neg_lo:[0,1,0]
    v_pk_fma_f32 v[246:247], v[244:245], v[250:251], v[246:247] op_sel_hi:[1,0,1]
    v_pk_fma_f32 v[246:247], v[244:245], v[250:251], v[246:247] op_sel:[1,1,0] op_sel_hi:[0,1,1] neg_lo:[0,1,0]
    v_bfi_b32 v246, s93, v5, v246
    v_bfi_b32 v247, s93, v5, v247
    buffer_store_dwordx2 v[246:247], v4, s[20:23], s60 offen sc1
    s_mov_b64 exec, s[34:35]
    ds_write2_b64 v3, v[242:243], v[244:245] offset0:160 offset1:240
    ds_write2_b64 v3, v[238:239], v[240:241] offset0:0 offset1:80
    v_subrev_u32 v3, 16384, v3
    ds_write2_b64 v3, v[234:235], v[236:237] offset0:160 offset1:240
    ds_write2_b64 v3, v[230:231], v[232:233] offset0:0 offset1:80
    v_subrev_u32 v3, 16384, v3
    ds_write2_b64 v3, v[226:227], v[228:229] offset0:160 offset1:240
    ds_write2_b64 v3, v[222:223], v[224:225] offset0:0 offset1:80
    v_subrev_u32 v3, 16384, v3
    ds_write2_b64 v3, v[218:219], v[220:221] offset0:160 offset1:240
    ds_write2_b64 v3, v[252:253], v[216:217] offset0:0 offset1:80
    s_branch LB_nocarry1
LB_lt:
    v_lshlrev_b32 v216, 3, v0
    v_add_u32 v216, 151552, v216
    v_mov_b32 v218, 1.0
    v_mov_b32 v219, 0
    v_cmp_gt_u32 vcc, 208, v0
    s_nop 0
    s_mov_b64 exec, vcc
    ds_write2_b64 v216, v[218:219], v[250:251] offset0:0 offset1:80
    v_pk_mul_f32 v[224:225], v[250:251], v[250:251] op_sel_hi:[1,0]
    v_pk_fma_f32 v[224:225], v[250:251], v[250:251], v[224:225] op_sel:[1,1,0] op_sel_hi:[0,1,1] neg_lo:[0,1,0]
    ds_write_b64 v216, v[224:225] offset:1280
    v_pk_mul_f32 v[226:227], v[224:225], v[250:251] op_sel_hi:[1,0]
    v_pk_fma_f32 v[226:227], v[224:225], v[250:251], v[226:227] op_sel:[1,1,0] op_sel_hi:[0,1,1] neg_lo:[0,1,0]
    ds_write_b64 v216, v[226:227] offset:1920
    v_pk_mul_f32 v[220:221], v[226:227], v[250:251] op_sel_hi:[1,0]
    v_pk_fma_f32 v[220:221], v[226:227], v[250:251], v[220:221] op_sel:[1,1,0] op_sel_hi:[0,1,1] neg_lo:[0,1,0]
    ds_write_b64 v216, v[220:221] offset:2560
    v_pk_mul_f32 v[222:223], v[220:221], v[250:251] op_sel_hi:[1,0]
    v_pk_fma_f32 v[222:223], v[220:221], v[250:251], v[222:223] op_sel:[1,1,0] op_sel_hi:[0,1,1] neg_lo:[0,1,0]
    ds_write_b64 v216, v[222:223] offset:3200
    v_pk_mul_f32 v[224:225], v[222:223], v[250:251] op_sel_hi:[1,0]
    v_pk_fma_f32 v[224:225], v[222:223], v[250:251], v[224:225] op_sel:[1,1,0] op_sel_hi:[0,1,1] neg_lo:[0,1,0]
    ds_write_b64 v216, v[224:225] offset:3840
    v_pk_mul_f32 v[226:227], v[224:225], v[250:251] op_sel_hi:[1,0]
    v_pk_fma_f32 v[226:227], v[224:225], v[250:251], v[226:227] op_sel:[1,1,0] op_sel_hi:[0,1,1] neg_lo:[0,1,0]
    ds_write_b64 v216, v[226:227] offset:4480
    v_pk_mul_f32 v[220:221], v[226:227], v[250:251] op_sel_hi:[1,0]
    v_pk_fma_f32 v[220:221], v[226:227], v[250:251], v[220:221] op_sel:[1,1,0] op_sel_hi:[0,1,1] neg_lo:[0,1,0]
    ds_write_b64 v216, v[220:221] offset:5120
    v_pk_mul_f32 v[222:223], v[220:221], v[250:251] op_sel_hi:[1,0]
    v_pk_fma_f32 v[222:223], v[220:221], v[250:251], v[222:223] op_sel:[1,1,0] op_sel_hi:[0,1,1] neg_lo:[0,1,0]
    ds_write_b64 v216, v[222:223] offset:5760
    v_pk_mul_f32 v[224:225], v[222:223], v[250:251] op_sel_hi:[1,0]
    v_pk_fma_f32 v[224:225], v[222:223], v[250:251], v[224:225] op_sel:[1,1,0] op_sel_hi:[0,1,1] neg_lo:[0,1,0]
    ds_write_b64 v216, v[224:225] offset:6400
    v_pk_mul_f32 v[226:227], v[224:225], v[250:251] op_sel_hi:[1,0]
    v_pk_fma_f32 v[226:227], v[224:225], v[250:251], v[226:227] op_sel:[1,1,0] op_sel_hi:[0,1,1] neg_lo:[0,1,0]
    ds_write_b64 v216, v[226:227] offset:7040
    v_pk_mul_f32 v[220:221], v[226:227], v[250:251] op_sel_hi:[1,0]
    v_pk_fma_f32 v[220:221], v[226:227], v[250:251], v[220:221] op_sel:[1,1,0] op_sel_hi:[0,1,1] neg_lo:[0,1,0]
    ds_write_b64 v216, v[220:221] offset:7680
    v_pk_mul_f32 v[222:223], v[220:221], v[250:251] op_sel_hi:[1,0]
    v_pk_fma_f32 v[222:223], v[220:221], v[250:251], v[222:223] op_sel:[1,1,0] op_sel_hi:[0,1,1] neg_lo:[0,1,0]
    ds_write_b64 v216, v[222:223] offset:8320
    v_pk_mul_f32 v[224:225], v[222:223], v[250:251] op_sel_hi:[1,0]
    v_pk_fma_f32 v[224:225], v[222:223], v[250:251], v[224:225] op_sel:[1,1,0] op_sel_hi:[0,1,1] neg_lo:[0,1,0]
    ds_write_b64 v216, v[224:225] offset:8960
    v_pk_mul_f32 v[226:227], v[224:225], v[250:251] op_sel_hi:[1,0]
    v_pk_fma_f32 v[226:227], v[224:225], v[250:251], v[226:227] op_sel:[1,1,0] op_sel_hi:[0,1,1] neg_lo:[0,1,0]
    ds_write_b64 v216, v[226:227] offset:9600
LB_nocarry1:
    s_mov_b64 exec, -1
    s_waitcnt lgkmcnt(10)
    v_mfma_f32_16x16x32_bf16 v[112:115], v[152:155], a[0:3], 0
    s_add_u32 m0, s90, 0
    v_mfma_f32_16x16x32_bf16 v[116:119], v[152:155], a[4:7], 0
    buffer_load_dwordx4 v11, s[16:19], s76 offen offset:0 lds
    s_waitcnt lgkmcnt(8)
    v_mfma_f32_16x16x32_bf16 v[120:123], v[156:159], a[0:3], 0
    ds_read_b64_tr_b16 v[152:153], v24 offset:5128
    ds_read_b64_tr_b16 v[154:155], v25 offset:5128
    v_mfma_f32_16x16x32_bf16 v[124:127], v[156:159], a[4:7], 0
    buffer_load_dwordx4 v12, s[16:19], s76 offen offset:1024 lds
    s_waitcnt lgkmcnt(8)
    v_mfma_f32_16x16x32_bf16 v[128:131], v[160:163], a[0:3], 0
    ds_read_b64_tr_b16 v[156:157], v24 offset:5136
    ds_read_b64_tr_b16 v[158:159], v25 offset:5136
    v_mfma_f32_16x16x32_bf16 v[132:135], v[160:163], a[4:7], 0
    buffer_load_dwordx4 v13, s[16:19], s76 offen offset:2048 lds
    s_waitcnt lgkmcnt(8)
    v_mfma_f32_16x16x32_bf16 v[136:139], v[164:167], a[0:3], 0
    ds_read_b64_tr_b16 v[160:161], v24 offset:5144
    ds_read_b64_tr_b16 v[162:163], v25 offset:5144
    v_mfma_f32_16x16x32_bf16 v[140:143], v[164:167], a[4:7], 0
    buffer_load_dwordx4 v14, s[16:19], s76 offen offset:3072 lds
    s_waitcnt lgkmcnt(8)
    v_mfma_f32_16x16x32_bf16 v[144:147], v[168:171], a[0:3], 0
    ds_read_b64_tr_b16 v[164:165], v24 offset:5152
    ds_read_b64_tr_b16 v[166:167], v25 offset:5152
    s_add_u32 m0, s90, 4096
    v_mfma_f32_16x16x32_bf16 v[148:151], v[168:171], a[4:7], 0
    buffer_load_dwordx4 v15, s[16:19], s76 offen lds
    s_waitcnt lgkmcnt(8)
    v_mfma_f32_16x16x32_bf16 v[112:115], v[172:175], a[8:11], v[112:115]
    ds_read_b64_tr_b16 v[168:169], v24 offset:10240
    v_mfma_f32_16x16x32_bf16 v[116:119], v[172:175], a[12:15], v[116:119]
    ds_read_b64_tr_b16 v[170:171], v25 offset:10240
    s_waitcnt lgkmcnt(8)
    v_mfma_f32_16x16x32_bf16 v[120:123], v[152:155], a[8:11], v[120:123]
    ds_read_b64_tr_b16 v[172:173], v24 offset:10248
    v_mfma_f32_16x16x32_bf16 v[124:127], v[152:155], a[12:15], v[124:127]
    ds_read_b64_tr_b16 v[174:175], v25 offset:10248
    s_waitcnt lgkmcnt(8)
    v_mfma_f32_16x16x32_bf16 v[128:131], v[156:159], a[8:11], v[128:131]
    ds_read_b64_tr_b16 v[152:153], v24 offset:10256
    v_mfma_f32_16x16x32_bf16 v[132:135], v[156:159], a[12:15], v[132:135]
    ds_read_b64_tr_b16 v[154:155], v25 offset:10256
    s_waitcnt lgkmcnt(8)
    v_mfma_f32_16x16x32_bf16 v[136:139], v[160:163], a[8:11], v[136:139]
    ds_read_b64_tr_b16 v[156:157], v24 offset:10264
    v_mfma_f32_16x16x32_bf16 v[140:143], v[160:163], a[12:15], v[140:143]
    ds_read_b64_tr_b16 v[158:159], v25 offset:10264
    s_waitcnt lgkmcnt(8)
    v_mfma_f32_16x16x32_bf16 v[144:147], v[164:167], a[8:11], v[144:147]
    ds_read_b64_tr_b16 v[160:161], v24 offset:10272
    v_mfma_f32_16x16x32_bf16 v[148:151], v[164:167], a[12:15], v[148:151]
    ds_read_b64_tr_b16 v[162:163], v25 offset:10272
    s_waitcnt lgkmcnt(8)
    v_mfma_f32_16x16x32_bf16 v[112:115], v[168:171], a[16:19], v[112:115]
    ds_read_b64_tr_b16 v[164:165], v24 offset:15360
    v_mfma_f32_16x16x32_bf16 v[116:119], v[168:171], a[20:23], v[116:119]
    ds_read_b64_tr_b16 v[166:167], v25 offset:15360
    s_waitcnt lgkmcnt(8)
    v_mfma_f32_16x16x32_bf16 v[120:123], v[172:175], a[16:19], v[120:123]
    ds_read_b64_tr_b16 v[168:169], v24 offset:15368
    v_mfma_f32_16x16x32_bf16 v[124:127], v[172:175], a[20:23], v[124:127]
    ds_read_b64_tr_b16 v[170:171], v25 offset:15368
    s_waitcnt lgkmcnt(8)
    v_mfma_f32_16x16x32_bf16 v[128:131], v[152:155], a[16:19], v[128:131]
    ds_read_b64_tr_b16 v[172:173], v24 offset:15376
    v_mfma_f32_16x16x32_bf16 v[132:135], v[152:155], a[20:23], v[132:135]
    ds_read_b64_tr_b16 v[174:175], v25 offset:15376
    s_waitcnt lgkmcnt(8)
    v_mfma_f32_16x16x32_bf16 v[136:139], v[156:159], a[16:19], v[136:139]
    ds_read_b64_tr_b16 v[152:153], v24 offset:15384
    v_mfma_f32_16x16x32_bf16 v[140:143], v[156:159], a[20:23], v[140:143]
    ds_read_b64_tr_b16 v[154:155], v25 offset:15384
    s_waitcnt lgkmcnt(8)
    v_mfma_f32_16x16x32_bf16 v[144:147], v[160:163], a[16:19], v[144:147]
    ds_read_b64_tr_b16 v[156:157], v24 offset:15392
    v_mfma_f32_16x16x32_bf16 v[148:151], v[160:163], a[20:23], v[148:151]
    ds_read_b64_tr_b16 v[158:159], v25 offset:15392
    s_waitcnt lgkmcnt(8)
    v_mfma_f32_16x16x32_bf16 v[112:115], v[164:167], a[24:27], v[112:115]
    s_waitcnt vmcnt(17)
    s_barrier
    ds_read_b64_tr_b16 v[160:161], v24 offset:20480
    v_mfma_f32_16x16x32_bf16 v[116:119], v[164:167], a[28:31], v[116:119]
    ds_read_b64_tr_b16 v[162:163], v25 offset:20480
    s_waitcnt lgkmcnt(8)
    v_mfma_f32_16x16x32_bf16 v[120:123], v[168:171], a[24:27], v[120:123]
    ds_read_b64_tr_b16 v[164:165], v24 offset:20488
    ds_read_b64_tr_b16 v[166:167], v25 offset:20488
    s_add_u32 m0, s90, 20480
    v_mfma_f32_16x16x32_bf16 v[124:127], v[168:171], a[28:31], v[124:127]
    buffer_load_dwordx4 v11, s[16:19], s77 offen offset:0 lds
    s_waitcnt lgkmcnt(8)
    v_mfma_f32_16x16x32_bf16 v[128:131], v[172:175], a[24:27], v[128:131]
    ds_read_b64_tr_b16 v[168:169], v24 offset:20496
    v_mfma_f32_16x16x32_bf16 v[132:135], v[172:175], a[28:31], v[132:135]
    ds_read_b64_tr_b16 v[170:171], v25 offset:20496
    s_waitcnt lgkmcnt(8)
    v_mfma_f32_16x16x32_bf16 v[136:139], v[152:155], a[24:27], v[136:139]
    ds_read_b64_tr_b16 v[172:173], v24 offset:20504
    ds_read_b64_tr_b16 v[174:175], v25 offset:20504
    v_mfma_f32_16x16x32_bf16 v[140:143], v[152:155], a[28:31], v[140:143]
    buffer_load_dwordx4 v12, s[16:19], s77 offen offset:1024 lds
    s_waitcnt lgkmcnt(8)
    v_mfma_f32_16x16x32_bf16 v[144:147], v[156:159], a[24:27], v[144:147]
    ds_read_b64_tr_b16 v[152:153], v24 offset:20512
    v_mfma_f32_16x16x32_bf16 v[148:151], v[156:159], a[28:31], v[148:151]
    ds_read_b64_tr_b16 v[154:155], v25 offset:20512
    s_waitcnt lgkmcnt(8)
    v_mfma_f32_16x16x32_bf16 v[112:115], v[160:163], a[32:35], v[112:115]
    ds_read_b64_tr_b16 v[156:157], v24 offset:25600
    ds_read_b64_tr_b16 v[158:159], v25 offset:25600
    v_mfma_f32_16x16x32_bf16 v[116:119], v[160:163], a[36:39], v[116:119]
    buffer_load_dwordx4 v13, s[16:19], s77 offen offset:2048 lds
    s_waitcnt lgkmcnt(8)
    v_mfma_f32_16x16x32_bf16 v[120:123], v[164:167], a[32:35], v[120:123]
    ds_read_b64_tr_b16 v[160:161], v24 offset:25608
    v_mfma_f32_16x16x32_bf16 v[124:127], v[164:167], a[36:39], v[124:127]
    ds_read_b64_tr_b16 v[162:163], v25 offset:25608
    s_waitcnt lgkmcnt(8)
    v_mfma_f32_16x16x32_bf16 v[128:131], v[168:171], a[32:35], v[128:131]
    ds_read_b64_tr_b16 v[164:165], v24 offset:25616
    ds_read_b64_tr_b16 v[166:167], v25 offset:25616
    v_mfma_f32_16x16x32_bf16 v[132:135], v[168:171], a[36:39], v[132:135]
    buffer_load_dwordx4 v14, s[16:19], s77 offen offset:3072 lds
    s_waitcnt lgkmcnt(8)
    v_mfma_f32_16x16x32_bf16 v[136:139], v[172:175], a[32:35], v[136:139]
    ds_read_b64_tr_b16 v[168:169], v24 offset:25624
    v_mfma_f32_16x16x32_bf16 v[140:143], v[172:175], a[36:39], v[140:143]
    ds_read_b64_tr_b16 v[170:171], v25 offset:25624
    s_waitcnt lgkmcnt(8)
    v_mfma_f32_16x16x32_bf16 v[144:147], v[152:155], a[32:35], v[144:147]
    ds_read_b64_tr_b16 v[172:173], v24 offset:25632
    ds_read_b64_tr_b16 v[174:175], v25 offset:25632
    s_add_u32 m0, s90, 24576
    v_mfma_f32_16x16x32_bf16 v[148:151], v[152:155], a[36:39], v[148:151]
    buffer_load_dwordx4 v15, s[16:19], s77 offen lds
    s_waitcnt lgkmcnt(8)
    v_mfma_f32_16x16x32_bf16 v[112:115], v[156:159], a[40:43], v[112:115]
    ds_read_b64_tr_b16 v[152:153], v24 offset:30720
    v_mfma_f32_16x16x32_bf16 v[116:119], v[156:159], a[44:47], v[116:119]
    ds_read_b64_tr_b16 v[154:155], v25 offset:30720
    s_waitcnt lgkmcnt(8)
    v_mfma_f32_16x16x32_bf16 v[120:123], v[160:163], a[40:43], v[120:123]
    ds_read_b64_tr_b16 v[156:157], v24 offset:30728
    v_mfma_f32_16x16x32_bf16 v[124:127], v[160:163], a[44:47], v[124:127]
    ds_read_b64_tr_b16 v[158:159], v25 offset:30728
    s_waitcnt lgkmcnt(8)
    v_mfma_f32_16x16x32_bf16 v[128:131], v[164:167], a[40:43], v[128:131]
    ds_read_b64_tr_b16 v[160:161], v24 offset:30736
    v_mfma_f32_16x16x32_bf16 v[132:135], v[164:167], a[44:47], v[132:135]
    ds_read_b64_tr_b16 v[162:163], v25 offset:30736
    s_waitcnt lgkmcnt(8)
    v_mfma_f32_16x16x32_bf16 v[136:139], v[168:171], a[40:43], v[136:139]
    ds_read_b64_tr_b16 v[164:165], v24 offset:30744
    v_mfma_f32_16x16x32_bf16 v[140:143], v[168:171], a[44:47], v[140:143]
    ds_read_b64_tr_b16 v[166:167], v25 offset:30744
    s_waitcnt lgkmcnt(8)
    v_mfma_f32_16x16x32_bf16 v[144:147], v[172:175], a[40:43], v[144:147]
    ds_read_b64_tr_b16 v[168:169], v24 offset:30752
    v_mfma_f32_16x16x32_bf16 v[148:151], v[172:175], a[44:47], v[148:151]
    ds_read_b64_tr_b16 v[170:171], v25 offset:30752
    s_waitcnt lgkmcnt(8)
    v_mfma_f32_16x16x32_bf16 v[112:115], v[152:155], a[48:51], v[112:115]
    ds_read_b64_tr_b16 v[172:173], v24 offset:35840
    ds_read_b64_tr_b16 v[174:175], v25 offset:35840
    s_mul_i32 s50, s85, 10240
    s_add_u32 s50, s50, 11534336
    v_mfma_f32_16x16x32_bf16 v[116:119], v[152:155], a[52:55], v[116:119]
    buffer_load_dwordx4 a[200:203], v26, s[20:23], s50 offen offset:0 sc1
    s_waitcnt lgkmcnt(8)
    v_mfma_f32_16x16x32_bf16 v[120:123], v[156:159], a[48:51], v[120:123]
    ds_read_b64_tr_b16 v[152:153], v24 offset:35848
    ds_read_b64_tr_b16 v[154:155], v25 offset:35848
    v_mfma_f32_16x16x32_bf16 v[124:127], v[156:159], a[52:55], v[124:127]
    buffer_load_dwordx4 a[204:207], v26, s[20:23], s50 offen offset:2048 sc1
    s_waitcnt lgkmcnt(8)
    v_mfma_f32_16x16x32_bf16 v[128:131], v[160:163], a[48:51], v[128:131]
    ds_read_b64_tr_b16 v[156:157], v24 offset:35856
    ds_read_b64_tr_b16 v[158:159], v25 offset:35856
    v_mfma_f32_16x16x32_bf16 v[132:135], v[160:163], a[52:55], v[132:135]
    buffer_load_dwordx4 a[208:211], v27, s[20:23], s50 offen offset:0 sc1
    s_waitcnt lgkmcnt(8)
    v_mfma_f32_16x16x32_bf16 v[136:139], v[164:167], a[48:51], v[136:139]
    ds_read_b64_tr_b16 v[160:161], v24 offset:35864
    ds_read_b64_tr_b16 v[162:163], v25 offset:35864
    v_mfma_f32_16x16x32_bf16 v[140:143], v[164:167], a[52:55], v[140:143]
    buffer_load_dwordx4 a[212:215], v27, s[20:23], s50 offen offset:2048 sc1
    s_waitcnt lgkmcnt(8)
    v_mfma_f32_16x16x32_bf16 v[144:147], v[168:171], a[48:51], v[144:147]
    ds_read_b64_tr_b16 v[164:165], v24 offset:35872
    ds_read_b64_tr_b16 v[166:167], v25 offset:35872
    v_mfma_f32_16x16x32_bf16 v[148:151], v[168:171], a[52:55], v[148:151]
    buffer_load_dwordx4 a[216:219], v28, s[20:23], s50 offen offset:0 sc1
    s_waitcnt lgkmcnt(8)
    v_mfma_f32_16x16x32_bf16 v[112:115], v[172:175], a[56:59], v[112:115]
    s_waitcnt vmcnt(10)
    s_barrier
    ds_read_b64_tr_b16 v[168:169], v22 offset:0
    ds_read_b64_tr_b16 v[170:171], v23 offset:0
    v_mfma_f32_16x16x32_bf16 v[116:119], v[172:175], a[60:63], v[116:119]
    buffer_load_dwordx4 a[220:223], v26, s[20:23], s50 offen offset:1024 sc1
    s_waitcnt lgkmcnt(8)
    v_mfma_f32_16x16x32_bf16 v[120:123], v[152:155], a[56:59], v[120:123]
    ds_read_b64_tr_b16 v[172:173], v22 offset:8
    ds_read_b64_tr_b16 v[174:175], v23 offset:8
    v_mfma_f32_16x16x32_bf16 v[124:127], v[152:155], a[60:63], v[124:127]
    buffer_load_dwordx4 a[224:227], v26, s[20:23], s50 offen offset:3072 sc1
    s_waitcnt lgkmcnt(8)
    v_mfma_f32_16x16x32_bf16 v[128:131], v[156:159], a[56:59], v[128:131]
    ds_read_b64_tr_b16 v[152:153], v22 offset:16
    ds_read_b64_tr_b16 v[154:155], v23 offset:16
    v_mfma_f32_16x16x32_bf16 v[132:135], v[156:159], a[60:63], v[132:135]
    buffer_load_dwordx4 a[228:231], v27, s[20:23], s50 offen offset:1024 sc1
    s_waitcnt lgkmcnt(8)
    v_mfma_f32_16x16x32_bf16 v[136:139], v[160:163], a[56:59], v[136:139]
    ds_read_b64_tr_b16 v[156:157], v22 offset:24
    ds_read_b64_tr_b16 v[158:159], v23 offset:24
    v_mfma_f32_16x16x32_bf16 v[140:143], v[160:163], a[60:63], v[140:143]
    buffer_load_dwordx4 a[232:235], v27, s[20:23], s50 offen offset:3072 sc1
    s_waitcnt lgkmcnt(8)
    v_mfma_f32_16x16x32_bf16 v[144:147], v[164:167], a[56:59], v[144:147]
    ds_read_b64_tr_b16 v[160:161], v22 offset:32
    ds_read_b64_tr_b16 v[162:163], v23 offset:32
    v_mfma_f32_16x16x32_bf16 v[148:151], v[164:167], a[60:63], v[148:151]
    buffer_load_dwordx4 a[236:239], v28, s[20:23], s50 offen offset:1024 sc1
    s_waitcnt lgkmcnt(8)
    v_mfma_f32_16x16x32_bf16 v[112:115], v[168:171], a[64:67], v[112:115]
    ds_read_b64_tr_b16 v[164:165], v22 offset:5120
    ds_read_b64_tr_b16 v[166:167], v23 offset:5120
    s_add_u32 m0, s90, 40960
    v_mfma_f32_16x16x32_bf16 v[116:119], v[168:171], a[68:71], v[116:119]
    buffer_load_dwordx4 v11, s[16:19], s78 offen offset:0 lds
    s_waitcnt lgkmcnt(8)
    v_mfma_f32_16x16x32_bf16 v[120:123], v[172:175], a[64:67], v[120:123]
    ds_read_b64_tr_b16 v[168:169], v22 offset:5128
    ds_read_b64_tr_b16 v[170:171], v23 offset:5128
    v_mfma_f32_16x16x32_bf16 v[124:127], v[172:175], a[68:71], v[124:127]
    buffer_load_dwordx4 v12, s[16:19], s78 offen offset:1024 lds
    s_waitcnt lgkmcnt(8)
    v_mfma_f32_16x16x32_bf16 v[128:131], v[152:155], a[64:67], v[128:131]
    ds_read_b64_tr_b16 v[172:173], v22 offset:5136
    ds_read_b64_tr_b16 v[174:175], v23 offset:5136
    v_mfma_f32_16x16x32_bf16 v[132:135], v[152:155], a[68:71], v[132:135]
    buffer_load_dwordx4 v13, s[16:19], s78 offen offset:2048 lds
    s_waitcnt lgkmcnt(8)
    v_mfma_f32_16x16x32_bf16 v[136:139], v[156:159], a[64:67], v[136:139]
    ds_read_b64_tr_b16 v[152:153], v22 offset:5144
    ds_read_b64_tr_b16 v[154:155], v23 offset:5144
    v_mfma_f32_16x16x32_bf16 v[140:143], v[156:159], a[68:71], v[140:143]
    buffer_load_dwordx4 v14, s[16:19], s78 offen offset:3072 lds
    s_waitcnt lgkmcnt(8)
    v_mfma_f32_16x16x32_bf16 v[144:147], v[160:163], a[64:67], v[144:147]
    ds_read_b64_tr_b16 v[156:157], v22 offset:5152
    ds_read_b64_tr_b16 v[158:159], v23 offset:5152
    s_add_u32 m0, s90, 45056
    v_mfma_f32_16x16x32_bf16 v[148:151], v[160:163], a[68:71], v[148:151]
    buffer_load_dwordx4 v15, s[16:19], s78 offen lds
    s_waitcnt lgkmcnt(8)
    v_mfma_f32_16x16x32_bf16 v[112:115], v[164:167], a[72:75], v[112:115]
    ds_read_b64_tr_b16 v[160:161], v22 offset:10240
    v_mfma_f32_16x16x32_bf16 v[116:119], v[164:167], a[76:79], v[116:119]
    ds_read_b64_tr_b16 v[162:163], v23 offset:10240
    s_waitcnt lgkmcnt(8)
    v_mfma_f32_16x16x32_bf16 v[120:123], v[168:171], a[72:75], v[120:123]
    ds_read_b64_tr_b16 v[164:165], v22 offset:10248
    v_mfma_f32_16x16x32_bf16 v[124:127], v[168:171], a[76:79], v[124:127]
    ds_read_b64_tr_b16 v[166:167], v23 offset:10248
    s_waitcnt lgkmcnt(8)
    v_mfma_f32_16x16x32_bf16 v[128:131], v[172:175], a[72:75], v[128:131]
    ds_read_b64_tr_b16 v[168:169], v22 offset:10256
    v_mfma_f32_16x16x32_bf16 v[132:135], v[172:175], a[76:79], v[132:135]
    ds_read_b64_tr_b16 v[170:171], v23 offset:10256
    s_waitcnt lgkmcnt(8)
    v_mfma_f32_16x16x32_bf16 v[136:139], v[152:155], a[72:75], v[136:139]
    ds_read_b64_tr_b16 v[172:173], v22 offset:10264
    v_mfma_f32_16x16x32_bf16 v[140:143], v[152:155], a[76:79], v[140:143]
    ds_read_b64_tr_b16 v[174:175], v23 offset:10264
    s_waitcnt lgkmcnt(8)
    v_mfma_f32_16x16x32_bf16 v[144:147], v[156:159], a[72:75], v[144:147]
    ds_read_b64_tr_b16 v[152:153], v22 offset:10272
    v_mfma_f32_16x16x32_bf16 v[148:151], v[156:159], a[76:79], v[148:151]
    ds_read_b64_tr_b16 v[154:155], v23 offset:10272
    s_waitcnt lgkmcnt(8)
    v_mfma_f32_16x16x32_bf16 v[112:115], v[160:163], a[80:83], v[112:115]
    ds_read_b64_tr_b16 v[156:157], v22 offset:15360
    ds_read_b64_tr_b16 v[158:159], v23 offset:15360
    s_mul_i32 s50, s86, 10240
    s_add_u32 s50, s50, 11534336
    v_mfma_f32_16x16x32_bf16 v[116:119], v[160:163], a[84:87], v[116:119]
    buffer_load_dwordx4 a[0:3], v26, s[20:23], s50 offen offset:0 sc1
    s_waitcnt lgkmcnt(8)
    v_mfma_f32_16x16x32_bf16 v[120:123], v[164:167], a[80:83], v[120:123]
    ds_read_b64_tr_b16 v[160:161], v22 offset:15368
    ds_read_b64_tr_b16 v[162:163], v23 offset:15368
    v_mfma_f32_16x16x32_bf16 v[124:127], v[164:167], a[84:87], v[124:127]
    buffer_load_dwordx4 a[4:7], v26, s[20:23], s50 offen offset:2048 sc1
    s_waitcnt lgkmcnt(8)
    v_mfma_f32_16x16x32_bf16 v[128:131], v[168:171], a[80:83], v[128:131]
    ds_read_b64_tr_b16 v[164:165], v22 offset:15376
    ds_read_b64_tr_b16 v[166:167], v23 offset:15376
    v_mfma_f32_16x16x32_bf16 v[132:135], v[168:171], a[84:87], v[132:135]
    buffer_load_dwordx4 a[8:11], v27, s[20:23], s50 offen offset:0 sc1
    s_waitcnt lgkmcnt(8)
    v_mfma_f32_16x16x32_bf16 v[136:139], v[172:175], a[80:83], v[136:139]
    ds_read_b64_tr_b16 v[168:169], v22 offset:15384
    ds_read_b64_tr_b16 v[170:171], v23 offset:15384
    v_mfma_f32_16x16x32_bf16 v[140:143], v[172:175], a[84:87], v[140:143]
    buffer_load_dwordx4 a[12:15], v27, s[20:23], s50 offen offset:2048 sc1
    s_waitcnt lgkmcnt(8)
    v_mfma_f32_16x16x32_bf16 v[144:147], v[152:155], a[80:83], v[144:147]
    ds_read_b64_tr_b16 v[172:173], v22 offset:15392
    ds_read_b64_tr_b16 v[174:175], v23 offset:15392
    v_mfma_f32_16x16x32_bf16 v[148:151], v[152:155], a[84:87], v[148:151]
    buffer_load_dwordx4 a[16:19], v28, s[20:23], s50 offen offset:0 sc1
    s_waitcnt lgkmcnt(8)
    v_mfma_f32_16x16x32_bf16 v[112:115], v[156:159], a[88:91], v[112:115]
    s_waitcnt vmcnt(20)
    s_barrier
    ds_read_b64_tr_b16 v[152:153], v22 offset:20480
    ds_read_b64_tr_b16 v[154:155], v23 offset:20480
    v_mfma_f32_16x16x32_bf16 v[116:119], v[156:159], a[92:95], v[116:119]
    buffer_load_dwordx4 a[20:23], v26, s[20:23], s50 offen offset:1024 sc1
    s_waitcnt lgkmcnt(8)
    v_mfma_f32_16x16x32_bf16 v[120:123], v[160:163], a[88:91], v[120:123]
    ds_read_b64_tr_b16 v[156:157], v22 offset:20488
    ds_read_b64_tr_b16 v[158:159], v23 offset:20488
    v_mfma_f32_16x16x32_bf16 v[124:127], v[160:163], a[92:95], v[124:127]
    buffer_load_dwordx4 a[24:27], v26, s[20:23], s50 offen offset:3072 sc1
    s_waitcnt lgkmcnt(8)
    v_mfma_f32_16x16x32_bf16 v[128:131], v[164:167], a[88:91], v[128:131]
    ds_read_b64_tr_b16 v[160:161], v22 offset:20496
    ds_read_b64_tr_b16 v[162:163], v23 offset:20496
    v_mfma_f32_16x16x32_bf16 v[132:135], v[164:167], a[92:95], v[132:135]
    buffer_load_dwordx4 a[28:31], v27, s[20:23], s50 offen offset:1024 sc1
    s_waitcnt lgkmcnt(8)
    v_mfma_f32_16x16x32_bf16 v[136:139], v[168:171], a[88:91], v[136:139]
    ds_read_b64_tr_b16 v[164:165], v22 offset:20504
    ds_read_b64_tr_b16 v[166:167], v23 offset:20504
    v_mfma_f32_16x16x32_bf16 v[140:143], v[168:171], a[92:95], v[140:143]
    buffer_load_dwordx4 a[32:35], v27, s[20:23], s50 offen offset:3072 sc1
    s_waitcnt lgkmcnt(8)
    v_mfma_f32_16x16x32_bf16 v[144:147], v[172:175], a[88:91], v[144:147]
    ds_read_b64_tr_b16 v[168:169], v22 offset:20512
    ds_read_b64_tr_b16 v[170:171], v23 offset:20512
    v_mfma_f32_16x16x32_bf16 v[148:151], v[172:175], a[92:95], v[148:151]
    buffer_load_dwordx4 a[36:39], v28, s[20:23], s50 offen offset:1024 sc1
    s_waitcnt lgkmcnt(8)
    v_mfma_f32_16x16x32_bf16 v[112:115], v[152:155], a[96:99], v[112:115]
    ds_read_b64_tr_b16 v[172:173], v22 offset:25600
    ds_read_b64_tr_b16 v[174:175], v23 offset:25600
    v_accvgpr_read_b32 v252, a252
    s_add_u32 m0, s90, 61440
    v_mfma_f32_16x16x32_bf16 v[116:119], v[152:155], a[100:103], v[116:119]
    buffer_load_dwordx4 v252, s[8:11], s61 offen offset:0 lds
    s_waitcnt lgkmcnt(8)
    v_mfma_f32_16x16x32_bf16 v[120:123], v[156:159], a[96:99], v[120:123]
    ds_read_b64_tr_b16 v[152:153], v22 offset:25608
    ds_read_b64_tr_b16 v[154:155], v23 offset:25608
    s_add_u32 s61, s61, 9152
    v_mfma_f32_16x16x32_bf16 v[124:127], v[156:159], a[100:103], v[124:127]
    buffer_load_dwordx4 v252, s[8:11], s61 offen offset:1088 lds
    s_waitcnt lgkmcnt(8)
    v_mfma_f32_16x16x32_bf16 v[128:131], v[160:163], a[96:99], v[128:131]
    ds_read_b64_tr_b16 v[156:157], v22 offset:25616
    ds_read_b64_tr_b16 v[158:159], v23 offset:25616
    s_add_u32 s61, s61, 9152
    v_mfma_f32_16x16x32_bf16 v[132:135], v[160:163], a[100:103], v[132:135]
    buffer_load_dwordx4 v252, s[8:11], s61 offen offset:2176 lds
    s_waitcnt lgkmcnt(8)
    v_mfma_f32_16x16x32_bf16 v[136:139], v[164:167], a[96:99], v[136:139]
    ds_read_b64_tr_b16 v[160:161], v22 offset:25624
    ds_read_b64_tr_b16 v[162:163], v23 offset:25624
    s_add_u32 s61, s61, 9152
    v_mfma_f32_16x16x32_bf16 v[140:143], v[164:167], a[100:103], v[140:143]
    buffer_load_dwordx4 v252, s[8:11], s61 offen offset:3264 lds
    s_waitcnt lgkmcnt(8)
    v_mfma_f32_16x16x32_bf16 v[144:147], v[168:171], a[96:99], v[144:147]
    ds_read_b64_tr_b16 v[164:165], v22 offset:25632
    ds_read_b64_tr_b16 v[166:167], v23 offset:25632
    s_add_u32 m0, s90, 65728
    v_mfma_f32_16x16x32_bf16 v[148:151], v[168:171], a[100:103], v[148:151]
    s_mov_b64 exec, 0x3ff
    buffer_load_dwordx4 v252, s[24:27], s40 offen lds
    s_mov_b64 exec, -1
    s_waitcnt lgkmcnt(8)
    v_mfma_f32_16x16x32_bf16 v[112:115], v[172:175], a[104:107], v[112:115]
    ds_read_b64_tr_b16 v[168:169], v22 offset:30720
    ds_read_b64_tr_b16 v[170:171], v23 offset:30720
    v_mfma_f32_16x16x32_bf16 v[116:119], v[172:175], a[108:111], v[116:119]
    buffer_load_dwordx2 v[244:245], v4, s[36:39], s46 offen offset:1280 sc1
    s_waitcnt lgkmcnt(8)
    v_mfma_f32_16x16x32_bf16 v[120:123], v[152:155], a[104:107], v[120:123]
    ds_read_b64_tr_b16 v[172:173], v22 offset:30728
    ds_read_b64_tr_b16 v[174:175], v23 offset:30728
    v_mfma_f32_16x16x32_bf16 v[124:127], v[152:155], a[108:111], v[124:127]
    buffer_load_dwordx2 v[242:243], v4, s[36:39], s46 offen offset:640 sc1
    s_waitcnt lgkmcnt(8)
    v_mfma_f32_16x16x32_bf16 v[128:131], v[156:159], a[104:107], v[128:131]
    ds_read_b64_tr_b16 v[152:153], v22 offset:30736
    ds_read_b64_tr_b16 v[154:155], v23 offset:30736
    v_mfma_f32_16x16x32_bf16 v[132:135], v[156:159], a[108:111], v[132:135]
    buffer_load_dwordx2 v[240:241], v4, s[36:39], s46 offen offset:0 sc1
    s_waitcnt lgkmcnt(8)
    v_mfma_f32_16x16x32_bf16 v[136:139], v[160:163], a[104:107], v[136:139]
    ds_read_b64_tr_b16 v[156:157], v22 offset:30744
    ds_read_b64_tr_b16 v[158:159], v23 offset:30744
    v_mfma_f32_16x16x32_bf16 v[140:143], v[160:163], a[108:111], v[140:143]
    buffer_load_dwordx2 v[238:239], v4, s[36:39], s41 offen offset:3200 sc1
    s_waitcnt lgkmcnt(8)
    v_mfma_f32_16x16x32_bf16 v[144:147], v[164:167], a[104:107], v[144:147]
    ds_read_b64_tr_b16 v[160:161], v22 offset:30752
    ds_read_b64_tr_b16 v[162:163], v23 offset:30752
    v_mfma_f32_16x16x32_bf16 v[148:151], v[164:167], a[108:111], v[148:151]
    buffer_load_dwordx2 v[236:237], v4, s[36:39], s41 offen offset:2560 sc1
    s_waitcnt lgkmcnt(8)
    v_mfma_f32_16x16x32_bf16 v[112:115], v[168:171], a[112:115], v[112:115]
    ds_read_b64_tr_b16 v[164:165], v22 offset:35840
    ds_read_b64_tr_b16 v[166:167], v23 offset:35840
    v_mfma_f32_16x16x32_bf16 v[116:119], v[168:171], a[116:119], v[116:119]
    buffer_load_dwordx2 v[234:235], v4, s[36:39], s41 offen offset:1920 sc1
    s_waitcnt lgkmcnt(8)
    v_mfma_f32_16x16x32_bf16 v[120:123], v[172:175], a[112:115], v[120:123]
    ds_read_b64_tr_b16 v[168:169], v22 offset:35848
    ds_read_b64_tr_b16 v[170:171], v23 offset:35848
    v_mfma_f32_16x16x32_bf16 v[124:127], v[172:175], a[116:119], v[124:127]
    buffer_load_dwordx2 v[232:233], v4, s[36:39], s41 offen offset:1280 sc1
    s_waitcnt lgkmcnt(8)
    v_mfma_f32_16x16x32_bf16 v[128:131], v[152:155], a[112:115], v[128:131]
    ds_read_b64_tr_b16 v[172:173], v22 offset:35856
    ds_read_b64_tr_b16 v[174:175], v23 offset:35856
    v_mfma_f32_16x16x32_bf16 v[132:135], v[152:155], a[116:119], v[132:135]
    buffer_load_dwordx2 v[230:231], v4, s[36:39], s41 offen offset:640 sc1
    s_waitcnt lgkmcnt(8)
    v_mfma_f32_16x16x32_bf16 v[136:139], v[156:159], a[112:115], v[136:139]
    ds_read_b64_tr_b16 v[152:153], v22 offset:35864
    ds_read_b64_tr_b16 v[154:155], v23 offset:35864
    v_mfma_f32_16x16x32_bf16 v[140:143], v[156:159], a[116:119], v[140:143]
    buffer_load_dwordx2 v[228:229], v4, s[36:39], s41 offen offset:0 sc1
    s_waitcnt lgkmcnt(8)
    v_mfma_f32_16x16x32_bf16 v[144:147], v[160:163], a[112:115], v[144:147]
    ds_read_b64_tr_b16 v[156:157], v22 offset:35872
    ds_read_b64_tr_b16 v[158:159], v23 offset:35872
    v_mfma_f32_16x16x32_bf16 v[148:151], v[160:163], a[116:119], v[148:151]
    buffer_load_dwordx2 v[226:227], v4, s[36:39], 0 offen offset:3200 sc1
    s_waitcnt lgkmcnt(8)
    v_mfma_f32_16x16x32_bf16 v[112:115], v[164:167], a[120:123], v[112:115]
    s_waitcnt vmcnt(25)
    s_barrier
    ds_read_b64_tr_b16 v[160:161], v24 offset:0
    ds_read_b64_tr_b16 v[162:163], v25 offset:0
    v_mfma_f32_16x16x32_bf16 v[116:119], v[164:167], a[124:127], v[116:119]
    buffer_load_dwordx2 v[224:225], v4, s[36:39], 0 offen offset:2560 sc1
    s_waitcnt lgkmcnt(8)
    v_mfma_f32_16x16x32_bf16 v[120:123], v[168:171], a[120:123], v[120:123]
    ds_read_b64_tr_b16 v[164:165], v24 offset:8
    ds_read_b64_tr_b16 v[166:167], v25 offset:8
    v_mfma_f32_16x16x32_bf16 v[124:127], v[168:171], a[124:127], v[124:127]
    buffer_load_dwordx2 v[222:223], v4, s[36:39], 0 offen offset:1920 sc1
    s_waitcnt lgkmcnt(8)
    v_mfma_f32_16x16x32_bf16 v[128:131], v[172:175], a[120:123], v[128:131]
    ds_read_b64_tr_b16 v[168:169], v24 offset:16
    ds_read_b64_tr_b16 v[170:171], v25 offset:16
    v_mfma_f32_16x16x32_bf16 v[132:135], v[172:175], a[124:127], v[132:135]
    buffer_load_dwordx2 v[220:221], v4, s[36:39], 0 offen offset:1280 sc1
    s_waitcnt lgkmcnt(8)
    v_mfma_f32_16x16x32_bf16 v[136:139], v[152:155], a[120:123], v[136:139]
    ds_read_b64_tr_b16 v[172:173], v24 offset:24
    ds_read_b64_tr_b16 v[174:175], v25 offset:24
    v_mfma_f32_16x16x32_bf16 v[140:143], v[152:155], a[124:127], v[140:143]
    buffer_load_dwordx2 v[218:219], v4, s[36:39], 0 offen offset:640 sc1
    s_waitcnt lgkmcnt(8)
    v_mfma_f32_16x16x32_bf16 v[144:147], v[156:159], a[120:123], v[144:147]
    ds_read_b64_tr_b16 v[152:153], v24 offset:32
    ds_read_b64_tr_b16 v[154:155], v25 offset:32
    v_mfma_f32_16x16x32_bf16 v[148:151], v[156:159], a[124:127], v[148:151]
    buffer_load_dwordx2 v[216:217], v4, s[36:39], 0 offen offset:0 sc1
    s_waitcnt lgkmcnt(8)
    v_mfma_f32_16x16x32_bf16 v[112:115], v[160:163], a[128:131], v[112:115]
    ds_read_b64_tr_b16 v[156:157], v24 offset:5120
    v_mfma_f32_16x16x32_bf16 v[116:119], v[160:163], a[132:135], v[116:119]
    ds_read_b64_tr_b16 v[158:159], v25 offset:5120
    s_waitcnt lgkmcnt(8)
    v_mfma_f32_16x16x32_bf16 v[120:123], v[164:167], a[128:131], v[120:123]
    ds_read_b64_tr_b16 v[160:161], v24 offset:5128
    v_mfma_f32_16x16x32_bf16 v[124:127], v[164:167], a[132:135], v[124:127]
    ds_read_b64_tr_b16 v[162:163], v25 offset:5128
    s_waitcnt lgkmcnt(8)
    v_mfma_f32_16x16x32_bf16 v[128:131], v[168:171], a[128:131], v[128:131]
    ds_read_b64_tr_b16 v[164:165], v24 offset:5136
    ds_read_b64_tr_b16 v[166:167], v25 offset:5136
    s_mul_i32 s50, s87, 10240
    s_add_u32 s50, s50, 11534336
    v_mfma_f32_16x16x32_bf16 v[132:135], v[168:171], a[132:135], v[132:135]
    buffer_load_dwordx4 a[40:43], v26, s[20:23], s50 offen offset:0 sc1
    s_waitcnt lgkmcnt(8)
    v_mfma_f32_16x16x32_bf16 v[136:139], v[172:175], a[128:131], v[136:139]
    ds_read_b64_tr_b16 v[168:169], v24 offset:5144
    v_mfma_f32_16x16x32_bf16 v[140:143], v[172:175], a[132:135], v[140:143]
    ds_read_b64_tr_b16 v[170:171], v25 offset:5144
    s_waitcnt lgkmcnt(8)
    v_mfma_f32_16x16x32_bf16 v[144:147], v[152:155], a[128:131], v[144:147]
    ds_read_b64_tr_b16 v[172:173], v24 offset:5152
    ds_read_b64_tr_b16 v[174:175], v25 offset:5152
    v_mfma_f32_16x16x32_bf16 v[148:151], v[152:155], a[132:135], v[148:151]
    buffer_load_dwordx4 a[44:47], v26, s[20:23], s50 offen offset:2048 sc1
    s_waitcnt lgkmcnt(8)
    v_mfma_f32_16x16x32_bf16 v[112:115], v[156:159], a[136:139], v[112:115]
    ds_read_b64_tr_b16 v[152:153], v24 offset:10240
    v_mfma_f32_16x16x32_bf16 v[116:119], v[156:159], a[140:143], v[116:119]
    ds_read_b64_tr_b16 v[154:155], v25 offset:10240
    s_waitcnt lgkmcnt(8)
    v_mfma_f32_16x16x32_bf16 v[120:123], v[160:163], a[136:139], v[120:123]
    ds_read_b64_tr_b16 v[156:157], v24 offset:10248
    ds_read_b64_tr_b16 v[158:159], v25 offset:10248
    v_mfma_f32_16x16x32_bf16 v[124:127], v[160:163], a[140:143], v[124:127]
    buffer_load_dwordx4 a[48:51], v27, s[20:23], s50 offen offset:0 sc1
    s_waitcnt lgkmcnt(8)
    v_mfma_f32_16x16x32_bf16 v[128:131], v[164:167], a[136:139], v[128:131]
    ds_read_b64_tr_b16 v[160:161], v24 offset:10256
    v_mfma_f32_16x16x32_bf16 v[132:135], v[164:167], a[140:143], v[132:135]
    ds_read_b64_tr_b16 v[162:163], v25 offset:10256
    s_waitcnt lgkmcnt(8)
    v_mfma_f32_16x16x32_bf16 v[136:139], v[168:171], a[136:139], v[136:139]
    ds_read_b64_tr_b16 v[164:165], v24 offset:10264
    ds_read_b64_tr_b16 v[166:167], v25 offset:10264
    v_mfma_f32_16x16x32_bf16 v[140:143], v[168:171], a[140:143], v[140:143]
    buffer_load_dwordx4 a[52:55], v27, s[20:23], s50 offen offset:2048 sc1
    s_waitcnt lgkmcnt(8)
    v_mfma_f32_16x16x32_bf16 v[144:147], v[172:175], a[136:139], v[144:147]
    ds_read_b64_tr_b16 v[168:169], v24 offset:10272
    v_mfma_f32_16x16x32_bf16 v[148:151], v[172:175], a[140:143], v[148:151]
    ds_read_b64_tr_b16 v[170:171], v25 offset:10272
    s_waitcnt lgkmcnt(8)
    v_mfma_f32_16x16x32_bf16 v[112:115], v[152:155], a[144:147], v[112:115]
    ds_read_b64_tr_b16 v[172:173], v24 offset:15360
    ds_read_b64_tr_b16 v[174:175], v25 offset:15360
    v_mfma_f32_16x16x32_bf16 v[116:119], v[152:155], a[148:151], v[116:119]
    buffer_load_dwordx4 a[56:59], v28, s[20:23], s50 offen offset:0 sc1
    s_waitcnt lgkmcnt(8)
    v_mfma_f32_16x16x32_bf16 v[120:123], v[156:159], a[144:147], v[120:123]
    ds_read_b64_tr_b16 v[152:153], v24 offset:15368
    v_mfma_f32_16x16x32_bf16 v[124:127], v[156:159], a[148:151], v[124:127]
    ds_read_b64_tr_b16 v[154:155], v25 offset:15368
    s_waitcnt lgkmcnt(8)
    v_mfma_f32_16x16x32_bf16 v[128:131], v[160:163], a[144:147], v[128:131]
    ds_read_b64_tr_b16 v[156:157], v24 offset:15376
    ds_read_b64_tr_b16 v[158:159], v25 offset:15376
    v_mfma_f32_16x16x32_bf16 v[132:135], v[160:163], a[148:151], v[132:135]
    buffer_load_dwordx4 a[60:63], v26, s[20:23], s50 offen offset:1024 sc1
    s_waitcnt lgkmcnt(8)
    v_mfma_f32_16x16x32_bf16 v[136:139], v[164:167], a[144:147], v[136:139]
    ds_read_b64_tr_b16 v[160:161], v24 offset:15384
    v_mfma_f32_16x16x32_bf16 v[140:143], v[164:167], a[148:151], v[140:143]
    ds_read_b64_tr_b16 v[162:163], v25 offset:15384
    s_waitcnt lgkmcnt(8)
    v_mfma_f32_16x16x32_bf16 v[144:147], v[168:171], a[144:147], v[144:147]
    ds_read_b64_tr_b16 v[164:165], v24 offset:15392
    ds_read_b64_tr_b16 v[166:167], v25 offset:15392
    v_mfma_f32_16x16x32_bf16 v[148:151], v[168:171], a[148:151], v[148:151]
    buffer_load_dwordx4 a[64:67], v26, s[20:23], s50 offen offset:3072 sc1
    s_waitcnt lgkmcnt(8)
    v_mfma_f32_16x16x32_bf16 v[112:115], v[172:175], a[152:155], v[112:115]
    v_mfma_f32_16x16x32_bf16 v[116:119], v[172:175], a[156:159], v[116:119]
    s_waitcnt lgkmcnt(6)
    v_mfma_f32_16x16x32_bf16 v[120:123], v[152:155], a[152:155], v[120:123]
    v_mfma_f32_16x16x32_bf16 v[124:127], v[152:155], a[156:159], v[124:127]
    buffer_load_dwordx4 a[68:71], v27, s[20:23], s50 offen offset:1024 sc1
    s_waitcnt lgkmcnt(4)
    v_mfma_f32_16x16x32_bf16 v[128:131], v[156:159], a[152:155], v[128:131]
    v_mfma_f32_16x16x32_bf16 v[132:135], v[156:159], a[156:159], v[132:135]
    s_waitcnt lgkmcnt(2)
    v_mfma_f32_16x16x32_bf16 v[136:139], v[160:163], a[152:155], v[136:139]
    v_mfma_f32_16x16x32_bf16 v[140:143], v[160:163], a[156:159], v[140:143]
    buffer_load_dwordx4 a[72:75], v27, s[20:23], s50 offen offset:3072 sc1
    s_waitcnt lgkmcnt(0)
    v_mfma_f32_16x16x32_bf16 v[144:147], v[164:167], a[152:155], v[144:147]
    v_mfma_f32_16x16x32_bf16 v[148:151], v[164:167], a[156:159], v[148:151]
    s_mov_b32 s96, 0
    v_accvgpr_read_b32 v21, a251
    v_accvgpr_read_b32 v6, a240
    v_accvgpr_read_b32 v7, a241
    v_accvgpr_read_b32 v8, a242
    v_accvgpr_read_b32 v9, a243
    v_accvgpr_read_b32 v19, a249
    v_accvgpr_read_b32 v20, a250
    v_lshlrev_b32 v10, 4, v1
    v_add_u32 v18, 162816, v4
    ds_read_b64 v[152:153], v2 offset:10240
    ds_read_b64 v[154:155], v21 offset:0
    ds_read_b64 v[156:157], v2 offset:10368
    ds_read_b64 v[158:159], v21 offset:128
    ds_read_b64 v[160:161], v2 offset:10496
    ds_read_b64 v[162:163], v21 offset:256
    ds_read_b64 v[164:165], v2 offset:10624
    ds_read_b64 v[166:167], v21 offset:384
    ds_read_b64 v[168:169], v2 offset:10752
    ds_read_b64 v[170:171], v21 offset:512
    s_cmp_ge_u32 s3, 2
    s_cbranch_scc1 LB_x23
    s_waitcnt vmcnt(9)
    s_add_u32 s7, s90, 61440
    v_lshrrev_b32 v172, 4, v1
    v_lshl_add_u32 v172, v172, 3, s7
    v_and_b32 v173, 15, v1
    v_mul_u32_u24 v173, 272, v173
    v_add_u32 v173, v173, v172
    ds_read_b64 a[136:137], v173 offset:0
    ds_read_b64 a[146:147], v172 offset:4288
    ds_read_b64 a[138:139], v173 offset:32
    ds_read_b64 a[148:149], v172 offset:4320
    ds_read_b64 a[140:141], v173 offset:64
    ds_read_b64 a[150:151], v172 offset:4352
    ds_read_b64 a[142:143], v173 offset:96
    ds_read_b64 a[152:153], v172 offset:4384
    ds_read_b64 a[144:145], v173 offset:128
    ds_read_b64 a[154:155], v172 offset:4416
    v_xor_b32 v244, s47, v244
    v_xor_b32 v245, s47, v245
    v_or_b32 v250, v244, v245
    buffer_load_dwordx4 a[76:79], v28, s[20:23], s50 offen offset:1024 sc1
    v_xor_b32 v242, s47, v242
    v_xor_b32 v243, s47, v243
    v_or3_b32 v250, v250, v242, v243
    v_pk_fma_f32 v[242:243], v[244:245], v[248:249], v[242:243] op_sel_hi:[1,0,1]
    v_pk_fma_f32 v[242:243], v[244:245], v[248:249], v[242:243] op_sel:[1,1,0] op_sel_hi:[0,1,1] neg_lo:[0,1,0]
    v_xor_b32 v240, s47, v240
    v_xor_b32 v241, s47, v241
    v_or3_b32 v250, v250, v240, v241
    v_pk_fma_f32 v[240:241], v[242:243], v[248:249], v[240:241] op_sel_hi:[1,0,1]
    v_pk_fma_f32 v[240:241], v[242:243], v[248:249], v[240:241] op_sel:[1,1,0] op_sel_hi:[0,1,1] neg_lo:[0,1,0]
    s_lshl_b32 s31, s84, 10
    s_add_u32 s31, s31, 8388608
    buffer_load_dwordx4 a[80:83], v29, s[20:23], s31 offen sc1
    v_xor_b32 v238, s47, v238
    v_xor_b32 v239, s47, v239
    v_or3_b32 v250, v250, v238, v239
    v_pk_fma_f32 v[238:239], v[240:241], v[248:249], v[238:239] op_sel_hi:[1,0,1]
    v_pk_fma_f32 v[238:239], v[240:241], v[248:249], v[238:239] op_sel:[1,1,0] op_sel_hi:[0,1,1] neg_lo:[0,1,0]
    v_xor_b32 v236, s47, v236
    v_xor_b32 v237, s47, v237
    v_or3_b32 v250, v250, v236, v237
    v_pk_fma_f32 v[236:237], v[238:239], v[248:249], v[236:237] op_sel_hi:[1,0,1]
    v_pk_fma_f32 v[236:237], v[238:239], v[248:249], v[236:237] op_sel:[1,1,0] op_sel_hi:[0,1,1] neg_lo:[0,1,0]
    s_add_u32 s31, s31, 20480
    buffer_load_dwordx4 a[84:87], v29, s[20:23], s31 offen sc1
    v_xor_b32 v234, s47, v234
    v_xor_b32 v235, s47, v235
    v_or3_b32 v250, v250, v234, v235
    v_pk_fma_f32 v[234:235], v[236:237], v[248:249], v[234:235] op_sel_hi:[1,0,1]
    v_pk_fma_f32 v[234:235], v[236:237], v[248:249], v[234:235] op_sel:[1,1,0] op_sel_hi:[0,1,1] neg_lo:[0,1,0]
    v_xor_b32 v232, s47, v232
    v_xor_b32 v233, s47, v233
    v_or3_b32 v250, v250, v232, v233
    v_pk_fma_f32 v[232:233], v[234:235], v[248:249], v[232:233] op_sel_hi:[1,0,1]
    v_pk_fma_f32 v[232:233], v[234:235], v[248:249], v[232:233] op_sel:[1,1,0] op_sel_hi:[0,1,1] neg_lo:[0,1,0]
    s_add_u32 s31, s31, 20480
    buffer_load_dwordx4 a[88:91], v29, s[20:23], s31 offen sc1
    v_xor_b32 v230, s47, v230
    v_xor_b32 v231, s47, v231
    v_or3_b32 v250, v250, v230, v231
    v_pk_fma_f32 v[230:231], v[232:233], v[248:249], v[230:231] op_sel_hi:[1,0,1]
    v_pk_fma_f32 v[230:231], v[232:233], v[248:249], v[230:231] op_sel:[1,1,0] op_sel_hi:[0,1,1] neg_lo:[0,1,0]
    v_xor_b32 v228, s47, v228
    v_xor_b32 v229, s47, v229
    v_or3_b32 v250, v250, v228, v229
    v_pk_fma_f32 v[228:229], v[230:231], v[248:249], v[228:229] op_sel_hi:[1,0,1]
    v_pk_fma_f32 v[228:229], v[230:231], v[248:249], v[228:229] op_sel:[1,1,0] op_sel_hi:[0,1,1] neg_lo:[0,1,0]
    s_add_u32 s31, s31, 20480
    buffer_load_dwordx4 a[92:95], v29, s[20:23], s31 offen sc1
    v_xor_b32 v226, s47, v226
    v_xor_b32 v227, s47, v227
    v_or3_b32 v250, v250, v226, v227
    v_pk_fma_f32 v[226:227], v[228:229], v[248:249], v[226:227] op_sel_hi:[1,0,1]
    v_pk_fma_f32 v[226:227], v[228:229], v[248:249], v[226:227] op_sel:[1,1,0] op_sel_hi:[0,1,1] neg_lo:[0,1,0]
    v_xor_b32 v224, s47, v224
    v_xor_b32 v225, s47, v225
    v_or3_b32 v250, v250, v224, v225
    v_pk_fma_f32 v[224:225], v[226:227], v[248:249], v[224:225] op_sel_hi:[1,0,1]
    v_pk_fma_f32 v[224:225], v[226:227], v[248:249], v[224:225] op_sel:[1,1,0] op_sel_hi:[0,1,1] neg_lo:[0,1,0]
    s_add_u32 s31, s31, 20480
    buffer_load_dwordx4 a[96:99], v29, s[20:23], s31 offen sc1
    v_xor_b32 v222, s47, v222
    v_xor_b32 v223, s47, v223
    v_or3_b32 v250, v250, v222, v223
    v_pk_fma_f32 v[222:223], v[224:225], v[248:249], v[222:223] op_sel_hi:[1,0,1]
    v_pk_fma_f32 v[222:223], v[224:225], v[248:249], v[222:223] op_sel:[1,1,0] op_sel_hi:[0,1,1] neg_lo:[0,1,0]
    v_xor_b32 v220, s47, v220
    v_xor_b32 v221, s47, v221
    v_or3_b32 v250, v250, v220, v221
    v_pk_fma_f32 v[220:221], v[222:223], v[248:249], v[220:221] op_sel_hi:[1,0,1]
    v_pk_fma_f32 v[220:221], v[222:223], v[248:249], v[220:221] op_sel:[1,1,0] op_sel_hi:[0,1,1] neg_lo:[0,1,0]
    s_lshl_b32 s31, s85, 10
    s_add_u32 s31, s31, 8388608
    buffer_load_dwordx4 a[100:103], v29, s[20:23], s31 offen sc1
    v_xor_b32 v218, s47, v218
    v_xor_b32 v219, s47, v219
    v_or3_b32 v250, v250, v218, v219
    v_pk_fma_f32 v[218:219], v[220:221], v[248:249], v[218:219] op_sel_hi:[1,0,1]
    v_pk_fma_f32 v[218:219], v[220:221], v[248:249], v[218:219] op_sel:[1,1,0] op_sel_hi:[0,1,1] neg_lo:[0,1,0]
    v_xor_b32 v216, s47, v216
    v_xor_b32 v217, s47, v217
    v_or3_b32 v250, v250, v216, v217
    v_pk_fma_f32 v[216:217], v[218:219], v[248:249], v[216:217] op_sel_hi:[1,0,1]
    v_pk_fma_f32 v[216:217], v[218:219], v[248:249], v[216:217] op_sel:[1,1,0] op_sel_hi:[0,1,1] neg_lo:[0,1,0]
    s_add_u32 s31, s31, 20480
    buffer_load_dwordx4 a[104:107], v29, s[20:23], s31 offen sc1
    v_and_b32 v250, 0xff, v250
    v_cmp_ne_u32 vcc, 0, v250
    s_add_u32 s96, s96, 1
    s_and_b64 vcc, vcc, s[34:35]
    s_add_u32 s31, s31, 20480
    buffer_load_dwordx4 a[108:111], v29, s[20:23], s31 offen sc1
    s_cbranch_vccnz LB_rs
LB_sok:
    s_mov_b64 exec, s[34:35]
    ds_write_b64 v18, v[216:217]
    s_mov_b64 exec, -1
    s_branch LB_xe1
LB_x23:
    buffer_load_dwordx4 a[76:79], v28, s[20:23], s50 offen offset:1024 sc1
    s_lshl_b32 s31, s84, 10
    s_add_u32 s31, s31, 8388608
    buffer_load_dwordx4 a[80:83], v29, s[20:23], s31 offen sc1
    s_add_u32 s31, s31, 20480
    buffer_load_dwordx4 a[84:87], v29, s[20:23], s31 offen sc1
    s_add_u32 s31, s31, 20480
    buffer_load_dwordx4 a[88:91], v29, s[20:23], s31 offen sc1
    s_add_u32 s31, s31, 20480
    buffer_load_dwordx4 a[92:95], v29, s[20:23], s31 offen sc1
    s_add_u32 s31, s31, 20480
    buffer_load_dwordx4 a[96:99], v29, s[20:23], s31 offen sc1
    s_lshl_b32 s31, s85, 10
    s_add_u32 s31, s31, 8388608
    buffer_load_dwordx4 a[100:103], v29, s[20:23], s31 offen sc1
    s_add_u32 s31, s31, 20480
    buffer_load_dwordx4 a[104:107], v29, s[20:23], s31 offen sc1
    s_add_u32 s31, s31, 20480
    buffer_load_dwordx4 a[108:111], v29, s[20:23], s31 offen sc1
    s_add_u32 s7, s90, 61440
    v_lshrrev_b32 v172, 4, v1
    v_lshl_add_u32 v172, v172, 3, s7
    v_and_b32 v173, 15, v1
    v_mul_u32_u24 v173, 272, v173
    v_add_u32 v173, v173, v172
    s_waitcnt vmcnt(33)
    ds_read_b64 a[136:137], v173 offset:0
    ds_read_b64 a[146:147], v172 offset:4288
    ds_read_b64 a[138:139], v173 offset:32
    ds_read_b64 a[148:149], v172 offset:4320
    ds_read_b64 a[140:141], v173 offset:64
    ds_read_b64 a[150:151], v172 offset:4352
    ds_read_b64 a[142:143], v173 offset:96
    ds_read_b64 a[152:153], v172 offset:4384
    ds_read_b64 a[144:145], v173 offset:128
    ds_read_b64 a[154:155], v172 offset:4416
LB_xe1:
    s_waitcnt lgkmcnt(0)
    s_barrier
    ds_read_b64 v[12:13], v19 offset:0
    ds_read_b64 v[14:15], v19 offset:128
    ds_read_b64 v[22:23], v19 offset:256
    ds_read_b64 v[24:25], v19 offset:384
    ds_read_b64 v[172:173], v19 offset:512
    s_waitcnt lgkmcnt(4)
    v_pk_fma_f32 v[152:153], v[12:13], v[154:155], v[152:153] op_sel_hi:[1,0,1]
    v_pk_fma_f32 v[152:153], v[12:13], v[154:155], v[152:153] op_sel:[1,1,0] op_sel_hi:[0,1,1] neg_lo:[0,1,0]
    v_mov_b32 v154, v153
    v_fma_f32 v153, v182, v152, v38
    v_fma_f32 v155, v182, v154, v46
    v_fma_f32 v153, -v183, v154, v153
    v_fma_f32 v155, v183, v152, v155
    v_pk_fma_f32 v[32:33], v[152:153], v[176:177], v[32:33] op_sel_hi:[1,0,1]
    v_pk_fma_f32 v[34:35], v[152:153], v[178:179], v[34:35] op_sel_hi:[1,0,1]
    v_pk_fma_f32 v[36:37], v[152:153], v[180:181], v[36:37] op_sel_hi:[1,0,1]
    v_pk_fma_f32 v[38:39], v[152:153], v[182:183], v[38:39] op_sel_hi:[1,0,1]
    v_pk_fma_f32 v[32:33], v[154:155], v[176:177], v[32:33] op_sel:[0,1,0] op_sel_hi:[1,1,1] neg_lo:[0,1,0] neg_hi:[0,1,0]
    v_pk_fma_f32 v[34:35], v[154:155], v[178:179], v[34:35] op_sel:[0,1,0] op_sel_hi:[1,1,1] neg_lo:[0,1,0] neg_hi:[0,1,0]
    v_pk_fma_f32 v[36:37], v[154:155], v[180:181], v[36:37] op_sel:[0,1,0] op_sel_hi:[1,1,1] neg_lo:[0,1,0] neg_hi:[0,1,0]
    v_pk_fma_f32 v[38:39], v[154:155], v[182:183], v[38:39] op_sel:[0,1,0] op_sel_hi:[1,1,1] neg_lo:[0,1,0] neg_hi:[0,1,0]
    v_cvt_pk_bf16_f32 v32, v32, v33
    v_cvt_pk_bf16_f32 v33, v34, v35
    v_cvt_pk_bf16_f32 v34, v36, v37
    v_cvt_pk_bf16_f32 v35, v38, v39
    ds_write_b128 v6, v[32:35] offset:0
    v_pk_fma_f32 v[40:41], v[154:155], v[176:177], v[40:41] op_sel_hi:[1,0,1]
    v_pk_fma_f32 v[42:43], v[154:155], v[178:179], v[42:43] op_sel_hi:[1,0,1]
    v_pk_fma_f32 v[44:45], v[154:155], v[180:181], v[44:45] op_sel_hi:[1,0,1]
    v_pk_fma_f32 v[46:47], v[154:155], v[182:183], v[46:47] op_sel_hi:[1,0,1]
    ds_read_b64_tr_b16 v[36:37], v7 offset:0
    ds_read_b64_tr_b16 v[38:39], v8 offset:0
    v_pk_fma_f32 v[40:41], v[152:153], v[176:177], v[40:41] op_sel:[0,1,0] op_sel_hi:[1,1,1]
    v_pk_fma_f32 v[42:43], v[152:153], v[178:179], v[42:43] op_sel:[0,1,0] op_sel_hi:[1,1,1]
    v_pk_fma_f32 v[44:45], v[152:153], v[180:181], v[44:45] op_sel:[0,1,0] op_sel_hi:[1,1,1]
    v_pk_fma_f32 v[46:47], v[152:153], v[182:183], v[46:47] op_sel:[0,1,0] op_sel_hi:[1,1,1]
    v_cvt_pk_bf16_f32 v40, v40, v41
    v_cvt_pk_bf16_f32 v41, v42, v43
    v_cvt_pk_bf16_f32 v42, v44, v45
    v_cvt_pk_bf16_f32 v43, v46, v47
    ds_write_b128 v6, v[40:43] offset:1024
    s_waitcnt lgkmcnt(7)
    v_pk_fma_f32 v[156:157], v[14:15], v[158:159], v[156:157] op_sel_hi:[1,0,1]
    v_pk_fma_f32 v[156:157], v[14:15], v[158:159], v[156:157] op_sel:[1,1,0] op_sel_hi:[0,1,1] neg_lo:[0,1,0]
    v_mov_b32 v158, v157
    v_fma_f32 v157, v190, v156, v54
    v_fma_f32 v159, v190, v158, v62
    v_fma_f32 v157, -v191, v158, v157
    v_fma_f32 v159, v191, v156, v159
    v_pk_fma_f32 v[48:49], v[156:157], v[184:185], v[48:49] op_sel_hi:[1,0,1]
    v_pk_fma_f32 v[50:51], v[156:157], v[186:187], v[50:51] op_sel_hi:[1,0,1]
    v_pk_fma_f32 v[52:53], v[156:157], v[188:189], v[52:53] op_sel_hi:[1,0,1]
    v_pk_fma_f32 v[54:55], v[156:157], v[190:191], v[54:55] op_sel_hi:[1,0,1]
    ds_read_b64_tr_b16 v[44:45], v7 offset:1024
    ds_read_b64_tr_b16 v[46:47], v8 offset:1024
    v_pk_fma_f32 v[48:49], v[158:159], v[184:185], v[48:49] op_sel:[0,1,0] op_sel_hi:[1,1,1] neg_lo:[0,1,0] neg_hi:[0,1,0]
    v_pk_fma_f32 v[50:51], v[158:159], v[186:187], v[50:51] op_sel:[0,1,0] op_sel_hi:[1,1,1] neg_lo:[0,1,0] neg_hi:[0,1,0]
    v_pk_fma_f32 v[52:53], v[158:159], v[188:189], v[52:53] op_sel:[0,1,0] op_sel_hi:[1,1,1] neg_lo:[0,1,0] neg_hi:[0,1,0]
    v_pk_fma_f32 v[54:55], v[158:159], v[190:191], v[54:55] op_sel:[0,1,0] op_sel_hi:[1,1,1] neg_lo:[0,1,0] neg_hi:[0,1,0]
    s_waitcnt lgkmcnt(3)
    buffer_store_dwordx4 v[36:39], v9, s[20:23], s54 offen offset:0 sc1
    v_cvt_pk_bf16_f32 v48, v48, v49
    v_cvt_pk_bf16_f32 v49, v50, v51
    v_cvt_pk_bf16_f32 v50, v52, v53
    v_cvt_pk_bf16_f32 v51, v54, v55
    ds_write_b128 v6, v[48:51] offset:2048
    v_pk_fma_f32 v[56:57], v[158:159], v[184:185], v[56:57] op_sel_hi:[1,0,1]
    v_pk_fma_f32 v[58:59], v[158:159], v[186:187], v[58:59] op_sel_hi:[1,0,1]
    v_pk_fma_f32 v[60:61], v[158:159], v[188:189], v[60:61] op_sel_hi:[1,0,1]
    v_pk_fma_f32 v[62:63], v[158:159], v[190:191], v[62:63] op_sel_hi:[1,0,1]
    ds_read_b64_tr_b16 v[52:53], v7 offset:2048
    ds_read_b64_tr_b16 v[54:55], v8 offset:2048
    v_pk_fma_f32 v[56:57], v[156:157], v[184:185], v[56:57] op_sel:[0,1,0] op_sel_hi:[1,1,1]
    v_pk_fma_f32 v[58:59], v[156:157], v[186:187], v[58:59] op_sel:[0,1,0] op_sel_hi:[1,1,1]
    v_pk_fma_f32 v[60:61], v[156:157], v[188:189], v[60:61] op_sel:[0,1,0] op_sel_hi:[1,1,1]
    v_pk_fma_f32 v[62:63], v[156:157], v[190:191], v[62:63] op_sel:[0,1,0] op_sel_hi:[1,1,1]
    s_waitcnt lgkmcnt(3)
    buffer_store_dwordx4 v[44:47], v9, s[20:23], s55 offen offset:0 sc1
    v_cvt_pk_bf16_f32 v56, v56, v57
    v_cvt_pk_bf16_f32 v57, v58, v59
    v_cvt_pk_bf16_f32 v58, v60, v61
    v_cvt_pk_bf16_f32 v59, v62, v63
    ds_write_b128 v6, v[56:59] offset:3072
    v_pk_fma_f32 v[160:161], v[22:23], v[162:163], v[160:161] op_sel_hi:[1,0,1]
    v_pk_fma_f32 v[160:161], v[22:23], v[162:163], v[160:161] op_sel:[1,1,0] op_sel_hi:[0,1,1] neg_lo:[0,1,0]
    v_mov_b32 v162, v161
    v_fma_f32 v161, v198, v160, v70
    v_fma_f32 v163, v198, v162, v78
    v_fma_f32 v161, -v199, v162, v161
    v_fma_f32 v163, v199, v160, v163
    v_pk_fma_f32 v[64:65], v[160:161], v[192:193], v[64:65] op_sel_hi:[1,0,1]
    v_pk_fma_f32 v[66:67], v[160:161], v[194:195], v[66:67] op_sel_hi:[1,0,1]
    v_pk_fma_f32 v[68:69], v[160:161], v[196:197], v[68:69] op_sel_hi:[1,0,1]
    v_pk_fma_f32 v[70:71], v[160:161], v[198:199], v[70:71] op_sel_hi:[1,0,1]
    ds_read_b64_tr_b16 v[60:61], v7 offset:3072
    ds_read_b64_tr_b16 v[62:63], v8 offset:3072
    v_pk_fma_f32 v[64:65], v[162:163], v[192:193], v[64:65] op_sel:[0,1,0] op_sel_hi:[1,1,1] neg_lo:[0,1,0] neg_hi:[0,1,0]
    v_pk_fma_f32 v[66:67], v[162:163], v[194:195], v[66:67] op_sel:[0,1,0] op_sel_hi:[1,1,1] neg_lo:[0,1,0] neg_hi:[0,1,0]
    v_pk_fma_f32 v[68:69], v[162:163], v[196:197], v[68:69] op_sel:[0,1,0] op_sel_hi:[1,1,1] neg_lo:[0,1,0] neg_hi:[0,1,0]
    v_pk_fma_f32 v[70:71], v[162:163], v[198:199], v[70:71] op_sel:[0,1,0] op_sel_hi:[1,1,1] neg_lo:[0,1,0] neg_hi:[0,1,0]
    s_waitcnt lgkmcnt(3)
    buffer_store_dwordx4 v[52:55], v9, s[20:23], s54 offen offset:512 sc1
    v_cvt_pk_bf16_f32 v64, v64, v65
    v_cvt_pk_bf16_f32 v65, v66, v67
    v_cvt_pk_bf16_f32 v66, v68, v69
    v_cvt_pk_bf16_f32 v67, v70, v71
    ds_write_b128 v6, v[64:67] offset:4096
    v_pk_fma_f32 v[72:73], v[162:163], v[192:193], v[72:73] op_sel_hi:[1,0,1]
    v_pk_fma_f32 v[74:75], v[162:163], v[194:195], v[74:75] op_sel_hi:[1,0,1]
    v_pk_fma_f32 v[76:77], v[162:163], v[196:197], v[76:77] op_sel_hi:[1,0,1]
    v_pk_fma_f32 v[78:79], v[162:163], v[198:199], v[78:79] op_sel_hi:[1,0,1]
    ds_read_b64_tr_b16 v[68:69], v7 offset:4096
    ds_read_b64_tr_b16 v[70:71], v8 offset:4096
    v_pk_fma_f32 v[72:73], v[160:161], v[192:193], v[72:73] op_sel:[0,1,0] op_sel_hi:[1,1,1]
    v_pk_fma_f32 v[74:75], v[160:161], v[194:195], v[74:75] op_sel:[0,1,0] op_sel_hi:[1,1,1]
    v_pk_fma_f32 v[76:77], v[160:161], v[196:197], v[76:77] op_sel:[0,1,0] op_sel_hi:[1,1,1]
    v_pk_fma_f32 v[78:79], v[160:161], v[198:199], v[78:79] op_sel:[0,1,0] op_sel_hi:[1,1,1]
    s_waitcnt lgkmcnt(3)
    buffer_store_dwordx4 v[60:63], v9, s[20:23], s55 offen offset:512 sc1
    v_cvt_pk_bf16_f32 v72, v72, v73
    v_cvt_pk_bf16_f32 v73, v74, v75
    v_cvt_pk_bf16_f32 v74, v76, v77
    v_cvt_pk_bf16_f32 v75, v78, v79
    ds_write_b128 v6, v[72:75] offset:5120
    v_pk_fma_f32 v[164:165], v[24:25], v[166:167], v[164:165] op_sel_hi:[1,0,1]
    v_pk_fma_f32 v[164:165], v[24:25], v[166:167], v[164:165] op_sel:[1,1,0] op_sel_hi:[0,1,1] neg_lo:[0,1,0]
    v_mov_b32 v166, v165
    v_fma_f32 v165, v206, v164, v86
    v_fma_f32 v167, v206, v166, v94
    v_fma_f32 v165, -v207, v166, v165
    v_fma_f32 v167, v207, v164, v167
    v_pk_fma_f32 v[80:81], v[164:165], v[200:201], v[80:81] op_sel_hi:[1,0,1]
    v_pk_fma_f32 v[82:83], v[164:165], v[202:203], v[82:83] op_sel_hi:[1,0,1]
    v_pk_fma_f32 v[84:85], v[164:165], v[204:205], v[84:85] op_sel_hi:[1,0,1]
    v_pk_fma_f32 v[86:87], v[164:165], v[206:207], v[86:87] op_sel_hi:[1,0,1]
    ds_read_b64_tr_b16 v[76:77], v7 offset:5120
    ds_read_b64_tr_b16 v[78:79], v8 offset:5120
    v_pk_fma_f32 v[80:81], v[166:167], v[200:201], v[80:81] op_sel:[0,1,0] op_sel_hi:[1,1,1] neg_lo:[0,1,0] neg_hi:[0,1,0]
    v_pk_fma_f32 v[82:83], v[166:167], v[202:203], v[82:83] op_sel:[0,1,0] op_sel_hi:[1,1,1] neg_lo:[0,1,0] neg_hi:[0,1,0]
    v_pk_fma_f32 v[84:85], v[166:167], v[204:205], v[84:85] op_sel:[0,1,0] op_sel_hi:[1,1,1] neg_lo:[0,1,0] neg_hi:[0,1,0]
    v_pk_fma_f32 v[86:87], v[166:167], v[206:207], v[86:87] op_sel:[0,1,0] op_sel_hi:[1,1,1] neg_lo:[0,1,0] neg_hi:[0,1,0]
    s_waitcnt lgkmcnt(3)
    buffer_store_dwordx4 v[68:71], v9, s[20:23], s54 offen offset:1024 sc1
    v_cvt_pk_bf16_f32 v80, v80, v81
    v_cvt_pk_bf16_f32 v81, v82, v83
    v_cvt_pk_bf16_f32 v82, v84, v85
    v_cvt_pk_bf16_f32 v83, v86, v87
    ds_write_b128 v6, v[80:83] offset:0
    v_pk_fma_f32 v[88:89], v[166:167], v[200:201], v[88:89] op_sel_hi:[1,0,1]
    v_pk_fma_f32 v[90:91], v[166:167], v[202:203], v[90:91] op_sel_hi:[1,0,1]
    v_pk_fma_f32 v[92:93], v[166:167], v[204:205], v[92:93] op_sel_hi:[1,0,1]
    v_pk_fma_f32 v[94:95], v[166:167], v[206:207], v[94:95] op_sel_hi:[1,0,1]
    ds_read_b64_tr_b16 v[84:85], v7 offset:0
    ds_read_b64_tr_b16 v[86:87], v8 offset:0
    v_pk_fma_f32 v[88:89], v[164:165], v[200:201], v[88:89] op_sel:[0,1,0] op_sel_hi:[1,1,1]
    v_pk_fma_f32 v[90:91], v[164:165], v[202:203], v[90:91] op_sel:[0,1,0] op_sel_hi:[1,1,1]
    v_pk_fma_f32 v[92:93], v[164:165], v[204:205], v[92:93] op_sel:[0,1,0] op_sel_hi:[1,1,1]
    v_pk_fma_f32 v[94:95], v[164:165], v[206:207], v[94:95] op_sel:[0,1,0] op_sel_hi:[1,1,1]
    s_waitcnt lgkmcnt(3)
    buffer_store_dwordx4 v[76:79], v9, s[20:23], s55 offen offset:1024 sc1
    v_cvt_pk_bf16_f32 v88, v88, v89
    v_cvt_pk_bf16_f32 v89, v90, v91
    v_cvt_pk_bf16_f32 v90, v92, v93
    v_cvt_pk_bf16_f32 v91, v94, v95
    ds_write_b128 v6, v[88:91] offset:1024
    v_pk_fma_f32 v[168:169], v[172:173], v[170:171], v[168:169] op_sel_hi:[1,0,1]
    v_pk_fma_f32 v[168:169], v[172:173], v[170:171], v[168:169] op_sel:[1,1,0] op_sel_hi:[0,1,1] neg_lo:[0,1,0]
    v_mov_b32 v170, v169
    v_fma_f32 v169, v214, v168, v102
    v_fma_f32 v171, v214, v170, v110
    v_fma_f32 v169, -v215, v170, v169
    v_fma_f32 v171, v215, v168, v171
    v_pk_fma_f32 v[96:97], v[168:169], v[208:209], v[96:97] op_sel_hi:[1,0,1]
    v_pk_fma_f32 v[98:99], v[168:169], v[210:211], v[98:99] op_sel_hi:[1,0,1]
    v_pk_fma_f32 v[100:101], v[168:169], v[212:213], v[100:101] op_sel_hi:[1,0,1]
    v_pk_fma_f32 v[102:103], v[168:169], v[214:215], v[102:103] op_sel_hi:[1,0,1]
    ds_read_b64_tr_b16 v[92:93], v7 offset:1024
    ds_read_b64_tr_b16 v[94:95], v8 offset:1024
    v_pk_fma_f32 v[96:97], v[170:171], v[208:209], v[96:97] op_sel:[0,1,0] op_sel_hi:[1,1,1] neg_lo:[0,1,0] neg_hi:[0,1,0]
    v_pk_fma_f32 v[98:99], v[170:171], v[210:211], v[98:99] op_sel:[0,1,0] op_sel_hi:[1,1,1] neg_lo:[0,1,0] neg_hi:[0,1,0]
    v_pk_fma_f32 v[100:101], v[170:171], v[212:213], v[100:101] op_sel:[0,1,0] op_sel_hi:[1,1,1] neg_lo:[0,1,0] neg_hi:[0,1,0]
    v_pk_fma_f32 v[102:103], v[170:171], v[214:215], v[102:103] op_sel:[0,1,0] op_sel_hi:[1,1,1] neg_lo:[0,1,0] neg_hi:[0,1,0]
    s_waitcnt lgkmcnt(3)
    buffer_store_dwordx4 v[84:87], v9, s[20:23], s54 offen offset:1536 sc1
    v_cvt_pk_bf16_f32 v96, v96, v97
    v_cvt_pk_bf16_f32 v97, v98, v99
    v_cvt_pk_bf16_f32 v98, v100, v101
    v_cvt_pk_bf16_f32 v99, v102, v103
    ds_write_b128 v6, v[96:99] offset:2048
    v_pk_fma_f32 v[104:105], v[170:171], v[208:209], v[104:105] op_sel_hi:[1,0,1]
    v_pk_fma_f32 v[106:107], v[170:171], v[210:211], v[106:107] op_sel_hi:[1,0,1]
    v_pk_fma_f32 v[108:109], v[170:171], v[212:213], v[108:109] op_sel_hi:[1,0,1]
    v_pk_fma_f32 v[110:111], v[170:171], v[214:215], v[110:111] op_sel_hi:[1,0,1]
    ds_read_b64_tr_b16 v[100:101], v7 offset:2048
    ds_read_b64_tr_b16 v[102:103], v8 offset:2048
    v_pk_fma_f32 v[104:105], v[168:169], v[208:209], v[104:105] op_sel:[0,1,0] op_sel_hi:[1,1,1]
    v_pk_fma_f32 v[106:107], v[168:169], v[210:211], v[106:107] op_sel:[0,1,0] op_sel_hi:[1,1,1]
    v_pk_fma_f32 v[108:109], v[168:169], v[212:213], v[108:109] op_sel:[0,1,0] op_sel_hi:[1,1,1]
    v_pk_fma_f32 v[110:111], v[168:169], v[214:215], v[110:111] op_sel:[0,1,0] op_sel_hi:[1,1,1]
    s_waitcnt lgkmcnt(3)
    buffer_store_dwordx4 v[92:95], v9, s[20:23], s55 offen offset:1536 sc1
    v_cvt_pk_bf16_f32 v104, v104, v105
    v_cvt_pk_bf16_f32 v105, v106, v107
    v_cvt_pk_bf16_f32 v106, v108, v109
    v_cvt_pk_bf16_f32 v107, v110, v111
    ds_write_b128 v6, v[104:107] offset:3072
    ds_read_b64_tr_b16 v[108:109], v7 offset:3072
    ds_read_b64_tr_b16 v[110:111], v8 offset:3072
    s_waitcnt lgkmcnt(3)
    buffer_store_dwordx4 v[100:103], v9, s[20:23], s54 offen offset:2048 sc1
    s_waitcnt lgkmcnt(0)
    buffer_store_dwordx4 v[108:111], v9, s[20:23], s55 offen offset:2048 sc1
    v_accvgpr_read_b32 v11, a253
    v_accvgpr_read_b32 v12, a254
    v_accvgpr_read_b32 v2, a248
    v_accvgpr_read_b32 v3, a255
    v_lshlrev_b32 v4, 4, v0
    v_add_u32 v5, 4096, v4
    s_lshl_b32 s65, s5, 13
    s_add_u32 s65, s65, 10485760
    v_and_b32 v13, 15, v1
    v_lshlrev_b32 v13, 2, v13
    s_lshl_b32 s66, s4, 2
    s_add_u32 s66, s66, s3
    s_lshl_b32 s66, s66, 8
    s_add_u32 s66, s66, 11010048
    s_mov_b32 s94, 1069066811
    v_pk_mul_f32 v[52:53], v[112:113], s[94:95] op_sel_hi:[1,0]
    v_max_f32 v112, 0x358637bd, v112
    v_max_f32 v113, 0x358637bd, v113
    v_exp_f32_e64 v52, v52 clamp
    v_exp_f32_e64 v53, v53 clamp
    v_pk_mul_f32 v[54:55], v[114:115], s[94:95] op_sel_hi:[1,0]
    v_max_f32 v114, 0x358637bd, v114
    v_max_f32 v115, 0x358637bd, v115
    v_exp_f32_e64 v54, v54 clamp
    v_exp_f32_e64 v55, v55 clamp
    v_pk_add_f32 v[112:113], v[112:113], v[52:53]
    v_pk_add_f32 v[114:115], v[114:115], v[54:55]
    v_cvt_pk_bf16_f32 v56, v112, v113
    v_cvt_pk_bf16_f32 v57, v114, v115
    s_mul_i32 s50, s88, 10240
    s_add_u32 s50, s50, 11534336
    buffer_load_dwordx4 a[156:159], v26, s[20:23], s50 offen offset:1024 sc1
    v_pk_mul_f32 v[52:53], v[116:117], s[94:95] op_sel_hi:[1,0]
    v_max_f32 v116, 0x358637bd, v116
    v_max_f32 v117, 0x358637bd, v117
    v_exp_f32_e64 v52, v52 clamp
    v_exp_f32_e64 v53, v53 clamp
    v_pk_mul_f32 v[54:55], v[118:119], s[94:95] op_sel_hi:[1,0]
    v_max_f32 v118, 0x358637bd, v118
    v_max_f32 v119, 0x358637bd, v119
    v_exp_f32_e64 v54, v54 clamp
    v_exp_f32_e64 v55, v55 clamp
    v_pk_add_f32 v[116:117], v[116:117], v[52:53]
    v_pk_add_f32 v[118:119], v[118:119], v[54:55]
    v_cvt_pk_bf16_f32 v68, v116, v117
    v_cvt_pk_bf16_f32 v69, v118, v119
    buffer_load_dwordx4 a[240:243], v26, s[20:23], s50 offen offset:3072 sc1
    v_pk_mul_f32 v[52:53], v[120:121], s[94:95] op_sel_hi:[1,0]
    v_max_f32 v120, 0x358637bd, v120
    v_max_f32 v121, 0x358637bd, v121
    v_exp_f32_e64 v52, v52 clamp
    v_exp_f32_e64 v53, v53 clamp
    v_pk_mul_f32 v[54:55], v[122:123], s[94:95] op_sel_hi:[1,0]
    v_max_f32 v122, 0x358637bd, v122
    v_max_f32 v123, 0x358637bd, v123
    v_exp_f32_e64 v54, v54 clamp
    v_exp_f32_e64 v55, v55 clamp
    v_pk_add_f32 v[120:121], v[120:121], v[52:53]
    v_pk_add_f32 v[122:123], v[122:123], v[54:55]
    v_cvt_pk_bf16_f32 v58, v120, v121
    v_cvt_pk_bf16_f32 v59, v122, v123
    buffer_load_dwordx4 a[244:247], v27, s[20:23], s50 offen offset:1024 sc1
    v_pk_mul_f32 v[52:53], v[124:125], s[94:95] op_sel_hi:[1,0]
    v_max_f32 v124, 0x358637bd, v124
    v_max_f32 v125, 0x358637bd, v125
    v_exp_f32_e64 v52, v52 clamp
    v_exp_f32_e64 v53, v53 clamp
    v_pk_mul_f32 v[54:55], v[126:127], s[94:95] op_sel_hi:[1,0]
    v_max_f32 v126, 0x358637bd, v126
    v_max_f32 v127, 0x358637bd, v127
    v_exp_f32_e64 v54, v54 clamp
    v_exp_f32_e64 v55, v55 clamp
    v_pk_add_f32 v[124:125], v[124:125], v[52:53]
    v_pk_add_f32 v[126:127], v[126:127], v[54:55]
    v_cvt_pk_bf16_f32 v70, v124, v125
    v_cvt_pk_bf16_f32 v71, v126, v127
    buffer_load_dwordx4 a[248:251], v27, s[20:23], s50 offen offset:3072 sc1
    v_pk_mul_f32 v[52:53], v[128:129], s[94:95] op_sel_hi:[1,0]
    v_max_f32 v128, 0x358637bd, v128
    v_max_f32 v129, 0x358637bd, v129
    v_exp_f32_e64 v52, v52 clamp
    v_exp_f32_e64 v53, v53 clamp
    v_pk_mul_f32 v[54:55], v[130:131], s[94:95] op_sel_hi:[1,0]
    v_max_f32 v130, 0x358637bd, v130
    v_max_f32 v131, 0x358637bd, v131
    v_exp_f32_e64 v54, v54 clamp
    v_exp_f32_e64 v55, v55 clamp
    v_pk_add_f32 v[128:129], v[128:129], v[52:53]
    v_pk_add_f32 v[130:131], v[130:131], v[54:55]
    v_cvt_pk_bf16_f32 v60, v128, v129
    v_cvt_pk_bf16_f32 v61, v130, v131
    buffer_load_dwordx4 a[252:255], v28, s[20:23], s50 offen offset:1024 sc1
    buffer_load_dwordx4 v[216:219], v4, s[20:23], s65 offen sc1
    buffer_load_dwordx4 v[220:223], v5, s[20:23], s65 offen sc1
    buffer_load_dword v102, v13, s[20:23], s66 offen offset:0 sc1
    buffer_load_dword v103, v13, s[20:23], s66 offen offset:128 sc1
    s_waitcnt vmcnt(9)
    s_barrier
    s_cmp_lg_u32 s3, 3
    s_cbranch_scc1 LB_nf
    s_lshl_b32 s7, s5, 4
    s_add_u32 s7, s7, s4
    s_mul_i32 s7, s7, 128
    s_add_u32 s7, s7, 11108352
    v_lshl_add_u32 v100, v1, 2, s7
    v_mov_b32 v101, s6
    s_mov_b64 exec, 1
    buffer_atomic_swap v101, v100, s[20:23], 0 offen sc1
    s_mov_b64 exec, -1
LB_nf:
    v_pk_mul_f32 v[52:53], v[132:133], s[94:95] op_sel_hi:[1,0]
    v_max_f32 v132, 0x358637bd, v132
    v_max_f32 v133, 0x358637bd, v133
    v_exp_f32_e64 v52, v52 clamp
    v_exp_f32_e64 v53, v53 clamp
    v_pk_mul_f32 v[54:55], v[134:135], s[94:95] op_sel_hi:[1,0]
    v_max_f32 v134, 0x358637bd, v134
    v_max_f32 v135, 0x358637bd, v135
    v_exp_f32_e64 v54, v54 clamp
    v_exp_f32_e64 v55, v55 clamp
    v_pk_add_f32 v[132:133], v[132:133], v[52:53]
    v_pk_add_f32 v[134:135], v[134:135], v[54:55]
    v_cvt_pk_bf16_f32 v72, v132, v133
    v_cvt_pk_bf16_f32 v73, v134, v135
    s_lshl_b32 s31, s85, 10
    s_add_u32 s31, s31, 8450048
    buffer_load_dwordx4 a[112:115], v29, s[20:23], s31 offen sc1
    v_pk_mul_f32 v[52:53], v[136:137], s[94:95] op_sel_hi:[1,0]
    v_max_f32 v136, 0x358637bd, v136
    v_max_f32 v137, 0x358637bd, v137
    v_exp_f32_e64 v52, v52 clamp
    v_exp_f32_e64 v53, v53 clamp
    v_pk_mul_f32 v[54:55], v[138:139], s[94:95] op_sel_hi:[1,0]
    v_max_f32 v138, 0x358637bd, v138
    v_max_f32 v139, 0x358637bd, v139
    v_exp_f32_e64 v54, v54 clamp
    v_exp_f32_e64 v55, v55 clamp
    v_pk_add_f32 v[136:137], v[136:137], v[52:53]
    v_pk_add_f32 v[138:139], v[138:139], v[54:55]
    v_cvt_pk_bf16_f32 v62, v136, v137
    v_cvt_pk_bf16_f32 v63, v138, v139
    s_add_u32 s31, s31, 20480
    buffer_load_dwordx4 a[116:119], v29, s[20:23], s31 offen sc1
    v_pk_mul_f32 v[52:53], v[140:141], s[94:95] op_sel_hi:[1,0]
    v_max_f32 v140, 0x358637bd, v140
    v_max_f32 v141, 0x358637bd, v141
    v_exp_f32_e64 v52, v52 clamp
    v_exp_f32_e64 v53, v53 clamp
    v_pk_mul_f32 v[54:55], v[142:143], s[94:95] op_sel_hi:[1,0]
    v_max_f32 v142, 0x358637bd, v142
    v_max_f32 v143, 0x358637bd, v143
    v_exp_f32_e64 v54, v54 clamp
    v_exp_f32_e64 v55, v55 clamp
    v_pk_add_f32 v[140:141], v[140:141], v[52:53]
    v_pk_add_f32 v[142:143], v[142:143], v[54:55]
    v_cvt_pk_bf16_f32 v74, v140, v141
    v_cvt_pk_bf16_f32 v75, v142, v143
    s_lshl_b32 s31, s86, 10
    s_add_u32 s31, s31, 8388608
    buffer_load_dwordx4 a[120:123], v29, s[20:23], s31 offen sc1
    v_pk_mul_f32 v[52:53], v[144:145], s[94:95] op_sel_hi:[1,0]
    v_max_f32 v144, 0x358637bd, v144
    v_max_f32 v145, 0x358637bd, v145
    v_exp_f32_e64 v52, v52 clamp
    v_exp_f32_e64 v53, v53 clamp
    v_pk_mul_f32 v[54:55], v[146:147], s[94:95] op_sel_hi:[1,0]
    v_max_f32 v146, 0x358637bd, v146
    v_max_f32 v147, 0x358637bd, v147
    v_exp_f32_e64 v54, v54 clamp
    v_exp_f32_e64 v55, v55 clamp
    v_pk_add_f32 v[144:145], v[144:145], v[52:53]
    v_pk_add_f32 v[146:147], v[146:147], v[54:55]
    v_cvt_pk_bf16_f32 v64, v144, v145
    v_cvt_pk_bf16_f32 v65, v146, v147
    s_add_u32 s31, s31, 20480
    buffer_load_dwordx4 a[124:127], v29, s[20:23], s31 offen sc1
    v_pk_mul_f32 v[52:53], v[148:149], s[94:95] op_sel_hi:[1,0]
    v_max_f32 v148, 0x358637bd, v148
    v_max_f32 v149, 0x358637bd, v149
    v_exp_f32_e64 v52, v52 clamp
    v_exp_f32_e64 v53, v53 clamp
    v_pk_mul_f32 v[54:55], v[150:151], s[94:95] op_sel_hi:[1,0]
    v_max_f32 v150, 0x358637bd, v150
    v_max_f32 v151, 0x358637bd, v151
    v_exp_f32_e64 v54, v54 clamp
    v_exp_f32_e64 v55, v55 clamp
    v_pk_add_f32 v[148:149], v[148:149], v[52:53]
    v_pk_add_f32 v[150:151], v[150:151], v[54:55]
    v_cvt_pk_bf16_f32 v76, v148, v149
    v_cvt_pk_bf16_f32 v77, v150, v151
    s_add_u32 s31, s31, 20480
    buffer_load_dwordx4 a[128:131], v29, s[20:23], s31 offen sc1
    s_waitcnt vmcnt(5)
    s_mov_b32 s96, 0
    s_mov_b32 s93, 0x07060302
    v_xor_b32 v216, s47, v216
    v_xor_b32 v218, s47, v218
    v_xor_b32 v220, s47, v220
    v_xor_b32 v222, s47, v222
    v_or3_b32 v250, v216, v218, v220
    v_xor_b32 v102, s47, v102
    v_xor_b32 v103, s47, v103
    v_or3_b32 v250, v250, v222, v102
    v_or_b32 v250, v250, v103
    v_and_b32 v250, 0xffff, v250
    v_cmp_ne_u32 vcc, 0, v250
    s_add_u32 s96, s96, 1
    s_cbranch_vccnz LB_rk
LB_kok:
    v_perm_b32 v216, v217, v216, s93
    v_perm_b32 v217, v219, v218, s93
    ds_write_b64 v2, v[216:217]
    v_perm_b32 v220, v221, v220, s93
    v_perm_b32 v221, v223, v222, s93
    ds_write_b64 v3, v[220:221]
    v_mov_b64 v[66:67], 0
    v_mov_b64 v[78:79], 0
    s_add_u32 s31, s31, 20480
    buffer_load_dwordx4 a[132:135], v29, s[20:23], s31 offen sc1
    s_add_u32 s31, s31, 20480
    buffer_load_dwordx4 v[152:155], v29, s[20:23], s31 offen sc1
    s_lshl_b32 s31, s87, 10
    s_add_u32 s31, s31, 8388608
    buffer_load_dwordx4 v[156:159], v29, s[20:23], s31 offen sc1
    s_waitcnt lgkmcnt(0)
    s_barrier
    s_cmp_eq_u32 s3, 0
    s_cselect_b32 s7, 0, 1073741824
    s_mov_b64 exec, 0xff00000
    v_mov_b32 v15, 0
    buffer_atomic_add v15, v12, s[20:23], s7 offen sc0 sc1
    s_mov_b64 exec, -1
    ds_read_b128 v[196:199], v20 offset:960
    ds_read_b128 v[200:203], v20 offset:976
    ds_read_b128 v[204:207], v20 offset:992
    ds_read_b128 v[208:211], v20 offset:0
    ds_read_b128 v[212:215], v20 offset:16
    ds_read_b128 v[216:219], v20 offset:32
    s_waitcnt lgkmcnt(5)
    v_mfma_f32_16x16x32_bf16 v[104:107], v[196:199], v[56:59], 0
    ds_read_b128 v[220:223], v20 offset:192
    v_mfma_f32_16x16x32_bf16 v[108:111], v[196:199], v[68:71], 0
    s_add_u32 s31, s31, 20480
    s_waitcnt lgkmcnt(5)
    v_mfma_f32_16x16x32_bf16 v[104:107], v[200:203], v[60:63], v[104:107]
    ds_read_b128 v[224:227], v20 offset:208
    v_mfma_f32_16x16x32_bf16 v[108:111], v[200:203], v[72:75], v[108:111]
    buffer_load_dwordx4 v[160:163], v29, s[20:23], s31 offen sc1
    s_waitcnt lgkmcnt(5)
    v_mfma_f32_16x16x32_bf16 v[104:107], v[204:207], v[64:67], v[104:107]
    ds_read_b128 v[228:231], v20 offset:224
    v_mfma_f32_16x16x32_bf16 v[108:111], v[204:207], v[76:79], v[108:111]
    s_add_u32 s31, s31, 20480
    v_sub_f32 v102, 1.0, v102
    v_sub_f32 v103, 1.0, v103
    v_cvt_pk_bf16_f32 v103, v102, v103
    v_lshlrev_b32 v102, 16, v103
    v_and_b32 v103, 0xffff0000, v103
    s_waitcnt lgkmcnt(5)
    v_mfma_f32_16x16x32_bf16 v[112:115], v[208:211], v[56:59], 0
    ds_read_b128 v[232:235], v20 offset:384
    v_mfma_f32_16x16x32_bf16 v[116:119], v[208:211], v[68:71], 0
    buffer_load_dwordx4 v[164:167], v29, s[20:23], s31 offen sc1
    s_waitcnt lgkmcnt(5)
    v_mfma_f32_16x16x32_bf16 v[112:115], v[212:215], v[60:63], v[112:115]
    ds_read_b128 v[236:239], v20 offset:400
    v_mfma_f32_16x16x32_bf16 v[116:119], v[212:215], v[72:75], v[116:119]
    s_add_u32 s31, s31, 20480
    s_waitcnt lgkmcnt(5)
    v_mfma_f32_16x16x32_bf16 v[112:115], v[216:219], v[64:67], v[112:115]
    ds_read_b128 v[240:243], v20 offset:416
    v_mfma_f32_16x16x32_bf16 v[116:119], v[216:219], v[76:79], v[116:119]
    buffer_load_dwordx4 v[168:171], v29, s[20:23], s31 offen sc1
    s_waitcnt lgkmcnt(5)
    v_mfma_f32_16x16x32_bf16 v[120:123], v[220:223], v[56:59], 0
    ds_read_b128 v[244:247], v20 offset:576
    v_mfma_f32_16x16x32_bf16 v[124:127], v[220:223], v[68:71], 0
    s_add_u32 s31, s31, 20480
    s_waitcnt lgkmcnt(5)
    v_mfma_f32_16x16x32_bf16 v[120:123], v[224:227], v[60:63], v[120:123]
    ds_read_b128 v[32:35], v20 offset:592
    v_mfma_f32_16x16x32_bf16 v[124:127], v[224:227], v[72:75], v[124:127]
    buffer_load_dwordx4 v[172:175], v29, s[20:23], s31 offen sc1
    s_waitcnt lgkmcnt(5)
    v_mfma_f32_16x16x32_bf16 v[120:123], v[228:231], v[64:67], v[120:123]
    ds_read_b128 v[36:39], v20 offset:608
    v_mfma_f32_16x16x32_bf16 v[124:127], v[228:231], v[76:79], v[124:127]
    s_lshl_b32 s31, s88, 10
    s_add_u32 s31, s31, 8388608
    v_add_f32 v104, 0x358637bd, v104
    v_add_f32 v108, 0x358637bd, v108
    v_rcp_f32 v104, v104
    v_rcp_f32 v108, v108
    s_waitcnt lgkmcnt(5)
    v_mfma_f32_16x16x32_bf16 v[128:131], v[232:235], v[56:59], 0
    ds_read_b128 v[40:43], v20 offset:768
    v_mfma_f32_16x16x32_bf16 v[132:135], v[232:235], v[68:71], 0
    buffer_load_dwordx4 v[176:179], v29, s[20:23], s31 offen sc1
    s_waitcnt lgkmcnt(5)
    v_mfma_f32_16x16x32_bf16 v[128:131], v[236:239], v[60:63], v[128:131]
    ds_read_b128 v[44:47], v20 offset:784
    v_mfma_f32_16x16x32_bf16 v[132:135], v[236:239], v[72:75], v[132:135]
    s_add_u32 s31, s31, 20480
    s_waitcnt lgkmcnt(5)
    v_mfma_f32_16x16x32_bf16 v[128:131], v[240:243], v[64:67], v[128:131]
    ds_read_b128 v[48:51], v20 offset:800
    v_mfma_f32_16x16x32_bf16 v[132:135], v[240:243], v[76:79], v[132:135]
    buffer_load_dwordx4 v[180:183], v29, s[20:23], s31 offen sc1
    v_mul_f32 v104, v104, v102
    v_mul_f32 v108, v108, v103
    s_waitcnt lgkmcnt(5)
    v_mfma_f32_16x16x32_bf16 v[136:139], v[244:247], v[56:59], 0
    v_mfma_f32_16x16x32_bf16 v[140:143], v[244:247], v[68:71], 0
    s_add_u32 s31, s31, 20480
    s_waitcnt lgkmcnt(4)
    v_mfma_f32_16x16x32_bf16 v[136:139], v[32:35], v[60:63], v[136:139]
    v_mfma_f32_16x16x32_bf16 v[140:143], v[32:35], v[72:75], v[140:143]
    buffer_load_dwordx4 v[184:187], v29, s[20:23], s31 offen sc1
    s_waitcnt lgkmcnt(3)
    v_mfma_f32_16x16x32_bf16 v[136:139], v[36:39], v[64:67], v[136:139]
    v_mfma_f32_16x16x32_bf16 v[140:143], v[36:39], v[76:79], v[140:143]
    s_add_u32 s31, s31, 20480
    s_waitcnt lgkmcnt(2)
    v_mfma_f32_16x16x32_bf16 v[144:147], v[40:43], v[56:59], 0
    v_mfma_f32_16x16x32_bf16 v[148:151], v[40:43], v[68:71], 0
    buffer_load_dwordx4 v[188:191], v29, s[20:23], s31 offen sc1
    s_waitcnt lgkmcnt(1)
    v_mfma_f32_16x16x32_bf16 v[144:147], v[44:47], v[60:63], v[144:147]
    v_mfma_f32_16x16x32_bf16 v[148:151], v[44:47], v[72:75], v[148:151]
    s_add_u32 s31, s31, 20480
    s_waitcnt lgkmcnt(0)
    v_mfma_f32_16x16x32_bf16 v[144:147], v[48:51], v[64:67], v[144:147]
    v_mfma_f32_16x16x32_bf16 v[148:151], v[48:51], v[76:79], v[148:151]
    buffer_load_dwordx4 v[192:195], v29, s[20:23], s31 offen sc1
    v_pk_mul_f32 v[112:113], v[112:113], v[104:105] op_sel_hi:[1,0]
    v_pk_mul_f32 v[114:115], v[114:115], v[104:105] op_sel_hi:[1,0]
    v_pk_mul_f32 v[120:121], v[120:121], v[104:105] op_sel_hi:[1,0]
    v_pk_mul_f32 v[122:123], v[122:123], v[104:105] op_sel_hi:[1,0]
    v_cvt_pk_bf16_f32 v80, v112, v113
    v_cvt_pk_bf16_f32 v81, v114, v115
    v_cvt_pk_bf16_f32 v82, v120, v121
    v_cvt_pk_bf16_f32 v83, v122, v123
    buffer_store_dwordx4 v[80:83], v10, s[20:23], s56 offen offset:0 sc1
    v_pk_mul_f32 v[116:117], v[116:117], v[108:109] op_sel_hi:[1,0]
    v_pk_mul_f32 v[118:119], v[118:119], v[108:109] op_sel_hi:[1,0]
    v_pk_mul_f32 v[124:125], v[124:125], v[108:109] op_sel_hi:[1,0]
    v_pk_mul_f32 v[126:127], v[126:127], v[108:109] op_sel_hi:[1,0]
    v_cvt_pk_bf16_f32 v88, v116, v117
    v_cvt_pk_bf16_f32 v89, v118, v119
    v_cvt_pk_bf16_f32 v90, v124, v125
    v_cvt_pk_bf16_f32 v91, v126, v127
    buffer_store_dwordx4 v[88:91], v10, s[20:23], s57 offen offset:0 sc1
    v_pk_mul_f32 v[128:129], v[128:129], v[104:105] op_sel_hi:[1,0]
    v_pk_mul_f32 v[130:131], v[130:131], v[104:105] op_sel_hi:[1,0]
    v_pk_mul_f32 v[136:137], v[136:137], v[104:105] op_sel_hi:[1,0]
    v_pk_mul_f32 v[138:139], v[138:139], v[104:105] op_sel_hi:[1,0]
    v_cvt_pk_bf16_f32 v84, v128, v129
    v_cvt_pk_bf16_f32 v85, v130, v131
    v_cvt_pk_bf16_f32 v86, v136, v137
    v_cvt_pk_bf16_f32 v87, v138, v139
    buffer_store_dwordx4 v[84:87], v10, s[20:23], s56 offen offset:1024 sc1
    v_pk_mul_f32 v[132:133], v[132:133], v[108:109] op_sel_hi:[1,0]
    v_pk_mul_f32 v[134:135], v[134:135], v[108:109] op_sel_hi:[1,0]
    v_pk_mul_f32 v[140:141], v[140:141], v[108:109] op_sel_hi:[1,0]
    v_pk_mul_f32 v[142:143], v[142:143], v[108:109] op_sel_hi:[1,0]
    v_cvt_pk_bf16_f32 v92, v132, v133
    v_cvt_pk_bf16_f32 v93, v134, v135
    v_cvt_pk_bf16_f32 v94, v140, v141
    v_cvt_pk_bf16_f32 v95, v142, v143
    buffer_store_dwordx4 v[92:95], v10, s[20:23], s57 offen offset:1024 sc1
    v_pk_mul_f32 v[144:145], v[144:145], v[104:105] op_sel_hi:[1,0]
    v_pk_mul_f32 v[146:147], v[146:147], v[104:105] op_sel_hi:[1,0]
    v_cvt_pk_bf16_f32 v96, v144, v145
    v_cvt_pk_bf16_f32 v97, v146, v147
    v_pk_mul_f32 v[148:149], v[148:149], v[108:109] op_sel_hi:[1,0]
    v_pk_mul_f32 v[150:151], v[150:151], v[108:109] op_sel_hi:[1,0]
    v_cvt_pk_bf16_f32 v98, v148, v149
    v_cvt_pk_bf16_f32 v99, v150, v151
    s_nop 0
    v_permlane16_swap_b32 v96, v98
    v_permlane16_swap_b32 v97, v99
    buffer_store_dwordx4 v[96:99], v9, s[20:23], s56 offen offset:2048 sc1
    s_mul_i32 s31, s79, 61440
    v_add_u32 v2, s31, v10
    s_mul_i32 s31, s80, 61440
    v_add_u32 v3, s31, v10
    s_mul_i32 s31, s81, 61440
    v_add_u32 v4, s31, v10
    s_mul_i32 s31, s82, 61440
    v_add_u32 v5, s31, v10
    s_mul_i32 s7, s28, 245760
    s_lshl_b32 s92, s84, 11
    s_add_u32 s64, s7, s92
    s_waitcnt vmcnt(14)
LK2:
    s_cmp_lg_u32 s3, 0
    s_cbranch_scc1 Lpolls_32
    s_mov_b64 exec, 0xff00000
    s_mov_b32 s96, 0
    s_waitcnt vmcnt(40)
    s_branch Lpollc_31
Lpoll_29:
    s_mov_b64 exec, vcc
    v_mov_b32 v15, 0
    buffer_atomic_add v15, v12, s[20:23], 0 offen sc0 sc1
    s_add_u32 s96, s96, 1
    s_waitcnt vmcnt(0)
Lpollc_31:
    v_cmp_ne_u32 vcc, s6, v15
    s_cmp_gt_u32 s96, 0x20000
    s_cbranch_scc1 Lpolle_30
    s_cbranch_vccnz Lpoll_29
Lpolle_30:
    s_mov_b64 exec, -1
Lpolls_32:
    s_barrier
    buffer_load_dwordx4 v[196:199], v2, s[20:23], s64 offen offset:0 sc1
    buffer_load_dwordx4 v[200:203], v3, s[20:23], s64 offen offset:0 sc1
    buffer_load_dwordx4 v[204:207], v4, s[20:23], s64 offen offset:0 sc1
    buffer_load_dwordx4 v[208:211], v5, s[20:23], s64 offen offset:0 sc1
    s_mul_i32 s7, s28, 245760
    s_add_u32 s93, s7, 40960
    s_lshl_b32 s92, s84, 11
    s_add_u32 s64, s7, s92
    s_lshl_b32 s92, s84, 10
    s_add_u32 s69, s93, s92
    s_lshl_b32 s92, s85, 11
    s_add_u32 s65, s7, s92
    s_lshl_b32 s92, s85, 10
    s_add_u32 s70, s93, s92
    s_lshl_b32 s92, s86, 11
    s_add_u32 s66, s7, s92
    s_lshl_b32 s92, s86, 10
    s_add_u32 s71, s93, s92
    s_lshl_b32 s92, s87, 11
    s_add_u32 s67, s7, s92
    s_lshl_b32 s92, s87, 10
    s_add_u32 s72, s93, s92
    s_lshl_b32 s92, s88, 11
    s_add_u32 s68, s7, s92
    s_lshl_b32 s92, s88, 10
    s_add_u32 s73, s93, s92
    s_waitcnt lgkmcnt(0)
    v_accvgpr_read_b32 v249, a136
    v_accvgpr_read_b32 v251, a146
    v_lshlrev_b32 v248, 16, v249
    v_and_b32 v249, 0xffff0000, v249
    v_lshlrev_b32 v250, 16, v251
    v_and_b32 v251, 0xffff0000, v251
    v_pk_mul_f32 v[248:249], v[248:249], v[250:251]
    v_cvt_pk_bf16_f32 v248, v248, v249
    v_lshlrev_b32 v132, 16, v248
    v_and_b32 v133, 0xffff0000, v248
    buffer_load_dwordx4 v[212:215], v2, s[20:23], s64 offen offset:1024 sc1
    v_accvgpr_read_b32 v249, a137
    v_accvgpr_read_b32 v251, a147
    v_lshlrev_b32 v248, 16, v249
    v_and_b32 v249, 0xffff0000, v249
    v_lshlrev_b32 v250, 16, v251
    v_and_b32 v251, 0xffff0000, v251
    v_pk_mul_f32 v[248:249], v[248:249], v[250:251]
    v_cvt_pk_bf16_f32 v248, v248, v249
    v_lshlrev_b32 v134, 16, v248
    v_and_b32 v135, 0xffff0000, v248
    buffer_load_dwordx4 v[216:219], v3, s[20:23], s64 offen offset:1024 sc1
    v_accvgpr_read_b32 v249, a138
    v_accvgpr_read_b32 v251, a148
    v_lshlrev_b32 v248, 16, v249
    v_and_b32 v249, 0xffff0000, v249
    v_lshlrev_b32 v250, 16, v251
    v_and_b32 v251, 0xffff0000, v251
    v_pk_mul_f32 v[248:249], v[248:249], v[250:251]
    v_cvt_pk_bf16_f32 v248, v248, v249
    v_lshlrev_b32 v136, 16, v248
    v_and_b32 v137, 0xffff0000, v248
    v_accvgpr_read_b32 v249, a139
    v_accvgpr_read_b32 v251, a149
    v_lshlrev_b32 v248, 16, v249
    v_and_b32 v249, 0xffff0000, v249
    v_lshlrev_b32 v250, 16, v251
    v_and_b32 v251, 0xffff0000, v251
    v_pk_mul_f32 v[248:249], v[248:249], v[250:251]
    v_cvt_pk_bf16_f32 v248, v248, v249
    v_lshlrev_b32 v138, 16, v248
    v_and_b32 v139, 0xffff0000, v248
    v_accvgpr_read_b32 v249, a140
    v_accvgpr_read_b32 v251, a150
    v_lshlrev_b32 v248, 16, v249
    v_and_b32 v249, 0xffff0000, v249
    v_lshlrev_b32 v250, 16, v251
    v_and_b32 v251, 0xffff0000, v251
    v_pk_mul_f32 v[248:249], v[248:249], v[250:251]
    v_cvt_pk_bf16_f32 v248, v248, v249
    v_lshlrev_b32 v140, 16, v248
    v_and_b32 v141, 0xffff0000, v248
    v_accvgpr_read_b32 v249, a141
    v_accvgpr_read_b32 v251, a151
    v_lshlrev_b32 v248, 16, v249
    v_and_b32 v249, 0xffff0000, v249
    v_lshlrev_b32 v250, 16, v251
    v_and_b32 v251, 0xffff0000, v251
    v_pk_mul_f32 v[248:249], v[248:249], v[250:251]
    v_cvt_pk_bf16_f32 v248, v248, v249
    v_lshlrev_b32 v142, 16, v248
    v_and_b32 v143, 0xffff0000, v248
    v_accvgpr_read_b32 v249, a142
    v_accvgpr_read_b32 v251, a152
    v_lshlrev_b32 v248, 16, v249
    v_and_b32 v249, 0xffff0000, v249
    v_lshlrev_b32 v250, 16, v251
    v_and_b32 v251, 0xffff0000, v251
    v_pk_mul_f32 v[248:249], v[248:249], v[250:251]
    v_cvt_pk_bf16_f32 v248, v248, v249
    v_lshlrev_b32 v144, 16, v248
    v_and_b32 v145, 0xffff0000, v248
    v_accvgpr_read_b32 v249, a143
    v_accvgpr_read_b32 v251, a153
    v_lshlrev_b32 v248, 16, v249
    v_and_b32 v249, 0xffff0000, v249
    v_lshlrev_b32 v250, 16, v251
    v_and_b32 v251, 0xffff0000, v251
    v_pk_mul_f32 v[248:249], v[248:249], v[250:251]
    v_cvt_pk_bf16_f32 v248, v248, v249
    v_lshlrev_b32 v146, 16, v248
    v_and_b32 v147, 0xffff0000, v248
    v_accvgpr_read_b32 v249, a144
    v_accvgpr_read_b32 v251, a154
    v_lshlrev_b32 v248, 16, v249
    v_and_b32 v249, 0xffff0000, v249
    v_lshlrev_b32 v250, 16, v251
    v_and_b32 v251, 0xffff0000, v251
    v_pk_mul_f32 v[248:249], v[248:249], v[250:251]
    v_cvt_pk_bf16_f32 v248, v248, v249
    v_lshlrev_b32 v148, 16, v248
    v_and_b32 v149, 0xffff0000, v248
    v_accvgpr_read_b32 v249, a145
    v_accvgpr_read_b32 v251, a155
    v_lshlrev_b32 v248, 16, v249
    v_and_b32 v249, 0xffff0000, v249
    v_lshlrev_b32 v250, 16, v251
    v_and_b32 v251, 0xffff0000, v251
    v_pk_mul_f32 v[248:249], v[248:249], v[250:251]
    v_cvt_pk_bf16_f32 v248, v248, v249
    v_lshlrev_b32 v150, 16, v248
    v_and_b32 v151, 0xffff0000, v248
    s_waitcnt vmcnt(6) lgkmcnt(0)
    s_barrier
    s_cmp_eq_u32 s100, 0
    s_cbranch_scc1 LB_nf2
    s_cmp_lg_u32 s3, 3
    s_cbranch_scc1 LB_nf2
    s_lshl_b32 s7, s5, 4
    s_add_u32 s7, s7, s4
    s_mul_i32 s7, s7, 128
    s_add_u32 s7, s7, 11075584
    v_lshl_add_u32 v252, v1, 2, s7
    v_mov_b32 v253, s6
    s_mov_b32 exec_hi, 0
    buffer_store_dword v253, v252, s[20:23], 0 offen sc1
    s_mov_b64 exec, -1
LB_nf2:
    s_waitcnt vmcnt(5)
    v_mfma_f32_16x16x32_bf16 v[32:35], a[160:163], v[196:199], 0
    buffer_load_dwordx4 v[220:223], v4, s[20:23], s64 offen offset:1024 sc1
    v_mfma_f32_16x16x32_bf16 v[36:39], a[164:167], v[196:199], 0
    v_and_b32 v13, 15, v1
    v_lshlrev_b32 v13, 2, v13
    v_mfma_f32_16x16x32_bf16 v[40:43], a[168:171], v[196:199], 0
    buffer_load_dwordx4 v[224:227], v5, s[20:23], s64 offen offset:1024 sc1
    v_mfma_f32_16x16x32_bf16 v[44:47], a[172:175], v[196:199], 0
    s_lshl_b32 s92, s28, 2
    s_add_u32 s92, s92, s79
    v_mfma_f32_16x16x32_bf16 v[48:51], a[176:179], v[196:199], 0
    buffer_load_dwordx4 v[228:231], v2, s[20:23], s65 offen offset:0 sc1
    s_waitcnt vmcnt(7)
    v_mfma_f32_16x16x32_bf16 v[52:55], a[160:163], v[200:203], 0
    buffer_load_dwordx4 v[232:235], v3, s[20:23], s65 offen offset:0 sc1
    v_mfma_f32_16x16x32_bf16 v[56:59], a[164:167], v[200:203], 0
    s_lshl_b32 s92, s92, 7
    s_add_u32 s92, s92, 11010048
    v_mfma_f32_16x16x32_bf16 v[60:63], a[168:171], v[200:203], 0
    buffer_load_dwordx4 v[236:239], v4, s[20:23], s65 offen offset:0 sc1
    v_mfma_f32_16x16x32_bf16 v[64:67], a[172:175], v[200:203], 0
    s_lshl_b32 s93, s28, 2
    s_add_u32 s93, s93, s80
    v_mfma_f32_16x16x32_bf16 v[68:71], a[176:179], v[200:203], 0
    buffer_load_dwordx4 v[240:243], v5, s[20:23], s65 offen offset:0 sc1
    s_waitcnt vmcnt(9)
    v_mfma_f32_16x16x32_bf16 v[72:75], a[160:163], v[204:207], 0
    buffer_load_dwordx4 v[196:199], v2, s[20:23], s65 offen offset:1024 sc1
    v_mfma_f32_16x16x32_bf16 v[76:79], a[164:167], v[204:207], 0
    s_lshl_b32 s93, s93, 7
    s_add_u32 s93, s93, 11010048
    v_mfma_f32_16x16x32_bf16 v[80:83], a[168:171], v[204:207], 0
    buffer_load_dwordx4 v[200:203], v3, s[20:23], s65 offen offset:1024 sc1
    v_mfma_f32_16x16x32_bf16 v[84:87], a[172:175], v[204:207], 0
    s_lshl_b32 s94, s28, 2
    s_add_u32 s94, s94, s81
    v_mfma_f32_16x16x32_bf16 v[88:91], a[176:179], v[204:207], 0
    s_waitcnt vmcnt(10)
    v_mfma_f32_16x16x32_bf16 v[92:95], a[160:163], v[208:211], 0
    buffer_load_dwordx4 v[204:207], v4, s[20:23], s65 offen offset:1024 sc1
    v_mfma_f32_16x16x32_bf16 v[96:99], a[164:167], v[208:211], 0
    s_lshl_b32 s94, s94, 7
    s_add_u32 s94, s94, 11010048
    v_mfma_f32_16x16x32_bf16 v[100:103], a[168:171], v[208:211], 0
    s_lshl_b32 s95, s28, 2
    s_add_u32 s95, s95, s82
    v_mfma_f32_16x16x32_bf16 v[104:107], a[172:175], v[208:211], 0
    s_lshl_b32 s95, s95, 7
    s_add_u32 s95, s95, 11010048
    v_mfma_f32_16x16x32_bf16 v[108:111], a[176:179], v[208:211], 0
    s_waitcnt vmcnt(10)
    v_mfma_f32_16x16x32_bf16 v[32:35], a[180:183], v[212:215], v[32:35]
    s_mul_i32 s39, s88, 10240
    s_add_u32 s39, s39, 11534336
    buffer_load_dwordx4 a[136:139], v26, s[20:23], s39 offen offset:0 sc1
    v_mfma_f32_16x16x32_bf16 v[36:39], a[184:187], v[212:215], v[36:39]
    s_mov_b32 s24, s58
    s_and_b32 s25, s59, 0xffff
    v_mfma_f32_16x16x32_bf16 v[40:43], a[188:191], v[212:215], v[40:43]
    s_mov_b32 s26, 5242880
    s_mov_b32 s27, 0x20000
    v_mfma_f32_16x16x32_bf16 v[44:47], a[192:195], v[212:215], v[44:47]
    s_add_u32 s38, s29, s3
    s_and_b32 s38, s38, 3
    v_mfma_f32_16x16x32_bf16 v[48:51], a[196:199], v[212:215], v[48:51]
    s_waitcnt vmcnt(10)
    v_mfma_f32_16x16x32_bf16 v[52:55], a[180:183], v[216:219], v[52:55]
    buffer_load_dwordx4 v[208:211], v5, s[20:23], s65 offen offset:1024 sc1
    v_mfma_f32_16x16x32_bf16 v[56:59], a[184:187], v[216:219], v[56:59]
    s_lshl_b32 s34, s28, 6
    s_lshr_b32 s35, s79, 1
    v_mfma_f32_16x16x32_bf16 v[60:63], a[188:191], v[216:219], v[60:63]
    s_lshl_b32 s35, s35, 5
    s_and_b32 s36, s79, 1
    v_mfma_f32_16x16x32_bf16 v[64:67], a[192:195], v[216:219], v[64:67]
    s_lshl_b32 s36, s36, 1
    s_add_u32 s35, s35, s36
    v_mfma_f32_16x16x32_bf16 v[68:71], a[196:199], v[216:219], v[68:71]
    s_waitcnt vmcnt(10)
    s_cmp_lg_u32 s3, 0
    s_cbranch_scc1 Lsk_33
    v_pk_add_f32 v[32:33], v[32:33], v[132:133]
    v_pk_add_f32 v[34:35], v[34:35], v[134:135]
    v_pk_add_f32 v[36:37], v[36:37], v[136:137]
    v_pk_add_f32 v[38:39], v[38:39], v[138:139]
    v_pk_add_f32 v[40:41], v[40:41], v[140:141]
    v_pk_add_f32 v[42:43], v[42:43], v[142:143]
    v_pk_add_f32 v[44:45], v[44:45], v[144:145]
    v_pk_add_f32 v[46:47], v[46:47], v[146:147]
    v_pk_add_f32 v[48:49], v[48:49], v[148:149]
    v_pk_add_f32 v[50:51], v[50:51], v[150:151]
Lsk_33:
    v_mfma_f32_16x16x32_bf16 v[72:75], a[180:183], v[220:223], v[72:75]
    buffer_load_dwordx4 v[212:215], v2, s[20:23], s66 offen offset:0 sc1
    v_mfma_f32_16x16x32_bf16 v[76:79], a[184:187], v[220:223], v[76:79]
    s_add_u32 s35, s35, s34
    s_mul_i32 s79, s35, 2560
    v_mfma_f32_16x16x32_bf16 v[80:83], a[188:191], v[220:223], v[80:83]
    s_lshr_b32 s35, s80, 1
    s_lshl_b32 s35, s35, 5
    v_mfma_f32_16x16x32_bf16 v[84:87], a[192:195], v[220:223], v[84:87]
    s_and_b32 s36, s80, 1
    s_lshl_b32 s36, s36, 1
    v_mfma_f32_16x16x32_bf16 v[88:91], a[196:199], v[220:223], v[88:91]
    s_waitcnt vmcnt(10)
    s_cmp_lg_u32 s3, 1
    s_cbranch_scc1 Lsk_34
    v_pk_add_f32 v[52:53], v[52:53], v[132:133]
    v_pk_add_f32 v[54:55], v[54:55], v[134:135]
    v_pk_add_f32 v[56:57], v[56:57], v[136:137]
    v_pk_add_f32 v[58:59], v[58:59], v[138:139]
    v_pk_add_f32 v[60:61], v[60:61], v[140:141]
    v_pk_add_f32 v[62:63], v[62:63], v[142:143]
    v_pk_add_f32 v[64:65], v[64:65], v[144:145]
    v_pk_add_f32 v[66:67], v[66:67], v[146:147]
    v_pk_add_f32 v[68:69], v[68:69], v[148:149]
    v_pk_add_f32 v[70:71], v[70:71], v[150:151]
Lsk_34:
    v_mfma_f32_16x16x32_bf16 v[92:95], a[180:183], v[224:227], v[92:95]
    buffer_load_dwordx4 v[216:219], v3, s[20:23], s66 offen offset:0 sc1
    v_mfma_f32_16x16x32_bf16 v[96:99], a[184:187], v[224:227], v[96:99]
    s_add_u32 s35, s35, s36
    s_add_u32 s35, s35, s34
    v_mfma_f32_16x16x32_bf16 v[100:103], a[188:191], v[224:227], v[100:103]
    s_mul_i32 s80, s35, 2560
    s_lshr_b32 s35, s81, 1
    v_mfma_f32_16x16x32_bf16 v[104:107], a[192:195], v[224:227], v[104:107]
    s_lshl_b32 s35, s35, 5
    s_and_b32 s36, s81, 1
    v_mfma_f32_16x16x32_bf16 v[108:111], a[196:199], v[224:227], v[108:111]
    s_waitcnt vmcnt(10)
    s_cmp_lg_u32 s3, 2
    s_cbranch_scc1 Lsk_35
    v_pk_add_f32 v[72:73], v[72:73], v[132:133]
    v_pk_add_f32 v[74:75], v[74:75], v[134:135]
    v_pk_add_f32 v[76:77], v[76:77], v[136:137]
    v_pk_add_f32 v[78:79], v[78:79], v[138:139]
    v_pk_add_f32 v[80:81], v[80:81], v[140:141]
    v_pk_add_f32 v[82:83], v[82:83], v[142:143]
    v_pk_add_f32 v[84:85], v[84:85], v[144:145]
    v_pk_add_f32 v[86:87], v[86:87], v[146:147]
    v_pk_add_f32 v[88:89], v[88:89], v[148:149]
    v_pk_add_f32 v[90:91], v[90:91], v[150:151]
Lsk_35:
    v_mfma_f32_16x16x32_bf16 v[32:35], a[200:203], v[228:231], v[32:35]
    buffer_load_dwordx4 a[140:143], v26, s[20:23], s39 offen offset:2048 sc1
    v_mfma_f32_16x16x32_bf16 v[36:39], a[204:207], v[228:231], v[36:39]
    s_lshl_b32 s36, s36, 1
    s_add_u32 s35, s35, s36
    v_mfma_f32_16x16x32_bf16 v[40:43], a[208:211], v[228:231], v[40:43]
    s_add_u32 s35, s35, s34
    s_mul_i32 s81, s35, 2560
    v_mfma_f32_16x16x32_bf16 v[44:47], a[212:215], v[228:231], v[44:47]
    s_lshr_b32 s35, s82, 1
    s_lshl_b32 s35, s35, 5
    v_mfma_f32_16x16x32_bf16 v[48:51], a[216:219], v[228:231], v[48:51]
    s_waitcnt vmcnt(10)
    s_cmp_lg_u32 s3, 3
    s_cbranch_scc1 Lsk_36
    v_pk_add_f32 v[92:93], v[92:93], v[132:133]
    v_pk_add_f32 v[94:95], v[94:95], v[134:135]
    v_pk_add_f32 v[96:97], v[96:97], v[136:137]
    v_pk_add_f32 v[98:99], v[98:99], v[138:139]
    v_pk_add_f32 v[100:101], v[100:101], v[140:141]
    v_pk_add_f32 v[102:103], v[102:103], v[142:143]
    v_pk_add_f32 v[104:105], v[104:105], v[144:145]
    v_pk_add_f32 v[106:107], v[106:107], v[146:147]
    v_pk_add_f32 v[108:109], v[108:109], v[148:149]
    v_pk_add_f32 v[110:111], v[110:111], v[150:151]
Lsk_36:
    v_mfma_f32_16x16x32_bf16 v[52:55], a[200:203], v[232:235], v[52:55]
    buffer_load_dwordx4 v[220:223], v4, s[20:23], s66 offen offset:0 sc1
    v_mfma_f32_16x16x32_bf16 v[56:59], a[204:207], v[232:235], v[56:59]
    s_and_b32 s36, s82, 1
    s_lshl_b32 s36, s36, 1
    v_mfma_f32_16x16x32_bf16 v[60:63], a[208:211], v[232:235], v[60:63]
    s_add_u32 s35, s35, s36
    s_add_u32 s35, s35, s34
    v_mfma_f32_16x16x32_bf16 v[64:67], a[212:215], v[232:235], v[64:67]
    s_mul_i32 s82, s35, 2560
    s_lshr_b32 s35, s38, 1
    v_mfma_f32_16x16x32_bf16 v[68:71], a[216:219], v[232:235], v[68:71]
    s_waitcnt vmcnt(10)
    v_mfma_f32_16x16x32_bf16 v[72:75], a[200:203], v[236:239], v[72:75]
    buffer_load_dwordx4 v[224:227], v5, s[20:23], s66 offen offset:0 sc1
    v_mfma_f32_16x16x32_bf16 v[76:79], a[204:207], v[236:239], v[76:79]
    s_lshl_b32 s35, s35, 5
    s_and_b32 s36, s38, 1
    v_mfma_f32_16x16x32_bf16 v[80:83], a[208:211], v[236:239], v[80:83]
    s_lshl_b32 s36, s36, 1
    s_add_u32 s35, s35, s36
    v_mfma_f32_16x16x32_bf16 v[84:87], a[212:215], v[236:239], v[84:87]
    s_add_u32 s35, s35, s34
    s_mul_i32 s38, s35, 2560
    v_mfma_f32_16x16x32_bf16 v[88:91], a[216:219], v[236:239], v[88:91]
    s_waitcnt vmcnt(10)
    v_mfma_f32_16x16x32_bf16 v[92:95], a[200:203], v[240:243], v[92:95]
    buffer_load_dwordx4 v[228:231], v2, s[20:23], s66 offen offset:1024 sc1
    v_mfma_f32_16x16x32_bf16 v[96:99], a[204:207], v[240:243], v[96:99]
    s_mul_i32 s36, s29, 320
    s_mul_i32 s37, s3, 5120
    v_mfma_f32_16x16x32_bf16 v[100:103], a[208:211], v[240:243], v[100:103]
    v_mov_b32 v248, v0
    v_mul_u32_u24 v249, 3277, v248
    v_mfma_f32_16x16x32_bf16 v[104:107], a[212:215], v[240:243], v[104:107]
    v_lshrrev_b32 v249, 16, v249
    v_bfe_u32 v250, v249, 1, 2
    v_mfma_f32_16x16x32_bf16 v[108:111], a[216:219], v[240:243], v[108:111]
    s_waitcnt vmcnt(10)
    v_mfma_f32_16x16x32_bf16 v[32:35], a[220:223], v[196:199], v[32:35]
    buffer_load_dwordx4 v[232:235], v3, s[20:23], s66 offen offset:1024 sc1
    v_mfma_f32_16x16x32_bf16 v[36:39], a[224:227], v[196:199], v[36:39]
    v_xor_b32 v250, v250, v248
    v_lshlrev_b32 v246, 4, v250
    v_mfma_f32_16x16x32_bf16 v[40:43], a[228:231], v[196:199], v[40:43]
    v_mul_u32_u24 v250, 20, v249
    v_sub_u32 v248, v248, v250
    v_mfma_f32_16x16x32_bf16 v[44:47], a[232:235], v[196:199], v[44:47]
    v_lshl_add_u32 v248, v248, 4, s36
    v_lshrrev_b32 v250, 2, v249
    v_mfma_f32_16x16x32_bf16 v[48:51], a[236:239], v[196:199], v[48:51]
    s_waitcnt vmcnt(10)
    v_mfma_f32_16x16x32_bf16 v[52:55], a[220:223], v[200:203], v[52:55]
    buffer_load_dwordx4 a[144:147], v27, s[20:23], s39 offen offset:0 sc1
    v_mfma_f32_16x16x32_bf16 v[56:59], a[224:227], v[200:203], v[56:59]
    v_lshlrev_b32 v250, 3, v250
    v_bfe_u32 v251, v249, 1, 1
    v_mfma_f32_16x16x32_bf16 v[60:63], a[228:231], v[200:203], v[60:63]
    v_add_u32 v250, v250, v251
    v_and_b32 v251, 1, v249
    v_mfma_f32_16x16x32_bf16 v[64:67], a[232:235], v[200:203], v[64:67]
    v_lshl_add_u32 v250, v251, 2, v250
    v_mul_u32_u24 v250, 2560, v250
    v_mfma_f32_16x16x32_bf16 v[68:71], a[236:239], v[200:203], v[68:71]
    s_waitcnt vmcnt(10)
    v_mfma_f32_16x16x32_bf16 v[72:75], a[220:223], v[204:207], v[72:75]
    buffer_load_dwordx4 v[236:239], v4, s[20:23], s66 offen offset:1024 sc1
    v_mfma_f32_16x16x32_bf16 v[76:79], a[224:227], v[204:207], v[76:79]
    v_add_u32 v244, v250, v248
    v_add_u32 v248, 256, v1
    v_mfma_f32_16x16x32_bf16 v[80:83], a[228:231], v[204:207], v[80:83]
    buffer_load_dwordx4 v[240:243], v5, s[20:23], s66 offen offset:1024 sc1
    v_mfma_f32_16x16x32_bf16 v[84:87], a[232:235], v[204:207], v[84:87]
    v_mul_u32_u24 v249, 3277, v248
    v_lshrrev_b32 v249, 16, v249
    v_mfma_f32_16x16x32_bf16 v[88:91], a[236:239], v[204:207], v[88:91]
    s_waitcnt vmcnt(10)
    v_mfma_f32_16x16x32_bf16 v[92:95], a[220:223], v[208:211], v[92:95]
    buffer_load_dwordx4 v[196:199], v2, s[20:23], s67 offen offset:0 sc1
    v_mfma_f32_16x16x32_bf16 v[96:99], a[224:227], v[208:211], v[96:99]
    v_bfe_u32 v250, v249, 1, 2
    v_xor_b32 v250, v250, v248
    v_mfma_f32_16x16x32_bf16 v[100:103], a[228:231], v[208:211], v[100:103]
    v_lshl_add_u32 v247, v250, 4, s37
    v_mul_u32_u24 v250, 20, v249
    v_mfma_f32_16x16x32_bf16 v[104:107], a[232:235], v[208:211], v[104:107]
    v_sub_u32 v248, v248, v250
    v_lshl_add_u32 v248, v248, 4, s36
    v_mfma_f32_16x16x32_bf16 v[108:111], a[236:239], v[208:211], v[108:111]
    s_waitcnt vmcnt(10)
    v_mfma_f32_16x16x32_bf16 v[32:35], a[0:3], v[212:215], v[32:35]
    buffer_load_dwordx4 a[148:151], v27, s[20:23], s39 offen offset:2048 sc1
    v_mfma_f32_16x16x32_bf16 v[36:39], a[4:7], v[212:215], v[36:39]
    v_lshrrev_b32 v250, 2, v249
    v_lshlrev_b32 v250, 3, v250
    v_mfma_f32_16x16x32_bf16 v[40:43], a[8:11], v[212:215], v[40:43]
    v_bfe_u32 v251, v249, 1, 1
    v_add_u32 v250, v250, v251
    v_mfma_f32_16x16x32_bf16 v[44:47], a[12:15], v[212:215], v[44:47]
    v_and_b32 v251, 1, v249
    v_lshl_add_u32 v250, v251, 2, v250
    v_mfma_f32_16x16x32_bf16 v[48:51], a[16:19], v[212:215], v[48:51]
    s_waitcnt vmcnt(10)
    v_mfma_f32_16x16x32_bf16 v[52:55], a[0:3], v[216:219], v[52:55]
    buffer_load_dwordx4 v[200:203], v3, s[20:23], s67 offen offset:0 sc1
    v_mfma_f32_16x16x32_bf16 v[56:59], a[4:7], v[216:219], v[56:59]
    v_mul_u32_u24 v250, 2560, v250
    v_add_u32 v245, v250, v248
    v_mfma_f32_16x16x32_bf16 v[60:63], a[8:11], v[216:219], v[60:63]
    buffer_load_dwordx4 v[204:207], v4, s[20:23], s67 offen offset:0 sc1
    v_mfma_f32_16x16x32_bf16 v[64:67], a[12:15], v[216:219], v[64:67]
    v_add_u32 v6, 15360, v246
    v_and_b32 v248, 15, v1
    v_mfma_f32_16x16x32_bf16 v[68:71], a[16:19], v[216:219], v[68:71]
    s_waitcnt vmcnt(10)
    v_mfma_f32_16x16x32_bf16 v[72:75], a[0:3], v[220:223], v[72:75]
    buffer_load_dwordx4 v[208:211], v5, s[20:23], s67 offen offset:0 sc1
    v_mfma_f32_16x16x32_bf16 v[76:79], a[4:7], v[220:223], v[76:79]
    v_lshrrev_b32 v249, 4, v1
    v_bfe_u32 v250, v1, 1, 2
    v_mfma_f32_16x16x32_bf16 v[80:83], a[8:11], v[220:223], v[80:83]
    v_xor_b32 v249, v249, v250
    v_mul_u32_u24 v248, 320, v248
    v_mfma_f32_16x16x32_bf16 v[84:87], a[12:15], v[220:223], v[84:87]
    v_lshl_add_u32 v248, v249, 4, v248
    s_mul_i32 s34, s3, 20480
    v_mfma_f32_16x16x32_bf16 v[88:91], a[16:19], v[220:223], v[88:91]
    s_waitcnt vmcnt(10)
    v_mfma_f32_16x16x32_bf16 v[92:95], a[0:3], v[224:227], v[92:95]
    buffer_load_dwordx4 a[152:155], v28, s[20:23], s39 offen offset:0 sc1
    v_mfma_f32_16x16x32_bf16 v[96:99], a[4:7], v[224:227], v[96:99]
    v_add_u32 v14, s34, v248
    v_mfma_f32_16x16x32_bf16 v[100:103], a[8:11], v[224:227], v[100:103]
    v_mfma_f32_16x16x32_bf16 v[104:107], a[12:15], v[224:227], v[104:107]
    v_mfma_f32_16x16x32_bf16 v[108:111], a[16:19], v[224:227], v[108:111]
    s_waitcnt vmcnt(10)
    v_mfma_f32_16x16x32_bf16 v[32:35], a[20:23], v[228:231], v[32:35]
    buffer_load_dwordx4 v[212:215], v2, s[20:23], s67 offen offset:1024 sc1
    v_mfma_f32_16x16x32_bf16 v[36:39], a[24:27], v[228:231], v[36:39]
    v_mfma_f32_16x16x32_bf16 v[40:43], a[28:31], v[228:231], v[40:43]
    v_mfma_f32_16x16x32_bf16 v[44:47], a[32:35], v[228:231], v[44:47]
    v_mfma_f32_16x16x32_bf16 v[48:51], a[36:39], v[228:231], v[48:51]
    s_waitcnt vmcnt(10)
    v_mfma_f32_16x16x32_bf16 v[52:55], a[20:23], v[232:235], v[52:55]
    buffer_load_dwordx4 v[216:219], v3, s[20:23], s67 offen offset:1024 sc1
    v_mfma_f32_16x16x32_bf16 v[56:59], a[24:27], v[232:235], v[56:59]
    v_mfma_f32_16x16x32_bf16 v[60:63], a[28:31], v[232:235], v[60:63]
    s_mov_b64 exec, 0xff
    buffer_load_dword v15, v11, s[20:23], 0 offen sc1
    s_mov_b64 exec, -1
    v_mfma_f32_16x16x32_bf16 v[64:67], a[32:35], v[232:235], v[64:67]
    v_mfma_f32_16x16x32_bf16 v[68:71], a[36:39], v[232:235], v[68:71]
    s_waitcnt vmcnt(10)
    v_mfma_f32_16x16x32_bf16 v[72:75], a[20:23], v[236:239], v[72:75]
    buffer_load_dword v18, v13, s[20:23], s92 offen sc1
    v_mfma_f32_16x16x32_bf16 v[76:79], a[24:27], v[236:239], v[76:79]
    v_mfma_f32_16x16x32_bf16 v[80:83], a[28:31], v[236:239], v[80:83]
    v_mfma_f32_16x16x32_bf16 v[84:87], a[32:35], v[236:239], v[84:87]
    v_mfma_f32_16x16x32_bf16 v[88:91], a[36:39], v[236:239], v[88:91]
    s_waitcnt vmcnt(10)
    v_mfma_f32_16x16x32_bf16 v[92:95], a[20:23], v[240:243], v[92:95]
    buffer_load_dword v20, v13, s[20:23], s93 offen sc1
    v_mfma_f32_16x16x32_bf16 v[96:99], a[24:27], v[240:243], v[96:99]
    v_mfma_f32_16x16x32_bf16 v[100:103], a[28:31], v[240:243], v[100:103]
    v_mfma_f32_16x16x32_bf16 v[104:107], a[32:35], v[240:243], v[104:107]
    v_mfma_f32_16x16x32_bf16 v[108:111], a[36:39], v[240:243], v[108:111]
    s_waitcnt vmcnt(10)
    v_mfma_f32_16x16x32_bf16 v[32:35], a[40:43], v[196:199], v[32:35]
    buffer_load_dword v22, v13, s[20:23], s94 offen sc1
    v_mfma_f32_16x16x32_bf16 v[36:39], a[44:47], v[196:199], v[36:39]
    v_mfma_f32_16x16x32_bf16 v[40:43], a[48:51], v[196:199], v[40:43]
    buffer_load_dword v24, v13, s[20:23], s95 offen sc1
    v_mfma_f32_16x16x32_bf16 v[44:47], a[52:55], v[196:199], v[44:47]
    v_mfma_f32_16x16x32_bf16 v[48:51], a[56:59], v[196:199], v[48:51]
    s_waitcnt vmcnt(10)
    v_mfma_f32_16x16x32_bf16 v[52:55], a[40:43], v[200:203], v[52:55]
    buffer_load_dwordx4 v[220:223], v4, s[20:23], s67 offen offset:1024 sc1
    v_mfma_f32_16x16x32_bf16 v[56:59], a[44:47], v[200:203], v[56:59]
    v_mfma_f32_16x16x32_bf16 v[60:63], a[48:51], v[200:203], v[60:63]
    v_mfma_f32_16x16x32_bf16 v[64:67], a[52:55], v[200:203], v[64:67]
    v_mfma_f32_16x16x32_bf16 v[68:71], a[56:59], v[200:203], v[68:71]
    s_waitcnt vmcnt(10)
    v_mfma_f32_16x16x32_bf16 v[72:75], a[40:43], v[204:207], v[72:75]
    buffer_load_dwordx4 v[224:227], v5, s[20:23], s67 offen offset:1024 sc1
    v_mfma_f32_16x16x32_bf16 v[76:79], a[44:47], v[204:207], v[76:79]
    v_mfma_f32_16x16x32_bf16 v[80:83], a[48:51], v[204:207], v[80:83]
    v_mfma_f32_16x16x32_bf16 v[84:87], a[52:55], v[204:207], v[84:87]
    v_mfma_f32_16x16x32_bf16 v[88:91], a[56:59], v[204:207], v[88:91]
    s_waitcnt vmcnt(10)
    v_mfma_f32_16x16x32_bf16 v[92:95], a[40:43], v[208:211], v[92:95]
    buffer_load_dwordx4 v[228:231], v2, s[20:23], s68 offen offset:0 sc1
    v_mfma_f32_16x16x32_bf16 v[96:99], a[44:47], v[208:211], v[96:99]
    v_mfma_f32_16x16x32_bf16 v[100:103], a[48:51], v[208:211], v[100:103]
    buffer_load_dwordx4 v[232:235], v3, s[20:23], s68 offen offset:0 sc1
    v_mfma_f32_16x16x32_bf16 v[104:107], a[52:55], v[208:211], v[104:107]
    v_mfma_f32_16x16x32_bf16 v[108:111], a[56:59], v[208:211], v[108:111]
    s_waitcnt vmcnt(10)
    v_mfma_f32_16x16x32_bf16 v[32:35], a[60:63], v[212:215], v[32:35]
    buffer_load_dwordx4 v[236:239], v4, s[20:23], s68 offen offset:0 sc1
    v_mfma_f32_16x16x32_bf16 v[36:39], a[64:67], v[212:215], v[36:39]
    v_mfma_f32_16x16x32_bf16 v[40:43], a[68:71], v[212:215], v[40:43]
    v_mfma_f32_16x16x32_bf16 v[44:47], a[72:75], v[212:215], v[44:47]
    v_mfma_f32_16x16x32_bf16 v[48:51], a[76:79], v[212:215], v[48:51]
    s_waitcnt vmcnt(10)
    v_mfma_f32_16x16x32_bf16 v[52:55], a[60:63], v[216:219], v[52:55]
    buffer_load_dwordx4 v[240:243], v5, s[20:23], s68 offen offset:0 sc1
    v_mfma_f32_16x16x32_bf16 v[56:59], a[64:67], v[216:219], v[56:59]
    v_mfma_f32_16x16x32_bf16 v[60:63], a[68:71], v[216:219], v[60:63]
    buffer_load_dwordx4 v[196:199], v2, s[20:23], s68 offen offset:1024 sc1
    v_mfma_f32_16x16x32_bf16 v[64:67], a[72:75], v[216:219], v[64:67]
    v_mfma_f32_16x16x32_bf16 v[68:71], a[76:79], v[216:219], v[68:71]
    buffer_load_dwordx4 v[200:203], v3, s[20:23], s68 offen offset:1024 sc1
    s_waitcnt vmcnt(7)
    s_mov_b64 exec, 0xff
    s_mov_b32 s96, 0
    s_branch LK_fc_38
LK_fl_37:
    buffer_load_dword v15, v11, s[20:23], 0 offen sc1
    s_add_u32 s96, s96, 1
    s_waitcnt vmcnt(0)
LK_fc_38:
    v_cmp_ne_u32 vcc, s6, v15
    s_cmp_gt_u32 s96, 0x20000
    s_cbranch_scc1 LK_fe_39
    s_cbranch_vccnz LK_fl_37
LK_fe_39:
    s_mov_b64 exec, -1
    v_mfma_f32_16x16x32_bf16 v[72:75], a[60:63], v[220:223], v[72:75]
    buffer_load_dwordx4 v[204:207], v4, s[20:23], s68 offen offset:1024 sc1
    v_mfma_f32_16x16x32_bf16 v[76:79], a[64:67], v[220:223], v[76:79]
    v_mfma_f32_16x16x32_bf16 v[80:83], a[68:71], v[220:223], v[80:83]
    buffer_load_dwordx4 v[208:211], v5, s[20:23], s68 offen offset:1024 sc1
    v_mfma_f32_16x16x32_bf16 v[84:87], a[72:75], v[220:223], v[84:87]
    v_mfma_f32_16x16x32_bf16 v[88:91], a[76:79], v[220:223], v[88:91]
    buffer_load_dwordx4 v[212:215], v2, s[20:23], s69 offen sc1
    s_waitcnt vmcnt(9)
    v_mfma_f32_16x16x32_bf16 v[92:95], a[60:63], v[224:227], v[92:95]
    buffer_load_dwordx4 v[216:219], v2, s[20:23], s70 offen sc1
    v_mfma_f32_16x16x32_bf16 v[96:99], a[64:67], v[224:227], v[96:99]
    v_mfma_f32_16x16x32_bf16 v[100:103], a[68:71], v[224:227], v[100:103]
    buffer_load_dwordx4 v[220:223], v2, s[20:23], s71 offen sc1
    v_mfma_f32_16x16x32_bf16 v[104:107], a[72:75], v[224:227], v[104:107]
    v_mfma_f32_16x16x32_bf16 v[108:111], a[76:79], v[224:227], v[108:111]
    s_waitcnt vmcnt(10)
    v_mfma_f32_16x16x32_bf16 v[32:35], a[136:139], v[228:231], v[32:35]
    buffer_load_dwordx4 v[224:227], v2, s[20:23], s72 offen sc1
    v_mfma_f32_16x16x32_bf16 v[36:39], a[140:143], v[228:231], v[36:39]
    v_mfma_f32_16x16x32_bf16 v[40:43], a[144:147], v[228:231], v[40:43]
    v_mfma_f32_16x16x32_bf16 v[44:47], a[148:151], v[228:231], v[44:47]
    v_mfma_f32_16x16x32_bf16 v[48:51], a[152:155], v[228:231], v[48:51]
    s_waitcnt vmcnt(10)
    v_mfma_f32_16x16x32_bf16 v[52:55], a[136:139], v[232:235], v[52:55]
    buffer_load_dwordx4 v[228:231], v2, s[20:23], s73 offen sc1
    v_mfma_f32_16x16x32_bf16 v[56:59], a[140:143], v[232:235], v[56:59]
    v_mfma_f32_16x16x32_bf16 v[60:63], a[144:147], v[232:235], v[60:63]
    v_mfma_f32_16x16x32_bf16 v[64:67], a[148:151], v[232:235], v[64:67]
    v_mfma_f32_16x16x32_bf16 v[68:71], a[152:155], v[232:235], v[68:71]
    s_waitcnt vmcnt(10)
    v_mfma_f32_16x16x32_bf16 v[72:75], a[136:139], v[236:239], v[72:75]
    buffer_load_dwordx4 v[232:235], v3, s[20:23], s69 offen sc1
    v_mfma_f32_16x16x32_bf16 v[76:79], a[140:143], v[236:239], v[76:79]
    v_mfma_f32_16x16x32_bf16 v[80:83], a[144:147], v[236:239], v[80:83]
    v_mfma_f32_16x16x32_bf16 v[84:87], a[148:151], v[236:239], v[84:87]
    v_mfma_f32_16x16x32_bf16 v[88:91], a[152:155], v[236:239], v[88:91]
    s_waitcnt vmcnt(10)
    v_mfma_f32_16x16x32_bf16 v[92:95], a[136:139], v[240:243], v[92:95]
    buffer_load_dwordx4 v[236:239], v3, s[20:23], s70 offen sc1
    v_mfma_f32_16x16x32_bf16 v[96:99], a[140:143], v[240:243], v[96:99]
    v_mfma_f32_16x16x32_bf16 v[100:103], a[144:147], v[240:243], v[100:103]
    v_mfma_f32_16x16x32_bf16 v[104:107], a[148:151], v[240:243], v[104:107]
    v_mfma_f32_16x16x32_bf16 v[108:111], a[152:155], v[240:243], v[108:111]
    s_waitcnt vmcnt(10)
    v_mfma_f32_16x16x32_bf16 v[32:35], a[156:159], v[196:199], v[32:35]
    buffer_load_dwordx4 v[240:243], v3, s[20:23], s71 offen sc1
    v_mfma_f32_16x16x32_bf16 v[36:39], a[240:243], v[196:199], v[36:39]
    v_mfma_f32_16x16x32_bf16 v[40:43], a[244:247], v[196:199], v[40:43]
    v_mfma_f32_16x16x32_bf16 v[44:47], a[248:251], v[196:199], v[44:47]
    v_mfma_f32_16x16x32_bf16 v[48:51], a[252:255], v[196:199], v[48:51]
    s_waitcnt vmcnt(10)
    s_and_b32 s7, s6, 0xff
    s_mov_b32 s96, 0
    v_xor_b32 v18, s7, v18
    v_xor_b32 v20, s7, v20
    v_xor_b32 v22, s7, v22
    v_xor_b32 v24, s7, v24
    v_or3_b32 v15, v18, v20, v22
    v_or_b32 v15, v15, v24
    v_and_b32 v15, 0xffff, v15
    v_cmp_ne_u32 vcc, 0, v15
    s_add_u32 s96, s96, 1
    s_cbranch_vccnz LK_rg
LK_gok:
    v_mfma_f32_16x16x32_bf16 v[52:55], a[156:159], v[200:203], v[52:55]
    v_mfma_f32_16x16x32_bf16 v[56:59], a[240:243], v[200:203], v[56:59]
    v_mul_f32 v32, v18, v32
    v_mul_f32 v33, v18, v33
    v_mfma_f32_16x16x32_bf16 v[60:63], a[244:247], v[200:203], v[60:63]
    v_mul_f32 v34, v18, v34
    v_mul_f32 v35, v18, v35
    v_mfma_f32_16x16x32_bf16 v[64:67], a[248:251], v[200:203], v[64:67]
    v_mul_f32 v36, v18, v36
    v_mul_f32 v37, v18, v37
    v_mfma_f32_16x16x32_bf16 v[68:71], a[252:255], v[200:203], v[68:71]
    v_mul_f32 v38, v18, v38
    v_mul_f32 v39, v18, v39
    buffer_load_dwordx4 v[196:199], v3, s[20:23], s72 offen sc1
    s_waitcnt vmcnt(10)
    v_mfma_f32_16x16x32_bf16 v[72:75], a[156:159], v[204:207], v[72:75]
    v_mfma_f32_16x16x32_bf16 v[76:79], a[240:243], v[204:207], v[76:79]
    v_mul_f32 v40, v18, v40
    v_mul_f32 v41, v18, v41
    v_mfma_f32_16x16x32_bf16 v[80:83], a[244:247], v[204:207], v[80:83]
    v_mul_f32 v42, v18, v42
    v_mul_f32 v43, v18, v43
    v_mfma_f32_16x16x32_bf16 v[84:87], a[248:251], v[204:207], v[84:87]
    v_mul_f32 v44, v18, v44
    v_mul_f32 v45, v18, v45
    v_mfma_f32_16x16x32_bf16 v[88:91], a[252:255], v[204:207], v[88:91]
    v_mul_f32 v46, v18, v46
    v_mul_f32 v47, v18, v47
    buffer_load_dwordx4 v[200:203], v3, s[20:23], s73 offen sc1
    s_waitcnt vmcnt(10)
    v_mfma_f32_16x16x32_bf16 v[92:95], a[156:159], v[208:211], v[92:95]
    v_mul_f32 v48, v18, v48
    v_mul_f32 v49, v18, v49
    v_mfma_f32_16x16x32_bf16 v[96:99], a[240:243], v[208:211], v[96:99]
    v_mul_f32 v50, v18, v50
    v_mul_f32 v51, v18, v51
    v_mfma_f32_16x16x32_bf16 v[100:103], a[244:247], v[208:211], v[100:103]
    v_mul_f32 v52, v20, v52
    v_mul_f32 v53, v20, v53
    v_mfma_f32_16x16x32_bf16 v[104:107], a[248:251], v[208:211], v[104:107]
    v_mul_f32 v54, v20, v54
    v_mul_f32 v55, v20, v55
    v_mfma_f32_16x16x32_bf16 v[108:111], a[252:255], v[208:211], v[108:111]
    buffer_load_dwordx4 v[204:207], v4, s[20:23], s69 offen sc1
    s_waitcnt vmcnt(10)
    v_mfma_f32_16x16x32_bf16 v[32:35], a[80:83], v[212:215], v[32:35]
    v_mul_f32 v56, v20, v56
    v_mul_f32 v57, v20, v57
    v_mfma_f32_16x16x32_bf16 v[36:39], a[84:87], v[212:215], v[36:39]
    v_mul_f32 v58, v20, v58
    v_mul_f32 v59, v20, v59
    v_mfma_f32_16x16x32_bf16 v[40:43], a[88:91], v[212:215], v[40:43]
    v_mul_f32 v60, v20, v60
    v_mul_f32 v61, v20, v61
    v_mfma_f32_16x16x32_bf16 v[44:47], a[92:95], v[212:215], v[44:47]
    v_mul_f32 v62, v20, v62
    v_mul_f32 v63, v20, v63
    v_mfma_f32_16x16x32_bf16 v[48:51], a[96:99], v[212:215], v[48:51]
    buffer_load_dwordx4 v[208:211], v4, s[20:23], s70 offen sc1
    s_waitcnt vmcnt(10)
    v_mfma_f32_16x16x32_bf16 v[32:35], a[100:103], v[216:219], v[32:35]
    v_mul_f32 v64, v20, v64
    v_mul_f32 v65, v20, v65
    v_mfma_f32_16x16x32_bf16 v[36:39], a[104:107], v[216:219], v[36:39]
    v_mul_f32 v66, v20, v66
    v_mul_f32 v67, v20, v67
    v_mfma_f32_16x16x32_bf16 v[40:43], a[108:111], v[216:219], v[40:43]
    v_mul_f32 v68, v20, v68
    v_mul_f32 v69, v20, v69
    v_mfma_f32_16x16x32_bf16 v[44:47], a[112:115], v[216:219], v[44:47]
    v_mul_f32 v70, v20, v70
    v_mul_f32 v71, v20, v71
    v_mfma_f32_16x16x32_bf16 v[48:51], a[116:119], v[216:219], v[48:51]
    buffer_load_dwordx4 v[212:215], v4, s[20:23], s71 offen sc1
    s_waitcnt vmcnt(10)
    v_mfma_f32_16x16x32_bf16 v[32:35], a[120:123], v[220:223], v[32:35]
    v_mul_f32 v72, v22, v72
    v_mul_f32 v73, v22, v73
    v_mfma_f32_16x16x32_bf16 v[36:39], a[124:127], v[220:223], v[36:39]
    v_mul_f32 v74, v22, v74
    v_mul_f32 v75, v22, v75
    v_mfma_f32_16x16x32_bf16 v[40:43], a[128:131], v[220:223], v[40:43]
    v_mul_f32 v76, v22, v76
    v_mul_f32 v77, v22, v77
    v_mfma_f32_16x16x32_bf16 v[44:47], a[132:135], v[220:223], v[44:47]
    v_mul_f32 v78, v22, v78
    v_mul_f32 v79, v22, v79
    v_mfma_f32_16x16x32_bf16 v[48:51], v[152:155], v[220:223], v[48:51]
    buffer_load_dwordx4 v[216:219], v4, s[20:23], s72 offen sc1
    s_waitcnt vmcnt(10)
    v_mfma_f32_16x16x32_bf16 v[32:35], v[156:159], v[224:227], v[32:35]
    v_mul_f32 v80, v22, v80
    v_mul_f32 v81, v22, v81
    v_mfma_f32_16x16x32_bf16 v[36:39], v[160:163], v[224:227], v[36:39]
    v_mul_f32 v82, v22, v82
    v_mul_f32 v83, v22, v83
    v_mfma_f32_16x16x32_bf16 v[40:43], v[164:167], v[224:227], v[40:43]
    v_mul_f32 v84, v22, v84
    v_mul_f32 v85, v22, v85
    v_mfma_f32_16x16x32_bf16 v[44:47], v[168:171], v[224:227], v[44:47]
    v_mul_f32 v86, v22, v86
    v_mul_f32 v87, v22, v87
    v_mfma_f32_16x16x32_bf16 v[48:51], v[172:175], v[224:227], v[48:51]
    buffer_load_dwordx4 v[220:223], v4, s[20:23], s73 offen sc1
    s_waitcnt vmcnt(10)
    v_mfma_f32_16x16x32_bf16 v[32:35], v[176:179], v[228:231], v[32:35]
    v_mul_f32 v88, v22, v88
    v_mul_f32 v89, v22, v89
    v_mfma_f32_16x16x32_bf16 v[36:39], v[180:183], v[228:231], v[36:39]
    v_mul_f32 v90, v22, v90
    v_mul_f32 v91, v22, v91
    v_mfma_f32_16x16x32_bf16 v[40:43], v[184:187], v[228:231], v[40:43]
    v_mul_f32 v92, v24, v92
    v_mul_f32 v93, v24, v93
    v_mfma_f32_16x16x32_bf16 v[44:47], v[188:191], v[228:231], v[44:47]
    v_mul_f32 v94, v24, v94
    v_mul_f32 v95, v24, v95
    v_mfma_f32_16x16x32_bf16 v[48:51], v[192:195], v[228:231], v[48:51]
    buffer_load_dwordx4 v[224:227], v5, s[20:23], s69 offen sc1
    s_waitcnt vmcnt(10)
    v_mfma_f32_16x16x32_bf16 v[52:55], a[80:83], v[232:235], v[52:55]
    v_mul_f32 v110, v24, v110
    v_mul_f32 v111, v24, v111
    v_mfma_f32_16x16x32_bf16 v[56:59], a[84:87], v[232:235], v[56:59]
    ds_write_b128 v14, v[32:35] offset:0
    v_mfma_f32_16x16x32_bf16 v[60:63], a[88:91], v[232:235], v[60:63]
    v_mfma_f32_16x16x32_bf16 v[64:67], a[92:95], v[232:235], v[64:67]
    v_mfma_f32_16x16x32_bf16 v[68:71], a[96:99], v[232:235], v[68:71]
    ds_write_b128 v14, v[36:39] offset:64
    buffer_load_dwordx4 v[228:231], v5, s[20:23], s70 offen sc1
    s_waitcnt vmcnt(10)
    v_mfma_f32_16x16x32_bf16 v[52:55], a[100:103], v[236:239], v[52:55]
    v_mul_f32 v96, v24, v96
    v_mul_f32 v97, v24, v97
    v_mfma_f32_16x16x32_bf16 v[56:59], a[104:107], v[236:239], v[56:59]
    v_mul_f32 v98, v24, v98
    v_mul_f32 v99, v24, v99
    v_mfma_f32_16x16x32_bf16 v[60:63], a[108:111], v[236:239], v[60:63]
    ds_write_b128 v14, v[40:43] offset:128
    v_mfma_f32_16x16x32_bf16 v[64:67], a[112:115], v[236:239], v[64:67]
    v_mul_f32 v100, v24, v100
    v_mul_f32 v101, v24, v101
    v_mfma_f32_16x16x32_bf16 v[68:71], a[116:119], v[236:239], v[68:71]
    v_mul_f32 v102, v24, v102
    v_mul_f32 v103, v24, v103
    buffer_load_dwordx4 v[232:235], v5, s[20:23], s71 offen sc1
    s_waitcnt vmcnt(10)
    v_mfma_f32_16x16x32_bf16 v[52:55], a[120:123], v[240:243], v[52:55]
    ds_write_b128 v14, v[44:47] offset:192
    v_mfma_f32_16x16x32_bf16 v[56:59], a[124:127], v[240:243], v[56:59]
    v_mul_f32 v104, v24, v104
    v_mul_f32 v105, v24, v105
    v_mfma_f32_16x16x32_bf16 v[60:63], a[128:131], v[240:243], v[60:63]
    v_mul_f32 v106, v24, v106
    v_mul_f32 v107, v24, v107
    v_mfma_f32_16x16x32_bf16 v[64:67], a[132:135], v[240:243], v[64:67]
    ds_write_b128 v14, v[48:51] offset:256
    v_mfma_f32_16x16x32_bf16 v[68:71], v[152:155], v[240:243], v[68:71]
    v_mul_f32 v108, v24, v108
    v_mul_f32 v109, v24, v109
    buffer_load_dwordx4 v[236:239], v5, s[20:23], s72 offen sc1
    s_waitcnt vmcnt(10)
    v_mfma_f32_16x16x32_bf16 v[52:55], v[156:159], v[196:199], v[52:55]
    v_mfma_f32_16x16x32_bf16 v[56:59], v[160:163], v[196:199], v[56:59]
    v_mfma_f32_16x16x32_bf16 v[60:63], v[164:167], v[196:199], v[60:63]
    v_mfma_f32_16x16x32_bf16 v[64:67], v[168:171], v[196:199], v[64:67]
    v_mfma_f32_16x16x32_bf16 v[68:71], v[172:175], v[196:199], v[68:71]
    buffer_load_dwordx4 v[240:243], v5, s[20:23], s73 offen sc1
    s_waitcnt vmcnt(10)
    v_mfma_f32_16x16x32_bf16 v[52:55], v[176:179], v[200:203], v[52:55]
    s_waitcnt lgkmcnt(0)
    s_barrier
    ds_read_b128 v[112:115], v246 offset:0
    v_mfma_f32_16x16x32_bf16 v[56:59], v[180:183], v[200:203], v[56:59]
    ds_read_b128 v[116:119], v246 offset:20480
    v_mfma_f32_16x16x32_bf16 v[60:63], v[184:187], v[200:203], v[60:63]
    ds_read_b128 v[120:123], v246 offset:40960
    v_mfma_f32_16x16x32_bf16 v[64:67], v[188:191], v[200:203], v[64:67]
    ds_read_b128 v[124:127], v6 offset:46080
    v_mfma_f32_16x16x32_bf16 v[68:71], v[192:195], v[200:203], v[68:71]
    s_waitcnt vmcnt(9)
    v_mfma_f32_16x16x32_bf16 v[72:75], a[80:83], v[204:207], v[72:75]
    v_mfma_f32_16x16x32_bf16 v[76:79], a[84:87], v[204:207], v[76:79]
    ds_write_b128 v14, v[52:55] offset:5120
    v_mfma_f32_16x16x32_bf16 v[80:83], a[88:91], v[204:207], v[80:83]
    v_mfma_f32_16x16x32_bf16 v[84:87], a[92:95], v[204:207], v[84:87]
    v_mfma_f32_16x16x32_bf16 v[88:91], a[96:99], v[204:207], v[88:91]
    ds_write_b128 v14, v[56:59] offset:5184
    s_waitcnt vmcnt(8)
    v_mfma_f32_16x16x32_bf16 v[72:75], a[100:103], v[208:211], v[72:75]
    s_waitcnt lgkmcnt(2)
    v_add_f32 v112, v112, v116
    v_add_f32 v113, v113, v117
    v_mfma_f32_16x16x32_bf16 v[76:79], a[104:107], v[208:211], v[76:79]
    v_add_f32 v114, v114, v118
    v_add_f32 v115, v115, v119
    v_mfma_f32_16x16x32_bf16 v[80:83], a[108:111], v[208:211], v[80:83]
    ds_write_b128 v14, v[60:63] offset:5248
    v_mfma_f32_16x16x32_bf16 v[84:87], a[112:115], v[208:211], v[84:87]
    v_add_f32 v120, v120, v124
    v_add_f32 v121, v121, v125
    v_mfma_f32_16x16x32_bf16 v[88:91], a[116:119], v[208:211], v[88:91]
    v_add_f32 v122, v122, v126
    v_add_f32 v123, v123, v127
    s_waitcnt vmcnt(7)
    v_mfma_f32_16x16x32_bf16 v[72:75], a[120:123], v[212:215], v[72:75]
    ds_write_b128 v14, v[64:67] offset:5312
    v_mfma_f32_16x16x32_bf16 v[76:79], a[124:127], v[212:215], v[76:79]
    v_add_f32 v112, v112, v120
    v_add_f32 v113, v113, v121
    v_mfma_f32_16x16x32_bf16 v[80:83], a[128:131], v[212:215], v[80:83]
    v_add_f32 v114, v114, v122
    v_add_f32 v115, v115, v123
    v_mfma_f32_16x16x32_bf16 v[84:87], a[132:135], v[212:215], v[84:87]
    ds_write_b128 v14, v[68:71] offset:5376
    v_mfma_f32_16x16x32_bf16 v[88:91], v[152:155], v[212:215], v[88:91]
    buffer_store_dwordx4 v[112:115], v244, s[24:27], s79 offen sc1
    s_waitcnt vmcnt(7)
    v_mfma_f32_16x16x32_bf16 v[72:75], v[156:159], v[216:219], v[72:75]
    v_mfma_f32_16x16x32_bf16 v[76:79], v[160:163], v[216:219], v[76:79]
    v_mfma_f32_16x16x32_bf16 v[80:83], v[164:167], v[216:219], v[80:83]
    v_mfma_f32_16x16x32_bf16 v[84:87], v[168:171], v[216:219], v[84:87]
    v_mfma_f32_16x16x32_bf16 v[88:91], v[172:175], v[216:219], v[88:91]
    s_waitcnt vmcnt(6)
    v_mfma_f32_16x16x32_bf16 v[72:75], v[176:179], v[220:223], v[72:75]
    s_waitcnt lgkmcnt(0)
    s_barrier
    ds_read_b128 v[112:115], v246 offset:5120
    v_mfma_f32_16x16x32_bf16 v[76:79], v[180:183], v[220:223], v[76:79]
    ds_read_b128 v[116:119], v246 offset:25600
    v_mfma_f32_16x16x32_bf16 v[80:83], v[184:187], v[220:223], v[80:83]
    ds_read_b128 v[120:123], v246 offset:46080
    v_mfma_f32_16x16x32_bf16 v[84:87], v[188:191], v[220:223], v[84:87]
    ds_read_b128 v[124:127], v6 offset:51200
    v_mfma_f32_16x16x32_bf16 v[88:91], v[192:195], v[220:223], v[88:91]
    s_waitcnt vmcnt(5)
    v_mfma_f32_16x16x32_bf16 v[92:95], a[80:83], v[224:227], v[92:95]
    v_mfma_f32_16x16x32_bf16 v[96:99], a[84:87], v[224:227], v[96:99]
    ds_write_b128 v14, v[72:75] offset:10240
    v_mfma_f32_16x16x32_bf16 v[100:103], a[88:91], v[224:227], v[100:103]
    v_mfma_f32_16x16x32_bf16 v[104:107], a[92:95], v[224:227], v[104:107]
    v_mfma_f32_16x16x32_bf16 v[108:111], a[96:99], v[224:227], v[108:111]
    ds_write_b128 v14, v[76:79] offset:10304
    s_waitcnt vmcnt(4)
    v_mfma_f32_16x16x32_bf16 v[92:95], a[100:103], v[228:231], v[92:95]
    s_waitcnt lgkmcnt(2)
    v_add_f32 v112, v112, v116
    v_add_f32 v113, v113, v117
    v_mfma_f32_16x16x32_bf16 v[96:99], a[104:107], v[228:231], v[96:99]
    v_add_f32 v114, v114, v118
    v_add_f32 v115, v115, v119
    v_mfma_f32_16x16x32_bf16 v[100:103], a[108:111], v[228:231], v[100:103]
    ds_write_b128 v14, v[80:83] offset:10368
    v_mfma_f32_16x16x32_bf16 v[104:107], a[112:115], v[228:231], v[104:107]
    v_add_f32 v120, v120, v124
    v_add_f32 v121, v121, v125
    v_mfma_f32_16x16x32_bf16 v[108:111], a[116:119], v[228:231], v[108:111]
    v_add_f32 v122, v122, v126
    v_add_f32 v123, v123, v127
    s_waitcnt vmcnt(3)
    v_mfma_f32_16x16x32_bf16 v[92:95], a[120:123], v[232:235], v[92:95]
    ds_write_b128 v14, v[84:87] offset:10432
    v_mfma_f32_16x16x32_bf16 v[96:99], a[124:127], v[232:235], v[96:99]
    v_add_f32 v112, v112, v120
    v_add_f32 v113, v113, v121
    v_mfma_f32_16x16x32_bf16 v[100:103], a[128:131], v[232:235], v[100:103]
    v_add_f32 v114, v114, v122
    v_add_f32 v115, v115, v123
    v_mfma_f32_16x16x32_bf16 v[104:107], a[132:135], v[232:235], v[104:107]
    ds_write_b128 v14, v[88:91] offset:10496
    v_mfma_f32_16x16x32_bf16 v[108:111], v[152:155], v[232:235], v[108:111]
    buffer_store_dwordx4 v[112:115], v244, s[24:27], s80 offen sc1
    s_waitcnt vmcnt(3)
    v_mfma_f32_16x16x32_bf16 v[92:95], v[156:159], v[236:239], v[92:95]
    v_mfma_f32_16x16x32_bf16 v[96:99], v[160:163], v[236:239], v[96:99]
    v_mfma_f32_16x16x32_bf16 v[100:103], v[164:167], v[236:239], v[100:103]
    v_mfma_f32_16x16x32_bf16 v[104:107], v[168:171], v[236:239], v[104:107]
    v_mfma_f32_16x16x32_bf16 v[108:111], v[172:175], v[236:239], v[108:111]
    s_waitcnt vmcnt(2)
    v_mfma_f32_16x16x32_bf16 v[92:95], v[176:179], v[240:243], v[92:95]
    s_waitcnt lgkmcnt(0)
    s_barrier
    ds_read_b128 v[112:115], v246 offset:10240
    v_mfma_f32_16x16x32_bf16 v[96:99], v[180:183], v[240:243], v[96:99]
    ds_read_b128 v[116:119], v246 offset:30720
    v_mfma_f32_16x16x32_bf16 v[100:103], v[184:187], v[240:243], v[100:103]
    ds_read_b128 v[120:123], v246 offset:51200
    v_mfma_f32_16x16x32_bf16 v[104:107], v[188:191], v[240:243], v[104:107]
    ds_read_b128 v[124:127], v6 offset:56320
    v_mfma_f32_16x16x32_bf16 v[108:111], v[192:195], v[240:243], v[108:111]
    ds_write_b128 v14, v[92:95] offset:15360
    s_nop 0
    ds_write_b128 v14, v[96:99] offset:15424
    s_waitcnt lgkmcnt(2)
    v_add_f32 v112, v112, v116
    v_add_f32 v113, v113, v117
    ds_write_b128 v14, v[100:103] offset:15488
    v_add_f32 v114, v114, v118
    v_add_f32 v115, v115, v119
    v_add_f32 v120, v120, v124
    v_add_f32 v121, v121, v125
    ds_write_b128 v14, v[104:107] offset:15552
    v_add_f32 v122, v122, v126
    v_add_f32 v123, v123, v127
    v_add_f32 v112, v112, v120
    v_add_f32 v113, v113, v121
    ds_write_b128 v14, v[108:111] offset:15616
    v_add_f32 v114, v114, v122
    v_add_f32 v115, v115, v123
    buffer_store_dwordx4 v[112:115], v244, s[24:27], s81 offen sc1
    s_cmp_lg_u32 s28, 31
    s_cbranch_scc1 LK_ne
    s_or_b32 s92, s3, s29
    s_cmp_lg_u32 s92, 0
    s_cbranch_scc1 LK_ne
    v_mov_b32 v196, 11272192
    v_mov_b32 v197, s6
    s_mov_b64 exec, 1
    buffer_store_dword v197, v196, s[20:23], 0 offen sc1
    s_mov_b64 exec, -1
LK_ne:
    s_waitcnt lgkmcnt(0)
    s_barrier
    ds_read_b128 v[32:35], v246 offset:15360
    ds_read_b128 v[36:39], v246 offset:35840
    ds_read_b128 v[40:43], v246 offset:56320
    ds_read_b128 v[44:47], v6 offset:61440
    ds_read_b128 v[48:51], v247 offset:0
    ds_read_b128 v[52:55], v247 offset:20480
    ds_read_b128 v[56:59], v247 offset:40960
    ds_read_b128 v[60:63], v247 offset:61440
    s_waitcnt lgkmcnt(4)
    v_pk_add_f32 v[32:33], v[32:33], v[36:37]
    v_pk_add_f32 v[34:35], v[34:35], v[38:39]
    v_pk_add_f32 v[40:41], v[40:41], v[44:45]
    v_pk_add_f32 v[42:43], v[42:43], v[46:47]
    v_pk_add_f32 v[32:33], v[32:33], v[40:41]
    v_pk_add_f32 v[34:35], v[34:35], v[42:43]
    buffer_store_dwordx4 v[32:35], v244, s[24:27], s82 offen sc1
    s_waitcnt lgkmcnt(0)
    v_pk_add_f32 v[48:49], v[48:49], v[52:53]
    v_pk_add_f32 v[50:51], v[50:51], v[54:55]
    v_pk_add_f32 v[56:57], v[56:57], v[60:61]
    v_pk_add_f32 v[58:59], v[58:59], v[62:63]
    v_pk_add_f32 v[48:49], v[48:49], v[56:57]
    v_pk_add_f32 v[50:51], v[50:51], v[58:59]
    buffer_store_dwordx4 v[48:51], v245, s[24:27], s38 offen sc1
Lend:
    s_endpgm
LB_rs:
    buffer_load_dwordx2 v[244:245], v4, s[36:39], s46 offen offset:1280 sc1
    buffer_load_dwordx2 v[242:243], v4, s[36:39], s46 offen offset:640 sc1
    buffer_load_dwordx2 v[240:241], v4, s[36:39], s46 offen offset:0 sc1
    buffer_load_dwordx2 v[238:239], v4, s[36:39], s41 offen offset:3200 sc1
    buffer_load_dwordx2 v[236:237], v4, s[36:39], s41 offen offset:2560 sc1
    buffer_load_dwordx2 v[234:235], v4, s[36:39], s41 offen offset:1920 sc1
    buffer_load_dwordx2 v[232:233], v4, s[36:39], s41 offen offset:1280 sc1
    buffer_load_dwordx2 v[230:231], v4, s[36:39], s41 offen offset:640 sc1
    buffer_load_dwordx2 v[228:229], v4, s[36:39], s41 offen offset:0 sc1
    buffer_load_dwordx2 v[226:227], v4, s[36:39], 0 offen offset:3200 sc1
    buffer_load_dwordx2 v[224:225], v4, s[36:39], 0 offen offset:2560 sc1
    buffer_load_dwordx2 v[222:223], v4, s[36:39], 0 offen offset:1920 sc1
    buffer_load_dwordx2 v[220:221], v4, s[36:39], 0 offen offset:1280 sc1
    buffer_load_dwordx2 v[218:219], v4, s[36:39], 0 offen offset:640 sc1
    buffer_load_dwordx2 v[216:217], v4, s[36:39], 0 offen offset:0 sc1
    s_waitcnt vmcnt(0)
LB_rsc:
    v_xor_b32 v244, s47, v244
    v_xor_b32 v245, s47, v245
    v_or_b32 v250, v244, v245
    v_xor_b32 v242, s47, v242
    v_xor_b32 v243, s47, v243
    v_or3_b32 v250, v250, v242, v243
    v_pk_fma_f32 v[242:243], v[244:245], v[248:249], v[242:243] op_sel_hi:[1,0,1]
    v_pk_fma_f32 v[242:243], v[244:245], v[248:249], v[242:243] op_sel:[1,1,0] op_sel_hi:[0,1,1] neg_lo:[0,1,0]
    v_xor_b32 v240, s47, v240
    v_xor_b32 v241, s47, v241
    v_or3_b32 v250, v250, v240, v241
    v_pk_fma_f32 v[240:241], v[242:243], v[248:249], v[240:241] op_sel_hi:[1,0,1]
    v_pk_fma_f32 v[240:241], v[242:243], v[248:249], v[240:241] op_sel:[1,1,0] op_sel_hi:[0,1,1] neg_lo:[0,1,0]
    v_xor_b32 v238, s47, v238
    v_xor_b32 v239, s47, v239
    v_or3_b32 v250, v250, v238, v239
    v_pk_fma_f32 v[238:239], v[240:241], v[248:249], v[238:239] op_sel_hi:[1,0,1]
    v_pk_fma_f32 v[238:239], v[240:241], v[248:249], v[238:239] op_sel:[1,1,0] op_sel_hi:[0,1,1] neg_lo:[0,1,0]
    v_xor_b32 v236, s47, v236
    v_xor_b32 v237, s47, v237
    v_or3_b32 v250, v250, v236, v237
    v_pk_fma_f32 v[236:237], v[238:239], v[248:249], v[236:237] op_sel_hi:[1,0,1]
    v_pk_fma_f32 v[236:237], v[238:239], v[248:249], v[236:237] op_sel:[1,1,0] op_sel_hi:[0,1,1] neg_lo:[0,1,0]
    v_xor_b32 v234, s47, v234
    v_xor_b32 v235, s47, v235
    v_or3_b32 v250, v250, v234, v235
    v_pk_fma_f32 v[234:235], v[236:237], v[248:249], v[234:235] op_sel_hi:[1,0,1]
    v_pk_fma_f32 v[234:235], v[236:237], v[248:249], v[234:235] op_sel:[1,1,0] op_sel_hi:[0,1,1] neg_lo:[0,1,0]
    v_xor_b32 v232, s47, v232
    v_xor_b32 v233, s47, v233
    v_or3_b32 v250, v250, v232, v233
    v_pk_fma_f32 v[232:233], v[234:235], v[248:249], v[232:233] op_sel_hi:[1,0,1]
    v_pk_fma_f32 v[232:233], v[234:235], v[248:249], v[232:233] op_sel:[1,1,0] op_sel_hi:[0,1,1] neg_lo:[0,1,0]
    v_xor_b32 v230, s47, v230
    v_xor_b32 v231, s47, v231
    v_or3_b32 v250, v250, v230, v231
    v_pk_fma_f32 v[230:231], v[232:233], v[248:249], v[230:231] op_sel_hi:[1,0,1]
    v_pk_fma_f32 v[230:231], v[232:233], v[248:249], v[230:231] op_sel:[1,1,0] op_sel_hi:[0,1,1] neg_lo:[0,1,0]
    v_xor_b32 v228, s47, v228
    v_xor_b32 v229, s47, v229
    v_or3_b32 v250, v250, v228, v229
    v_pk_fma_f32 v[228:229], v[230:231], v[248:249], v[228:229] op_sel_hi:[1,0,1]
    v_pk_fma_f32 v[228:229], v[230:231], v[248:249], v[228:229] op_sel:[1,1,0] op_sel_hi:[0,1,1] neg_lo:[0,1,0]
    v_xor_b32 v226, s47, v226
    v_xor_b32 v227, s47, v227
    v_or3_b32 v250, v250, v226, v227
    v_pk_fma_f32 v[226:227], v[228:229], v[248:249], v[226:227] op_sel_hi:[1,0,1]
    v_pk_fma_f32 v[226:227], v[228:229], v[248:249], v[226:227] op_sel:[1,1,0] op_sel_hi:[0,1,1] neg_lo:[0,1,0]
    v_xor_b32 v224, s47, v224
    v_xor_b32 v225, s47, v225
    v_or3_b32 v250, v250, v224, v225
    v_pk_fma_f32 v[224:225], v[226:227], v[248:249], v[224:225] op_sel_hi:[1,0,1]
    v_pk_fma_f32 v[224:225], v[226:227], v[248:249], v[224:225] op_sel:[1,1,0] op_sel_hi:[0,1,1] neg_lo:[0,1,0]
    v_xor_b32 v222, s47, v222
    v_xor_b32 v223, s47, v223
    v_or3_b32 v250, v250, v222, v223
    v_pk_fma_f32 v[222:223], v[224:225], v[248:249], v[222:223] op_sel_hi:[1,0,1]
    v_pk_fma_f32 v[222:223], v[224:225], v[248:249], v[222:223] op_sel:[1,1,0] op_sel_hi:[0,1,1] neg_lo:[0,1,0]
    v_xor_b32 v220, s47, v220
    v_xor_b32 v221, s47, v221
    v_or3_b32 v250, v250, v220, v221
    v_pk_fma_f32 v[220:221], v[222:223], v[248:249], v[220:221] op_sel_hi:[1,0,1]
    v_pk_fma_f32 v[220:221], v[222:223], v[248:249], v[220:221] op_sel:[1,1,0] op_sel_hi:[0,1,1] neg_lo:[0,1,0]
    v_xor_b32 v218, s47, v218
    v_xor_b32 v219, s47, v219
    v_or3_b32 v250, v250, v218, v219
    v_pk_fma_f32 v[218:219], v[220:221], v[248:249], v[218:219] op_sel_hi:[1,0,1]
    v_pk_fma_f32 v[218:219], v[220:221], v[248:249], v[218:219] op_sel:[1,1,0] op_sel_hi:[0,1,1] neg_lo:[0,1,0]
    v_xor_b32 v216, s47, v216
    v_xor_b32 v217, s47, v217
    v_or3_b32 v250, v250, v216, v217
    v_pk_fma_f32 v[216:217], v[218:219], v[248:249], v[216:217] op_sel_hi:[1,0,1]
    v_pk_fma_f32 v[216:217], v[218:219], v[248:249], v[216:217] op_sel:[1,1,0] op_sel_hi:[0,1,1] neg_lo:[0,1,0]
    v_and_b32 v250, 0xff, v250
    v_cmp_ne_u32 vcc, 0, v250
    s_add_u32 s96, s96, 1
    s_and_b64 vcc, vcc, s[34:35]
    s_cmp_gt_u32 s96, 0x20000
    s_cbranch_scc1 LB_sok
    s_cbranch_vccnz LB_rs
    s_branch LB_sok
LB_rk:
    buffer_load_dwordx4 v[216:219], v4, s[20:23], s65 offen sc1
    buffer_load_dwordx4 v[220:223], v5, s[20:23], s65 offen sc1
    buffer_load_dword v102, v13, s[20:23], s66 offen offset:0 sc1
    buffer_load_dword v103, v13, s[20:23], s66 offen offset:128 sc1
    s_waitcnt vmcnt(0)
    v_xor_b32 v216, s47, v216
    v_xor_b32 v218, s47, v218
    v_xor_b32 v220, s47, v220
    v_xor_b32 v222, s47, v222
    v_or3_b32 v250, v216, v218, v220
    v_xor_b32 v102, s47, v102
    v_xor_b32 v103, s47, v103
    v_or3_b32 v250, v250, v222, v102
    v_or_b32 v250, v250, v103
    v_and_b32 v250, 0xffff, v250
    v_cmp_ne_u32 vcc, 0, v250
    s_add_u32 s96, s96, 1
    s_cmp_gt_u32 s96, 0x20000
    s_cbranch_scc1 LB_kok
    s_cbranch_vccnz LB_rk
    s_branch LB_kok
LK_rg:
    buffer_load_dword v18, v13, s[20:23], s92 offen sc1
    buffer_load_dword v20, v13, s[20:23], s93 offen sc1
    buffer_load_dword v22, v13, s[20:23], s94 offen sc1
    buffer_load_dword v24, v13, s[20:23], s95 offen sc1
    s_waitcnt vmcnt(0)
    v_xor_b32 v18, s7, v18
    v_xor_b32 v20, s7, v20
    v_xor_b32 v22, s7, v22
    v_xor_b32 v24, s7, v24
    v_or3_b32 v15, v18, v20, v22
    v_or_b32 v15, v15, v24
    v_and_b32 v15, 0xffff, v15
    v_cmp_ne_u32 vcc, 0, v15
    s_add_u32 s96, s96, 1
    s_cmp_gt_u32 s96, 0x20000
    s_cbranch_scc1 LK_gok
    s_cbranch_vccnz LK_rg
    s_branch LK_gok
Lcode_end:
.fill 320, 4, 0xbf800000
.section .rodata,"a"
.p2align 6
.amdhsa_kernel gated_mix__ssm_conv_s5__linear_attn_block__prompt_kernel
  .amdhsa_next_free_vgpr 512
  .amdhsa_next_free_sgpr 102
  .amdhsa_accum_offset 256
  .amdhsa_group_segment_fixed_size 0
  .amdhsa_kernarg_size 128
  .amdhsa_user_sgpr_count 2
  .amdhsa_user_sgpr_kernarg_segment_ptr 1
  .amdhsa_system_sgpr_workgroup_id_x 1
  .amdhsa_float_denorm_mode_32 3
.end_amdhsa_kernel
```
